```python
import torch

def _softmax(x, axis=-1):
    return torch.softmax(x, dim=axis)

def _gelu(x):
    return torch.nn.functional.gelu(x, approximate='tanh')

def _silu(x):
    return torch.nn.functional.silu(x)

def _sigmoid(x):
    return torch.sigmoid(x)

def _layernorm(x, axis=-1, eps=1e-05):
    m = x.mean(dim=axis, keepdim=True)
    v = x.var(dim=axis, keepdim=True, unbiased=False)
    return (x - m) / torch.sqrt(v + eps)

def _scatter_add(tgt, idx, src, axis=0):
    return tgt.clone().index_add_(axis, idx, src)

def _segment_sum(src, seg, n):
    out = torch.zeros((n,) + src.shape[1:], dtype=src.dtype)
    return out.index_add_(0, seg, src)

def _pad(x, pw):
    flat = tuple((v for pair in reversed(pw) for v in pair))
    return torch.nn.functional.pad(x, flat)
kernel_name = 'standalone__swin_window_attn__vision'

def setup_inputs():

    _w = lambda a: (lambda t: t.to(torch.bfloat16) if t.is_floating_point() else t)(torch.as_tensor(a))
    H = W = 512 // 8 * 8
    C, win = (192, 8)
    return {'x': _w((lambda *s: torch.randn(*s, dtype=torch.bfloat16) * 0.2)(1, H, W, C)), 'wqkv': _w((lambda *s: torch.randn(*s, dtype=torch.bfloat16) * 0.2)(C, 3 * C)), 'wo': _w((lambda *s: torch.randn(*s, dtype=torch.bfloat16) * 0.05)(C, C))}

def reference(x, wqkv, wo):
    B, H, W, C = x.shape
    win = 8
    nh, nw = (H // win, W // win)
    xw = (lambda x, *d: x.permute(*d))(x.reshape(B, nh, win, nw, win, C), 0, 1, 3, 2, 4, 5)
    xw = xw.reshape(B * nh * nw, win * win, C)
    qkv = xw @ wqkv
    q, k, v = (qkv[..., :C].clone(), qkv[..., C:2 * C].clone(), qkv[..., 2 * C:].clone())
    scale = C ** (-0.5)
    p = _softmax(torch.einsum('bqc,bkc->bqk', q, k) * scale, axis=-1)
    o = torch.einsum('bqk,bkc->bqc', p, v) @ wo
    o = (lambda x, *d: x.permute(*d))(o.reshape(B, nh, nw, win, win, C), 0, 1, 3, 2, 4, 5)
    return o.reshape(B, H, W, C)
```

```asm
; @launch kernel=swin_prep_kernel grid=(144,1,1) block=(64,1,1) lds=6144
; @launch kernel=standalone__swin_window_attn__vision_kernel grid=(256,1,1) block=(256,1,1) lds=114688
.amdgcn_target "amdgcn-amd-amdhsa--gfx950"
.text
.globl swin_prep_kernel
.p2align 8
.type swin_prep_kernel,@function
swin_prep_kernel:
    s_cmp_ge_u32 s2, 144
    s_cbranch_scc1 L_prep_end
    s_load_dwordx4 s[4:7], s[0:1], 8
    s_load_dwordx2 s[8:9], s[0:1], 40
    v_and_b32 v1, 15, v0
    v_lshrrev_b32 v2, 4, v0
    v_lshrrev_b32 v3, 2, v1
    v_lshlrev_b32 v3, 3, v3
    v_and_b32 v4, 3, v1
    v_add_u32 v3, v3, v4
    s_cmp_ge_u32 s2, 72
    s_cselect_b32 s20, 1, 0
    s_cselect_b32 s21, 72, 0
    s_sub_u32 s21, s2, s21
    s_mul_i32 s22, s21, 43
    s_lshr_b32 s22, s22, 8
    s_mul_i32 s23, s22, 6
    s_sub_u32 s23, s21, s23
    s_waitcnt lgkmcnt(0)
    s_mov_b32 s12, s4
    s_mov_b32 s13, s5
    s_mov_b32 s14, 221184
    s_mov_b32 s15, 0x00020000
    s_mov_b32 s16, s6
    s_mov_b32 s17, s7
    s_mov_b32 s18, 73728
    s_mov_b32 s19, 0x00020000
    s_mov_b32 s24, s8
    s_mov_b32 s25, s9
    s_mov_b32 s26, 147456
    s_mov_b32 s27, 0x00020000
    s_lshl_b32 s28, s23, 5
    v_add_u32 v6, s28, v3
    s_movk_i32 s29, 1152
    v_mul_lo_u32 v6, v6, s29
    v_lshl_add_u32 v6, v2, 4, v6
    s_mul_i32 s30, s20, 768
    v_add_u32 v6, s30, v6
    v_add_u32 v7, 4608, v6
    buffer_load_dwordx4 v[16:19], v6, s[12:15], 0 offen offset:0
    buffer_load_dwordx4 v[40:43], v7, s[12:15], 0 offen offset:0
    buffer_load_dwordx4 v[20:23], v6, s[12:15], 0 offen offset:64
    buffer_load_dwordx4 v[44:47], v7, s[12:15], 0 offen offset:64
    buffer_load_dwordx4 v[24:27], v6, s[12:15], 0 offen offset:128
    buffer_load_dwordx4 v[48:51], v7, s[12:15], 0 offen offset:128
    buffer_load_dwordx4 v[28:31], v6, s[12:15], 0 offen offset:192
    buffer_load_dwordx4 v[52:55], v7, s[12:15], 0 offen offset:192
    buffer_load_dwordx4 v[32:35], v6, s[12:15], 0 offen offset:256
    buffer_load_dwordx4 v[56:59], v7, s[12:15], 0 offen offset:256
    buffer_load_dwordx4 v[36:39], v6, s[12:15], 0 offen offset:320
    buffer_load_dwordx4 v[60:63], v7, s[12:15], 0 offen offset:320
    s_cmp_eq_u32 s20, 1
    s_cbranch_scc1 L_prep_N
    s_lshr_b32 s28, s22, 1
    s_lshl_b32 s28, s28, 5
    s_and_b32 s31, s22, 1
    s_lshl_b32 s31, s31, 2
    s_add_u32 s28, s28, s31
    v_add_u32 v8, s28, v3
    v_mul_lo_u32 v8, v8, s29
    v_lshl_add_u32 v8, v2, 4, v8
    buffer_load_dwordx4 v[64:67], v8, s[12:15], 0 offen offset:384
    buffer_load_dwordx4 v[68:71], v8, s[12:15], 0 offen offset:448
    buffer_load_dwordx4 v[72:75], v8, s[12:15], 0 offen offset:512
    buffer_load_dwordx4 v[76:79], v8, s[12:15], 0 offen offset:576
    buffer_load_dwordx4 v[80:83], v8, s[12:15], 0 offen offset:640
    buffer_load_dwordx4 v[84:87], v8, s[12:15], 0 offen offset:704
    s_lshl_b32 s28, s21, 10
    v_lshlrev_b32 v9, 4, v0
    s_branch L_prep_mm
L_prep_N:
    v_lshrrev_b32 v8, 1, v0
    v_mul_u32_u24 v8, 384, v8
    v_and_b32 v9, 1, v0
    v_lshl_add_u32 v8, v9, 4, v8
    s_lshl_b32 s28, s22, 5
    s_mov_b32 m0, 0
    s_add_u32 s34, s28, 0
    buffer_load_dwordx4 v8, s[16:19], s34 offen lds
    s_mov_b32 m0, 1024
    s_add_u32 s34, s28, 12288
    buffer_load_dwordx4 v8, s[16:19], s34 offen lds
    s_mov_b32 m0, 2048
    s_add_u32 s34, s28, 24576
    buffer_load_dwordx4 v8, s[16:19], s34 offen lds
    s_mov_b32 m0, 3072
    s_add_u32 s34, s28, 36864
    buffer_load_dwordx4 v8, s[16:19], s34 offen lds
    s_mov_b32 m0, 4096
    s_add_u32 s34, s28, 49152
    buffer_load_dwordx4 v8, s[16:19], s34 offen lds
    s_mov_b32 m0, 5120
    s_add_u32 s34, s28, 61440
    buffer_load_dwordx4 v8, s[16:19], s34 offen lds
    v_lshlrev_b32 v8, 3, v2
    v_lshrrev_b32 v9, 2, v0
    v_and_b32 v9, 3, v9
    v_add_u32 v8, v8, v9
    v_lshlrev_b32 v8, 5, v8
    v_and_b32 v10, 3, v0
    v_lshl_add_u32 v8, v10, 3, v8
    s_waitcnt vmcnt(0)
    ds_read_b64_tr_b16 v[64:65], v8 offset:0
    ds_read_b64_tr_b16 v[66:67], v8 offset:128
    ds_read_b64_tr_b16 v[68:69], v8 offset:1024
    ds_read_b64_tr_b16 v[70:71], v8 offset:1152
    ds_read_b64_tr_b16 v[72:73], v8 offset:2048
    ds_read_b64_tr_b16 v[74:75], v8 offset:2176
    ds_read_b64_tr_b16 v[76:77], v8 offset:3072
    ds_read_b64_tr_b16 v[78:79], v8 offset:3200
    ds_read_b64_tr_b16 v[80:81], v8 offset:4096
    ds_read_b64_tr_b16 v[82:83], v8 offset:4224
    ds_read_b64_tr_b16 v[84:85], v8 offset:5120
    ds_read_b64_tr_b16 v[86:87], v8 offset:5248
    v_and_b32 v9, 3, v1
    v_lshlrev_b32 v10, 8, v2
    v_lshrrev_b32 v11, 2, v1
    s_lshl_b32 s33, s23, 10
    s_add_u32 s33, s33, 73728
    s_cmp_ge_u32 s22, 8
    s_cbranch_scc1 L_prep_N2
    v_mul_u32_u24 v9, 6144, v9
    v_lshlrev_b32 v11, 4, v11
    v_add3_u32 v9, v9, v10, v11
    s_lshr_b32 s28, s22, 2
    s_mul_i32 s28, s28, 36864
    s_and_b32 s34, s22, 3
    s_lshl_b32 s34, s34, 6
    s_branch L_prep_N3
L_prep_N2:
    v_lshlrev_b32 v9, 4, v9
    v_and_b32 v12, 1, v11
    v_mul_u32_u24 v12, 6144, v12
    v_lshrrev_b32 v11, 3, v1
    v_lshlrev_b32 v11, 6, v11
    v_add3_u32 v9, v9, v10, v11
    v_add_u32 v9, v9, v12
    s_sub_u32 s34, s22, 8
    s_lshr_b32 s28, s34, 1
    s_mul_i32 s28, s28, 36864
    s_add_u32 s28, s28, 24576
    s_and_b32 s34, s34, 1
    s_lshl_b32 s34, s34, 7
L_prep_N3:
    s_add_u32 s28, s28, s34
    s_add_u32 s28, s28, s33
    s_waitcnt lgkmcnt(0)
L_prep_mm:
    s_waitcnt vmcnt(0)
    v_mfma_f32_16x16x32_bf16 v[112:115], v[16:19], v[64:67], 0
    v_mfma_f32_16x16x32_bf16 v[116:119], v[40:43], v[64:67], 0
    v_mfma_f32_16x16x32_bf16 v[112:115], v[20:23], v[68:71], v[112:115]
    v_mfma_f32_16x16x32_bf16 v[116:119], v[44:47], v[68:71], v[116:119]
    v_mfma_f32_16x16x32_bf16 v[112:115], v[24:27], v[72:75], v[112:115]
    v_mfma_f32_16x16x32_bf16 v[116:119], v[48:51], v[72:75], v[116:119]
    v_mfma_f32_16x16x32_bf16 v[112:115], v[28:31], v[76:79], v[112:115]
    v_mfma_f32_16x16x32_bf16 v[116:119], v[52:55], v[76:79], v[116:119]
    v_mfma_f32_16x16x32_bf16 v[112:115], v[32:35], v[80:83], v[112:115]
    v_mfma_f32_16x16x32_bf16 v[116:119], v[56:59], v[80:83], v[116:119]
    v_mfma_f32_16x16x32_bf16 v[112:115], v[36:39], v[84:87], v[112:115]
    v_mfma_f32_16x16x32_bf16 v[116:119], v[60:63], v[84:87], v[116:119]
    s_nop 15
    v_cvt_pk_bf16_f32 v128, v112, v113
    v_cvt_pk_bf16_f32 v129, v114, v115
    v_cvt_pk_bf16_f32 v130, v116, v117
    v_cvt_pk_bf16_f32 v131, v118, v119
    buffer_store_dwordx4 v[128:131], v9, s[24:27], s28 offen
L_prep_end:
    s_endpgm
.globl standalone__swin_window_attn__vision_kernel
.p2align 8
.type standalone__swin_window_attn__vision_kernel,@function
standalone__swin_window_attn__vision_kernel:
    s_cmp_ge_u32 s2, 256
    s_cbranch_scc1 L_end
    s_load_dwordx2 s[4:5], s[0:1], 0
    s_load_dwordx2 s[6:7], s[0:1], 24
    s_load_dwordx2 s[50:51], s[0:1], 40
    v_lshrrev_b32 v16, 6, v0
    v_and_b32 v0, 63, v0
    s_lshr_b32 s53, s2, 6
    v_readfirstlane_b32 s49, v16
    v_lshlrev_b32 v1, 4, v0
    v_and_b32 v16, 15, v0
    v_lshrrev_b32 v17, 4, v0
    s_mul_i32 s53, s53, 1572864
    s_and_b32 s54, s2, 63
    s_mul_i32 s54, s54, 3072
    s_add_u32 s38, s53, s54
    s_and_b32 s37, s49, 1
    s_mov_b32 s54, 147456
    s_mov_b32 s55, 0x00020000
    s_cmp_ge_u32 s49, 2
    s_cbranch_scc1 L_nrole
    s_waitcnt lgkmcnt(0)
    s_mov_b32 s52, s50
    s_mov_b32 s53, s51
    s_mov_b32 s60, 0
    buffer_load_dwordx4 a[0:3], v1, s[52:55], s60 offen offset:0
    buffer_load_dwordx4 a[4:7], v1, s[52:55], s60 offen offset:1024
    buffer_load_dwordx4 a[8:11], v1, s[52:55], s60 offen offset:2048
    buffer_load_dwordx4 a[12:15], v1, s[52:55], s60 offen offset:3072
    s_mov_b32 s60, 4096
    buffer_load_dwordx4 a[16:19], v1, s[52:55], s60 offen offset:0
    buffer_load_dwordx4 a[20:23], v1, s[52:55], s60 offen offset:1024
    buffer_load_dwordx4 a[24:27], v1, s[52:55], s60 offen offset:2048
    buffer_load_dwordx4 a[28:31], v1, s[52:55], s60 offen offset:3072
    s_mov_b32 s60, 8192
    buffer_load_dwordx4 a[32:35], v1, s[52:55], s60 offen offset:0
    buffer_load_dwordx4 a[36:39], v1, s[52:55], s60 offen offset:1024
    buffer_load_dwordx4 a[40:43], v1, s[52:55], s60 offen offset:2048
    buffer_load_dwordx4 a[44:47], v1, s[52:55], s60 offen offset:3072
    s_mov_b32 s60, 12288
    buffer_load_dwordx4 a[48:51], v1, s[52:55], s60 offen offset:0
    buffer_load_dwordx4 a[52:55], v1, s[52:55], s60 offen offset:1024
    buffer_load_dwordx4 a[56:59], v1, s[52:55], s60 offen offset:2048
    buffer_load_dwordx4 a[60:63], v1, s[52:55], s60 offen offset:3072
    s_mov_b32 s60, 16384
    buffer_load_dwordx4 a[64:67], v1, s[52:55], s60 offen offset:0
    buffer_load_dwordx4 a[68:71], v1, s[52:55], s60 offen offset:1024
    buffer_load_dwordx4 a[72:75], v1, s[52:55], s60 offen offset:2048
    buffer_load_dwordx4 a[76:79], v1, s[52:55], s60 offen offset:3072
    s_mov_b32 s60, 20480
    buffer_load_dwordx4 a[80:83], v1, s[52:55], s60 offen offset:0
    buffer_load_dwordx4 a[84:87], v1, s[52:55], s60 offen offset:1024
    buffer_load_dwordx4 a[88:91], v1, s[52:55], s60 offen offset:2048
    buffer_load_dwordx4 a[92:95], v1, s[52:55], s60 offen offset:3072
    s_mov_b32 s60, 24576
    buffer_load_dwordx4 a[96:99], v1, s[52:55], s60 offen offset:0
    buffer_load_dwordx4 a[100:103], v1, s[52:55], s60 offen offset:1024
    buffer_load_dwordx4 a[104:107], v1, s[52:55], s60 offen offset:2048
    buffer_load_dwordx4 a[108:111], v1, s[52:55], s60 offen offset:3072
    s_mov_b32 s60, 28672
    buffer_load_dwordx4 a[112:115], v1, s[52:55], s60 offen offset:0
    buffer_load_dwordx4 a[116:119], v1, s[52:55], s60 offen offset:1024
    buffer_load_dwordx4 a[120:123], v1, s[52:55], s60 offen offset:2048
    buffer_load_dwordx4 a[124:127], v1, s[52:55], s60 offen offset:3072
    s_mov_b32 s60, 32768
    buffer_load_dwordx4 a[128:131], v1, s[52:55], s60 offen offset:0
    buffer_load_dwordx4 a[132:135], v1, s[52:55], s60 offen offset:1024
    buffer_load_dwordx4 a[136:139], v1, s[52:55], s60 offen offset:2048
    buffer_load_dwordx4 a[140:143], v1, s[52:55], s60 offen offset:3072
    s_mov_b32 s60, 36864
    buffer_load_dwordx4 a[144:147], v1, s[52:55], s60 offen offset:0
    buffer_load_dwordx4 a[148:151], v1, s[52:55], s60 offen offset:1024
    buffer_load_dwordx4 a[152:155], v1, s[52:55], s60 offen offset:2048
    buffer_load_dwordx4 a[156:159], v1, s[52:55], s60 offen offset:3072
    s_mov_b32 s60, 40960
    buffer_load_dwordx4 a[160:163], v1, s[52:55], s60 offen offset:0
    buffer_load_dwordx4 a[164:167], v1, s[52:55], s60 offen offset:1024
    buffer_load_dwordx4 a[168:171], v1, s[52:55], s60 offen offset:2048
    buffer_load_dwordx4 a[172:175], v1, s[52:55], s60 offen offset:3072
    s_mov_b32 s60, 45056
    buffer_load_dwordx4 a[176:179], v1, s[52:55], s60 offen offset:0
    buffer_load_dwordx4 a[180:183], v1, s[52:55], s60 offen offset:1024
    buffer_load_dwordx4 a[184:187], v1, s[52:55], s60 offen offset:2048
    buffer_load_dwordx4 a[188:191], v1, s[52:55], s60 offen offset:3072
    s_mov_b32 s60, 49152
    buffer_load_dwordx4 a[192:195], v1, s[52:55], s60 offen offset:0
    buffer_load_dwordx4 a[196:199], v1, s[52:55], s60 offen offset:1024
    buffer_load_dwordx4 a[200:203], v1, s[52:55], s60 offen offset:2048
    buffer_load_dwordx4 a[204:207], v1, s[52:55], s60 offen offset:3072
    s_mov_b32 s60, 53248
    buffer_load_dwordx4 a[208:211], v1, s[52:55], s60 offen offset:0
    buffer_load_dwordx4 a[212:215], v1, s[52:55], s60 offen offset:1024
    buffer_load_dwordx4 a[216:219], v1, s[52:55], s60 offen offset:2048
    buffer_load_dwordx4 a[220:223], v1, s[52:55], s60 offen offset:3072
    s_mov_b32 s60, 57344
    buffer_load_dwordx4 a[224:227], v1, s[52:55], s60 offen offset:0
    buffer_load_dwordx4 a[228:231], v1, s[52:55], s60 offen offset:1024
    buffer_load_dwordx4 a[232:235], v1, s[52:55], s60 offen offset:2048
    buffer_load_dwordx4 a[236:239], v1, s[52:55], s60 offen offset:3072
    s_mov_b32 s60, 61440
    buffer_load_dwordx4 a[240:243], v1, s[52:55], s60 offen offset:0
    buffer_load_dwordx4 a[244:247], v1, s[52:55], s60 offen offset:1024
    buffer_load_dwordx4 a[248:251], v1, s[52:55], s60 offen offset:2048
    buffer_load_dwordx4 a[252:255], v1, s[52:55], s60 offen offset:3072
    s_mov_b32 s60, 65536
    buffer_load_dwordx4 v[224:227], v1, s[52:55], s60 offen offset:0
    buffer_load_dwordx4 v[228:231], v1, s[52:55], s60 offen offset:1024
    buffer_load_dwordx4 v[232:235], v1, s[52:55], s60 offen offset:2048
    buffer_load_dwordx4 v[236:239], v1, s[52:55], s60 offen offset:3072
    s_mov_b32 s60, 69632
    buffer_load_dwordx4 v[240:243], v1, s[52:55], s60 offen offset:0
    buffer_load_dwordx4 v[244:247], v1, s[52:55], s60 offen offset:1024
    buffer_load_dwordx4 v[248:251], v1, s[52:55], s60 offen offset:2048
    buffer_load_dwordx4 v[252:255], v1, s[52:55], s60 offen offset:3072
    v_lshrrev_b32 v18, 1, v16
    v_xor_b32 v18, v18, v17
    v_lshlrev_b32 v18, 4, v18
    v_mul_u32_u24 v19, 384, v16
    v_add_u32 v2, v18, v19
    v_xor_b32 v3, 64, v2
    s_mul_i32 s47, s37, 12288
    s_sub_u32 s39, 12288, s47
    s_mov_b32 s41, 73728
    s_mul_i32 s60, s37, 5120
    s_add_u32 s60, s60, 106496
    v_add_u32 v8, s60, v1
    v_xor_b32 v9, 1024, v8
    s_mov_b32 s40, 0x3dd53b95
    s_mov_b32 s48, -1
    s_barrier
    .p2align 6
L_mloop:
    v_mfma_f32_16x16x32_bf16 v[32:35], v[128:131], v[80:83], 0
    s_add_u32 s41, s41, 24576
    s_cmp_ge_u32 s41, 98304
    s_cselect_b32 s56, 98304, 0
    s_sub_u32 s41, s41, s56
    s_add_u32 s46, s41, s47
    v_mfma_f32_16x16x32_bf16 v[32:35], v[132:135], v[84:87], v[32:35]
    v_cvt_pk_bf16_f32 v126, v76, v77
    v_cvt_pk_bf16_f32 v127, v78, v79
    v_mfma_f32_16x16x32_bf16 v[32:35], v[136:139], v[88:91], v[32:35]
    v_add_u32 v4, s46, v2
    v_add_u32 v5, s46, v3
    v_mfma_f32_16x16x32_bf16 v[32:35], v[140:143], v[92:95], v[32:35]
    s_add_u32 s57, s41, s39
    v_add_u32 v6, s57, v2
    v_mfma_f32_16x16x32_bf16 v[32:35], v[144:147], v[96:99], v[32:35]
    v_add_u32 v7, s57, v3
    v_xor_b32 v8, 8192, v8
    v_mfma_f32_16x16x32_bf16 v[32:35], v[148:151], v[100:103], v[32:35]
    v_xor_b32 v9, 8192, v9
    v_mfma_f32_16x16x32_bf16 v[48:51], v[128:131], v[104:107], 0
    ds_read_b128 v[128:131], v4 offset:0
    v_mfma_f32_16x16x32_bf16 v[48:51], v[132:135], v[108:111], v[48:51]
    ds_read_b128 v[132:135], v5 offset:0
    v_mfma_f32_16x16x32_bf16 v[48:51], v[136:139], v[112:115], v[48:51]
    ds_read_b128 v[136:139], v4 offset:128
    v_max3_f32 v12, v32, v33, v34
    v_mfma_f32_16x16x32_bf16 v[48:51], v[140:143], v[116:119], v[48:51]
    ds_read_b128 v[140:143], v5 offset:128
    v_mfma_f32_16x16x32_bf16 v[48:51], v[144:147], v[120:123], v[48:51]
    ds_read_b128 v[144:147], v4 offset:256
    v_mfma_f32_16x16x32_bf16 v[48:51], v[148:151], v[124:127], v[48:51]
    ds_read_b128 v[148:151], v5 offset:256
    v_mfma_f32_16x16x32_bf16 v[36:39], v[152:155], v[80:83], 0
    v_mfma_f32_16x16x32_bf16 v[36:39], v[156:159], v[84:87], v[36:39]
    v_mfma_f32_16x16x32_bf16 v[36:39], v[160:163], v[88:91], v[36:39]
    v_max3_f32 v13, v48, v49, v50
    v_mfma_f32_16x16x32_bf16 v[36:39], v[164:167], v[92:95], v[36:39]
    v_mfma_f32_16x16x32_bf16 v[36:39], v[168:171], v[96:99], v[36:39]
    v_mfma_f32_16x16x32_bf16 v[36:39], v[172:175], v[100:103], v[36:39]
    v_mfma_f32_16x16x32_bf16 v[52:55], v[152:155], v[104:107], 0
    ds_read_b128 v[152:155], v4 offset:6144
    v_mfma_f32_16x16x32_bf16 v[52:55], v[156:159], v[108:111], v[52:55]
    ds_read_b128 v[156:159], v5 offset:6144
    v_mfma_f32_16x16x32_bf16 v[52:55], v[160:163], v[112:115], v[52:55]
    ds_read_b128 v[160:163], v4 offset:6272
    v_max3_f32 v12, v12, v35, v36
    v_mfma_f32_16x16x32_bf16 v[52:55], v[164:167], v[116:119], v[52:55]
    ds_read_b128 v[164:167], v5 offset:6272
    v_max3_f32 v12, v12, v37, v38
    v_mfma_f32_16x16x32_bf16 v[52:55], v[168:171], v[120:123], v[52:55]
    ds_read_b128 v[168:171], v4 offset:6400
    v_mfma_f32_16x16x32_bf16 v[52:55], v[172:175], v[124:127], v[52:55]
    ds_read_b128 v[172:175], v5 offset:6400
    v_mfma_f32_16x16x32_bf16 v[40:43], v[176:179], v[80:83], 0
    v_mfma_f32_16x16x32_bf16 v[40:43], v[180:183], v[84:87], v[40:43]
    v_mfma_f32_16x16x32_bf16 v[40:43], v[184:187], v[88:91], v[40:43]
    v_max3_f32 v13, v13, v51, v52
    v_max3_f32 v13, v13, v53, v54
    v_mfma_f32_16x16x32_bf16 v[40:43], v[188:191], v[92:95], v[40:43]
    v_mfma_f32_16x16x32_bf16 v[40:43], v[192:195], v[96:99], v[40:43]
    v_mfma_f32_16x16x32_bf16 v[40:43], v[196:199], v[100:103], v[40:43]
    v_mfma_f32_16x16x32_bf16 v[56:59], v[176:179], v[104:107], 0
    v_mfma_f32_16x16x32_bf16 v[56:59], v[180:183], v[108:111], v[56:59]
    v_mfma_f32_16x16x32_bf16 v[56:59], v[184:187], v[112:115], v[56:59]
    v_max3_f32 v12, v12, v39, v40
    v_max3_f32 v12, v12, v41, v42
    v_mfma_f32_16x16x32_bf16 v[56:59], v[188:191], v[116:119], v[56:59]
    v_mfma_f32_16x16x32_bf16 v[56:59], v[192:195], v[120:123], v[56:59]
    v_mfma_f32_16x16x32_bf16 v[56:59], v[196:199], v[124:127], v[56:59]
    v_mfma_f32_16x16x32_bf16 v[44:47], v[200:203], v[80:83], 0
    v_mfma_f32_16x16x32_bf16 v[44:47], v[204:207], v[84:87], v[44:47]
    v_mfma_f32_16x16x32_bf16 v[44:47], v[208:211], v[88:91], v[44:47]
    v_max3_f32 v13, v13, v55, v56
    v_max3_f32 v13, v13, v57, v58
    v_mfma_f32_16x16x32_bf16 v[44:47], v[212:215], v[92:95], v[44:47]
    v_mfma_f32_16x16x32_bf16 v[44:47], v[216:219], v[96:99], v[44:47]
    v_mfma_f32_16x16x32_bf16 v[44:47], v[220:223], v[100:103], v[44:47]
    v_mfma_f32_16x16x32_bf16 v[60:63], v[200:203], v[104:107], 0
    v_mfma_f32_16x16x32_bf16 v[60:63], v[204:207], v[108:111], v[60:63]
    v_mfma_f32_16x16x32_bf16 v[60:63], v[208:211], v[112:115], v[60:63]
    s_waitcnt vmcnt(0)
    v_max3_f32 v12, v12, v43, v44
    v_mfma_f32_16x16x32_bf16 v[60:63], v[212:215], v[116:119], v[60:63]
    v_max3_f32 v12, v12, v45, v46
    v_max_f32 v12, v12, v47
    v_mfma_f32_16x16x32_bf16 v[60:63], v[216:219], v[120:123], v[60:63]
    v_mfma_f32_16x16x32_bf16 v[60:63], v[220:223], v[124:127], v[60:63]
    s_waitcnt lgkmcnt(0)
    v_mfma_f32_16x16x32_bf16 v[64:67], a[0:3], v[128:131], 0
    v_mfma_f32_16x16x32_bf16 v[64:67], a[4:7], v[132:135], v[64:67]
    v_mfma_f32_16x16x32_bf16 v[64:67], a[8:11], v[136:139], v[64:67]
    v_max3_f32 v13, v13, v59, v60
    v_max3_f32 v13, v13, v61, v62
    v_mfma_f32_16x16x32_bf16 v[64:67], a[12:15], v[140:143], v[64:67]
    v_max_f32 v13, v13, v63
    v_mfma_f32_16x16x32_bf16 v[64:67], a[16:19], v[144:147], v[64:67]
    v_mfma_f32_16x16x32_bf16 v[64:67], a[20:23], v[148:151], v[64:67]
    v_permlane16_swap_b32 v12, v13
    v_max_f32 v12, v12, v13
    v_mfma_f32_16x16x32_bf16 v[68:71], a[0:3], v[152:155], 0
    v_mov_b32 v13, v12
    v_mfma_f32_16x16x32_bf16 v[68:71], a[4:7], v[156:159], v[68:71]
    v_mfma_f32_16x16x32_bf16 v[68:71], a[8:11], v[160:163], v[68:71]
    v_cvt_pk_bf16_f32 v80, v64, v65
    v_cvt_pk_bf16_f32 v81, v66, v67
    v_mfma_f32_16x16x32_bf16 v[68:71], a[12:15], v[164:167], v[68:71]
    v_permlane32_swap_b32 v12, v13
    v_max_f32 v12, v12, v13
    v_mfma_f32_16x16x32_bf16 v[68:71], a[16:19], v[168:171], v[68:71]
    v_mul_f32 v12, s40, v12
    v_mov_b32 v13, v12
    v_mfma_f32_16x16x32_bf16 v[68:71], a[20:23], v[172:175], v[68:71]
    v_mfma_f32_16x16x32_bf16 v[72:75], a[24:27], v[128:131], 0
    v_permlane16_swap_b32 v12, v13
    v_fma_f32 v32, v32, s40, -v12
    v_mfma_f32_16x16x32_bf16 v[72:75], a[28:31], v[132:135], v[72:75]
    v_fma_f32 v48, v48, s40, -v13
    v_fma_f32 v33, v33, s40, -v12
    v_mfma_f32_16x16x32_bf16 v[72:75], a[32:35], v[136:139], v[72:75]
    v_cvt_pk_bf16_f32 v104, v68, v69
    v_cvt_pk_bf16_f32 v105, v70, v71
    v_mfma_f32_16x16x32_bf16 v[72:75], a[36:39], v[140:143], v[72:75]
    v_fma_f32 v49, v49, s40, -v13
    v_fma_f32 v34, v34, s40, -v12
    v_mfma_f32_16x16x32_bf16 v[72:75], a[40:43], v[144:147], v[72:75]
    v_exp_f32 v32, v32
    v_mfma_f32_16x16x32_bf16 v[72:75], a[44:47], v[148:151], v[72:75]
    v_exp_f32 v48, v48
    v_mfma_f32_16x16x32_bf16 v[76:79], a[24:27], v[152:155], 0
    v_exp_f32 v33, v33
    v_mfma_f32_16x16x32_bf16 v[76:79], a[28:31], v[156:159], v[76:79]
    v_exp_f32 v49, v49
    v_mfma_f32_16x16x32_bf16 v[76:79], a[32:35], v[160:163], v[76:79]
    v_cvt_pk_bf16_f32 v82, v72, v73
    v_cvt_pk_bf16_f32 v83, v74, v75
    v_mfma_f32_16x16x32_bf16 v[76:79], a[36:39], v[164:167], v[76:79]
    v_fma_f32 v50, v50, s40, -v13
    v_fma_f32 v35, v35, s40, -v12
    v_mfma_f32_16x16x32_bf16 v[76:79], a[40:43], v[168:171], v[76:79]
    v_exp_f32 v34, v34
    v_mfma_f32_16x16x32_bf16 v[76:79], a[44:47], v[172:175], v[76:79]
    v_exp_f32 v50, v50
    v_mfma_f32_16x16x32_bf16 v[64:67], a[48:51], v[128:131], 0
    v_fma_f32 v51, v51, s40, -v13
    v_fma_f32 v36, v36, s40, -v12
    v_mfma_f32_16x16x32_bf16 v[64:67], a[52:55], v[132:135], v[64:67]
    v_exp_f32 v35, v35
    v_mfma_f32_16x16x32_bf16 v[64:67], a[56:59], v[136:139], v[64:67]
    v_cvt_pk_bf16_f32 v106, v76, v77
    v_cvt_pk_bf16_f32 v107, v78, v79
    v_mfma_f32_16x16x32_bf16 v[64:67], a[60:63], v[140:143], v[64:67]
    v_exp_f32 v51, v51
    v_mfma_f32_16x16x32_bf16 v[64:67], a[64:67], v[144:147], v[64:67]
    v_fma_f32 v52, v52, s40, -v13
    v_add_f32 v14, v32, v33
    v_mfma_f32_16x16x32_bf16 v[64:67], a[68:71], v[148:151], v[64:67]
    v_add_f32 v15, v48, v49
    v_fma_f32 v37, v37, s40, -v12
    v_mfma_f32_16x16x32_bf16 v[68:71], a[48:51], v[152:155], 0
    v_exp_f32 v36, v36
    v_mfma_f32_16x16x32_bf16 v[68:71], a[52:55], v[156:159], v[68:71]
    v_exp_f32 v52, v52
    v_mfma_f32_16x16x32_bf16 v[68:71], a[56:59], v[160:163], v[68:71]
    v_cvt_pk_bf16_f32 v84, v64, v65
    v_cvt_pk_bf16_f32 v85, v66, v67
    v_mfma_f32_16x16x32_bf16 v[68:71], a[60:63], v[164:167], v[68:71]
    v_fma_f32 v53, v53, s40, -v13
    v_add_f32 v14, v14, v34
    v_mfma_f32_16x16x32_bf16 v[68:71], a[64:67], v[168:171], v[68:71]
    v_add_f32 v15, v15, v50
    v_fma_f32 v38, v38, s40, -v12
    v_mfma_f32_16x16x32_bf16 v[68:71], a[68:71], v[172:175], v[68:71]
    v_exp_f32 v37, v37
    v_mfma_f32_16x16x32_bf16 v[72:75], a[72:75], v[128:131], 0
    v_exp_f32 v53, v53
    v_mfma_f32_16x16x32_bf16 v[72:75], a[76:79], v[132:135], v[72:75]
    v_fma_f32 v54, v54, s40, -v13
    v_add_f32 v14, v14, v35
    v_mfma_f32_16x16x32_bf16 v[72:75], a[80:83], v[136:139], v[72:75]
    v_cvt_pk_bf16_f32 v108, v68, v69
    v_cvt_pk_bf16_f32 v109, v70, v71
    v_mfma_f32_16x16x32_bf16 v[72:75], a[84:87], v[140:143], v[72:75]
    v_add_f32 v15, v15, v51
    v_fma_f32 v39, v39, s40, -v12
    v_mfma_f32_16x16x32_bf16 v[72:75], a[88:91], v[144:147], v[72:75]
    v_exp_f32 v38, v38
    v_mfma_f32_16x16x32_bf16 v[72:75], a[92:95], v[148:151], v[72:75]
    v_exp_f32 v54, v54
    v_mfma_f32_16x16x32_bf16 v[76:79], a[72:75], v[152:155], 0
    v_fma_f32 v55, v55, s40, -v13
    v_add_f32 v14, v14, v36
    v_mfma_f32_16x16x32_bf16 v[76:79], a[76:79], v[156:159], v[76:79]
    v_add_f32 v15, v15, v52
    v_fma_f32 v40, v40, s40, -v12
    v_mfma_f32_16x16x32_bf16 v[76:79], a[80:83], v[160:163], v[76:79]
    v_cvt_pk_bf16_f32 v86, v72, v73
    v_cvt_pk_bf16_f32 v87, v74, v75
    v_mfma_f32_16x16x32_bf16 v[76:79], a[84:87], v[164:167], v[76:79]
    v_exp_f32 v39, v39
    v_mfma_f32_16x16x32_bf16 v[76:79], a[88:91], v[168:171], v[76:79]
    v_exp_f32 v55, v55
    v_mfma_f32_16x16x32_bf16 v[76:79], a[92:95], v[172:175], v[76:79]
    v_fma_f32 v56, v56, s40, -v13
    v_add_f32 v14, v14, v37
    v_mfma_f32_16x16x32_bf16 v[64:67], a[96:99], v[128:131], 0
    v_add_f32 v15, v15, v53
    v_fma_f32 v41, v41, s40, -v12
    v_mfma_f32_16x16x32_bf16 v[64:67], a[100:103], v[132:135], v[64:67]
    v_exp_f32 v40, v40
    v_mfma_f32_16x16x32_bf16 v[64:67], a[104:107], v[136:139], v[64:67]
    v_cvt_pk_bf16_f32 v110, v76, v77
    v_cvt_pk_bf16_f32 v111, v78, v79
    v_mfma_f32_16x16x32_bf16 v[64:67], a[108:111], v[140:143], v[64:67]
    v_exp_f32 v56, v56
    v_mfma_f32_16x16x32_bf16 v[64:67], a[112:115], v[144:147], v[64:67]
    v_fma_f32 v57, v57, s40, -v13
    v_add_f32 v14, v14, v38
    v_mfma_f32_16x16x32_bf16 v[64:67], a[116:119], v[148:151], v[64:67]
    v_add_f32 v15, v15, v54
    v_fma_f32 v42, v42, s40, -v12
    v_mfma_f32_16x16x32_bf16 v[68:71], a[96:99], v[152:155], 0
    v_exp_f32 v41, v41
    v_mfma_f32_16x16x32_bf16 v[68:71], a[100:103], v[156:159], v[68:71]
    v_exp_f32 v57, v57
    v_mfma_f32_16x16x32_bf16 v[68:71], a[104:107], v[160:163], v[68:71]
    v_cvt_pk_bf16_f32 v88, v64, v65
    v_cvt_pk_bf16_f32 v89, v66, v67
    v_mfma_f32_16x16x32_bf16 v[68:71], a[108:111], v[164:167], v[68:71]
    v_fma_f32 v58, v58, s40, -v13
    v_add_f32 v14, v14, v39
    v_mfma_f32_16x16x32_bf16 v[68:71], a[112:115], v[168:171], v[68:71]
    v_add_f32 v15, v15, v55
    v_fma_f32 v43, v43, s40, -v12
    v_mfma_f32_16x16x32_bf16 v[68:71], a[116:119], v[172:175], v[68:71]
    v_exp_f32 v42, v42
    v_mfma_f32_16x16x32_bf16 v[72:75], a[120:123], v[128:131], 0
    v_exp_f32 v58, v58
    v_mfma_f32_16x16x32_bf16 v[72:75], a[124:127], v[132:135], v[72:75]
    v_fma_f32 v59, v59, s40, -v13
    v_add_f32 v14, v14, v40
    v_mfma_f32_16x16x32_bf16 v[72:75], a[128:131], v[136:139], v[72:75]
    v_cvt_pk_bf16_f32 v112, v68, v69
    v_cvt_pk_bf16_f32 v113, v70, v71
    v_mfma_f32_16x16x32_bf16 v[72:75], a[132:135], v[140:143], v[72:75]
    v_add_f32 v15, v15, v56
    v_fma_f32 v44, v44, s40, -v12
    v_mfma_f32_16x16x32_bf16 v[72:75], a[136:139], v[144:147], v[72:75]
    v_exp_f32 v43, v43
    v_mfma_f32_16x16x32_bf16 v[72:75], a[140:143], v[148:151], v[72:75]
    v_exp_f32 v59, v59
    v_mfma_f32_16x16x32_bf16 v[76:79], a[120:123], v[152:155], 0
    v_fma_f32 v60, v60, s40, -v13
    v_add_f32 v14, v14, v41
    v_mfma_f32_16x16x32_bf16 v[76:79], a[124:127], v[156:159], v[76:79]
    v_add_f32 v15, v15, v57
    v_fma_f32 v45, v45, s40, -v12
    v_mfma_f32_16x16x32_bf16 v[76:79], a[128:131], v[160:163], v[76:79]
    v_cvt_pk_bf16_f32 v90, v72, v73
    v_cvt_pk_bf16_f32 v91, v74, v75
    v_mfma_f32_16x16x32_bf16 v[76:79], a[132:135], v[164:167], v[76:79]
    v_exp_f32 v44, v44
    v_mfma_f32_16x16x32_bf16 v[76:79], a[136:139], v[168:171], v[76:79]
    v_exp_f32 v60, v60
    v_mfma_f32_16x16x32_bf16 v[76:79], a[140:143], v[172:175], v[76:79]
    v_fma_f32 v61, v61, s40, -v13
    v_add_f32 v14, v14, v42
    v_mfma_f32_16x16x32_bf16 v[64:67], a[144:147], v[128:131], 0
    ds_read_b128 v[176:179], v6 offset:0
    v_add_f32 v15, v15, v58
    v_mfma_f32_16x16x32_bf16 v[64:67], a[148:151], v[132:135], v[64:67]
    v_exp_f32 v45, v45
    v_mfma_f32_16x16x32_bf16 v[64:67], a[152:155], v[136:139], v[64:67]
    v_cvt_pk_bf16_f32 v114, v76, v77
    v_cvt_pk_bf16_f32 v115, v78, v79
    v_mfma_f32_16x16x32_bf16 v[64:67], a[156:159], v[140:143], v[64:67]
    v_exp_f32 v61, v61
    v_mfma_f32_16x16x32_bf16 v[64:67], a[160:163], v[144:147], v[64:67]
    v_fma_f32 v46, v46, s40, -v12
    v_fma_f32 v62, v62, s40, -v13
    v_mfma_f32_16x16x32_bf16 v[64:67], a[164:167], v[148:151], v[64:67]
    ds_read_b128 v[180:183], v7 offset:0
    v_add_f32 v14, v14, v43
    v_mfma_f32_16x16x32_bf16 v[68:71], a[144:147], v[152:155], 0
    v_add_f32 v15, v15, v59
    v_fma_f32 v47, v47, s40, -v12
    v_mfma_f32_16x16x32_bf16 v[68:71], a[148:151], v[156:159], v[68:71]
    v_exp_f32 v46, v46
    v_mfma_f32_16x16x32_bf16 v[68:71], a[152:155], v[160:163], v[68:71]
    v_cvt_pk_bf16_f32 v92, v64, v65
    v_cvt_pk_bf16_f32 v93, v66, v67
    v_mfma_f32_16x16x32_bf16 v[68:71], a[156:159], v[164:167], v[68:71]
    v_exp_f32 v62, v62
    v_mfma_f32_16x16x32_bf16 v[68:71], a[160:163], v[168:171], v[68:71]
    ds_read_b128 v[184:187], v6 offset:128
    v_fma_f32 v63, v63, s40, -v13
    v_mfma_f32_16x16x32_bf16 v[68:71], a[164:167], v[172:175], v[68:71]
    v_add_f32 v14, v14, v44
    v_add_f32 v15, v15, v60
    v_mfma_f32_16x16x32_bf16 v[72:75], a[168:171], v[128:131], 0
    v_exp_f32 v47, v47
    v_mfma_f32_16x16x32_bf16 v[72:75], a[172:175], v[132:135], v[72:75]
    v_exp_f32 v63, v63
    v_mfma_f32_16x16x32_bf16 v[72:75], a[176:179], v[136:139], v[72:75]
    v_cvt_pk_bf16_f32 v116, v68, v69
    v_cvt_pk_bf16_f32 v117, v70, v71
    v_mfma_f32_16x16x32_bf16 v[72:75], a[180:183], v[140:143], v[72:75]
    ds_read_b128 v[188:191], v7 offset:128
    v_add_f32 v14, v14, v45
    v_mfma_f32_16x16x32_bf16 v[72:75], a[184:187], v[144:147], v[72:75]
    v_add_f32 v15, v15, v61
    v_add_f32 v14, v14, v46
    v_mfma_f32_16x16x32_bf16 v[72:75], a[188:191], v[148:151], v[72:75]
    v_add_f32 v15, v15, v62
    v_add_f32 v14, v14, v47
    v_mfma_f32_16x16x32_bf16 v[76:79], a[168:171], v[152:155], 0
    v_add_f32 v15, v15, v63
    v_mfma_f32_16x16x32_bf16 v[76:79], a[172:175], v[156:159], v[76:79]
    v_mfma_f32_16x16x32_bf16 v[76:79], a[176:179], v[160:163], v[76:79]
    ds_read_b128 v[192:195], v6 offset:256
    v_cvt_pk_bf16_f32 v94, v72, v73
    v_mfma_f32_16x16x32_bf16 v[76:79], a[180:183], v[164:167], v[76:79]
    v_cvt_pk_bf16_f32 v95, v74, v75
    v_permlane16_swap_b32 v14, v15
    v_mfma_f32_16x16x32_bf16 v[76:79], a[184:187], v[168:171], v[76:79]
    v_add_f32 v14, v14, v15
    v_mov_b32 v15, v14
    v_mfma_f32_16x16x32_bf16 v[76:79], a[188:191], v[172:175], v[76:79]
    v_mfma_f32_16x16x32_bf16 v[64:67], a[192:195], v[128:131], 0
    v_permlane32_swap_b32 v14, v15
    v_add_f32 v14, v14, v15
    v_mfma_f32_16x16x32_bf16 v[64:67], a[196:199], v[132:135], v[64:67]
    ds_read_b128 v[196:199], v7 offset:256
    v_mfma_f32_16x16x32_bf16 v[64:67], a[200:203], v[136:139], v[64:67]
    v_cvt_pk_bf16_f32 v118, v76, v77
    v_cvt_pk_bf16_f32 v119, v78, v79
    v_mfma_f32_16x16x32_bf16 v[64:67], a[204:207], v[140:143], v[64:67]
    v_rcp_f32 v14, v14
    v_mfma_f32_16x16x32_bf16 v[64:67], a[208:211], v[144:147], v[64:67]
    v_mov_b32 v15, v14
    v_mfma_f32_16x16x32_bf16 v[64:67], a[212:215], v[148:151], v[64:67]
    v_mfma_f32_16x16x32_bf16 v[68:71], a[192:195], v[152:155], 0
    ds_read_b128 v[200:203], v6 offset:6144
    v_permlane16_swap_b32 v14, v15
    v_mfma_f32_16x16x32_bf16 v[68:71], a[196:199], v[156:159], v[68:71]
    v_mul_f32 v32, v32, v14
    v_mul_f32 v33, v33, v14
    v_mfma_f32_16x16x32_bf16 v[68:71], a[200:203], v[160:163], v[68:71]
    v_cvt_pk_bf16_f32 v96, v64, v65
    v_cvt_pk_bf16_f32 v97, v66, v67
    v_mfma_f32_16x16x32_bf16 v[68:71], a[204:207], v[164:167], v[68:71]
    v_mul_f32 v40, v40, v14
    v_mul_f32 v41, v41, v14
    v_mfma_f32_16x16x32_bf16 v[68:71], a[208:211], v[168:171], v[68:71]
    v_mul_f32 v48, v48, v15
    v_mul_f32 v49, v49, v15
    v_mfma_f32_16x16x32_bf16 v[68:71], a[212:215], v[172:175], v[68:71]
    ds_read_b128 v[204:207], v7 offset:6144
    v_mul_f32 v56, v56, v15
    v_mfma_f32_16x16x32_bf16 v[72:75], a[216:219], v[128:131], 0
    v_mul_f32 v57, v57, v15
    v_cvt_pk_bf16_f32 v32, v32, v33
    v_mfma_f32_16x16x32_bf16 v[72:75], a[220:223], v[132:135], v[72:75]
    v_mul_f32 v34, v34, v14
    v_mul_f32 v35, v35, v14
    v_mfma_f32_16x16x32_bf16 v[72:75], a[224:227], v[136:139], v[72:75]
    v_cvt_pk_bf16_f32 v120, v68, v69
    v_cvt_pk_bf16_f32 v121, v70, v71
    v_mfma_f32_16x16x32_bf16 v[72:75], a[228:231], v[140:143], v[72:75]
    v_cvt_pk_bf16_f32 v40, v40, v41
    v_mul_f32 v42, v42, v14
    v_mfma_f32_16x16x32_bf16 v[72:75], a[232:235], v[144:147], v[72:75]
    ds_read_b128 v[208:211], v6 offset:6272
    v_mul_f32 v43, v43, v14
    v_mfma_f32_16x16x32_bf16 v[72:75], a[236:239], v[148:151], v[72:75]
    v_cvt_pk_bf16_f32 v48, v48, v49
    v_mul_f32 v50, v50, v15
    v_mfma_f32_16x16x32_bf16 v[76:79], a[216:219], v[152:155], 0
    v_mul_f32 v51, v51, v15
    v_cvt_pk_bf16_f32 v56, v56, v57
    v_mfma_f32_16x16x32_bf16 v[76:79], a[220:223], v[156:159], v[76:79]
    v_mul_f32 v58, v58, v15
    v_mul_f32 v59, v59, v15
    v_mfma_f32_16x16x32_bf16 v[76:79], a[224:227], v[160:163], v[76:79]
    v_cvt_pk_bf16_f32 v98, v72, v73
    v_cvt_pk_bf16_f32 v99, v74, v75
    v_mfma_f32_16x16x32_bf16 v[76:79], a[228:231], v[164:167], v[76:79]
    ds_read_b128 v[212:215], v7 offset:6272
    v_cvt_pk_bf16_f32 v33, v34, v35
    v_mfma_f32_16x16x32_bf16 v[76:79], a[232:235], v[168:171], v[76:79]
    v_mul_f32 v36, v36, v14
    v_mul_f32 v37, v37, v14
    v_mfma_f32_16x16x32_bf16 v[76:79], a[236:239], v[172:175], v[76:79]
    v_mul_f32 v38, v38, v14
    v_mul_f32 v39, v39, v14
    v_mfma_f32_16x16x32_bf16 v[64:67], a[240:243], v[128:131], 0
    v_cvt_pk_bf16_f32 v41, v42, v43
    v_mul_f32 v44, v44, v14
    v_mfma_f32_16x16x32_bf16 v[64:67], a[244:247], v[132:135], v[64:67]
    v_mul_f32 v45, v45, v14
    v_mul_f32 v46, v46, v14
    v_mfma_f32_16x16x32_bf16 v[64:67], a[248:251], v[136:139], v[64:67]
    ds_read_b128 v[216:219], v6 offset:6400
    v_cvt_pk_bf16_f32 v122, v76, v77
    v_mfma_f32_16x16x32_bf16 v[64:67], a[252:255], v[140:143], v[64:67]
    v_cvt_pk_bf16_f32 v123, v78, v79
    v_mul_f32 v47, v47, v14
    v_mfma_f32_16x16x32_bf16 v[64:67], v[224:227], v[144:147], v[64:67]
    v_cvt_pk_bf16_f32 v49, v50, v51
    v_mul_f32 v52, v52, v15
    v_mfma_f32_16x16x32_bf16 v[64:67], v[228:231], v[148:151], v[64:67]
    v_mul_f32 v53, v53, v15
    v_mul_f32 v54, v54, v15
    v_mfma_f32_16x16x32_bf16 v[68:71], a[240:243], v[152:155], 0
    v_mul_f32 v55, v55, v15
    v_cvt_pk_bf16_f32 v57, v58, v59
    v_mfma_f32_16x16x32_bf16 v[68:71], a[244:247], v[156:159], v[68:71]
    ds_read_b128 v[220:223], v7 offset:6400
    v_mul_f32 v60, v60, v15
    v_mfma_f32_16x16x32_bf16 v[68:71], a[248:251], v[160:163], v[68:71]
    v_mul_f32 v61, v61, v15
    v_mul_f32 v62, v62, v15
    v_mfma_f32_16x16x32_bf16 v[68:71], a[252:255], v[164:167], v[68:71]
    v_mul_f32 v63, v63, v15
    v_cvt_pk_bf16_f32 v34, v36, v37
    v_mfma_f32_16x16x32_bf16 v[68:71], v[224:227], v[168:171], v[68:71]
    v_cvt_pk_bf16_f32 v35, v38, v39
    v_cvt_pk_bf16_f32 v42, v44, v45
    v_mfma_f32_16x16x32_bf16 v[68:71], v[228:231], v[172:175], v[68:71]
    ds_write_b128 v8, v[32:35] offset:0
    v_mfma_f32_16x16x32_bf16 v[72:75], v[232:235], v[128:131], 0
    v_cvt_pk_bf16_f32 v43, v46, v47
    v_cvt_pk_bf16_f32 v50, v52, v53
    v_mfma_f32_16x16x32_bf16 v[72:75], v[236:239], v[132:135], v[72:75]
    ds_write_b128 v9, v[40:43] offset:0
    v_mfma_f32_16x16x32_bf16 v[72:75], v[240:243], v[136:139], v[72:75]
    v_cvt_pk_bf16_f32 v51, v54, v55
    v_cvt_pk_bf16_f32 v58, v60, v61
    v_mfma_f32_16x16x32_bf16 v[72:75], v[244:247], v[140:143], v[72:75]
    ds_write_b128 v8, v[48:51] offset:2048
    v_mfma_f32_16x16x32_bf16 v[72:75], v[248:251], v[144:147], v[72:75]
    v_cvt_pk_bf16_f32 v59, v62, v63
    v_cvt_pk_bf16_f32 v100, v64, v65
    v_mfma_f32_16x16x32_bf16 v[72:75], v[252:255], v[148:151], v[72:75]
    ds_write_b128 v9, v[56:59] offset:2048
    v_mfma_f32_16x16x32_bf16 v[76:79], v[232:235], v[152:155], 0
    v_cvt_pk_bf16_f32 v101, v66, v67
    v_cvt_pk_bf16_f32 v124, v68, v69
    v_mfma_f32_16x16x32_bf16 v[76:79], v[236:239], v[156:159], v[76:79]
    v_cvt_pk_bf16_f32 v125, v70, v71
    v_mfma_f32_16x16x32_bf16 v[76:79], v[240:243], v[160:163], v[76:79]
    v_cvt_pk_bf16_f32 v102, v72, v73
    v_cvt_pk_bf16_f32 v103, v74, v75
    v_mfma_f32_16x16x32_bf16 v[76:79], v[244:247], v[164:167], v[76:79]
    v_mfma_f32_16x16x32_bf16 v[76:79], v[248:251], v[168:171], v[76:79]
    v_mfma_f32_16x16x32_bf16 v[76:79], v[252:255], v[172:175], v[76:79]
    s_waitcnt lgkmcnt(0)
    s_barrier
    s_mov_b64 vcc, 0
    s_add_u32 s48, s48, 1
    s_cmp_lg_u32 s48, 16
    s_cbranch_scc1 L_mloop
    s_branch L_fin
L_nrole:
    v_add_u32 v18, 0, v0
    v_mul_u32_u24 v18, 171, v18
    v_lshrrev_b32 v18, 13, v18
    s_lshl_b32 s60, s37, 2
    v_or_b32 v18, s60, v18
    v_lshlrev_b32 v18, 4, v18
    v_xor_b32 v18, v18, v1
    s_mul_i32 s60, s37, 196608
    v_add_u32 v8, s60, v18
    v_add_u32 v18, 64, v0
    v_mul_u32_u24 v18, 171, v18
    v_lshrrev_b32 v18, 13, v18
    s_lshl_b32 s60, s37, 2
    v_or_b32 v18, s60, v18
    v_lshlrev_b32 v18, 4, v18
    v_xor_b32 v18, v18, v1
    s_mul_i32 s60, s37, 196608
    v_add_u32 v9, s60, v18
    v_add_u32 v18, 128, v0
    v_mul_u32_u24 v18, 171, v18
    v_lshrrev_b32 v18, 13, v18
    s_lshl_b32 s60, s37, 2
    v_or_b32 v18, s60, v18
    v_lshlrev_b32 v18, 4, v18
    v_xor_b32 v18, v18, v1
    s_mul_i32 s60, s37, 196608
    v_add_u32 v10, s60, v18
    s_mul_i32 s42, s37, 3072
    s_mov_b32 s10, 100663296
    s_mov_b32 s11, 0x00020000
    s_waitcnt lgkmcnt(0)
    s_mov_b32 s8, s4
    s_mov_b32 s9, s5
    s_mov_b32 s52, s50
    s_mov_b32 s53, s51
    s_add_u32 m0, s42, 0
    s_add_u32 s46, s38, 0
    buffer_load_dwordx4 v8, s[8:11], s46 offen offset:0 nt lds
    buffer_load_dwordx4 v9, s[8:11], s46 offen offset:1024 nt lds
    buffer_load_dwordx4 v10, s[8:11], s46 offen offset:2048 nt lds
    s_add_u32 m0, s42, 6144
    s_add_u32 s46, s38, 393216
    buffer_load_dwordx4 v8, s[8:11], s46 offen offset:0 nt lds
    buffer_load_dwordx4 v9, s[8:11], s46 offen offset:1024 nt lds
    buffer_load_dwordx4 v10, s[8:11], s46 offen offset:2048 nt lds
    s_add_u32 m0, s42, 12288
    s_add_u32 s46, s38, 786432
    buffer_load_dwordx4 v8, s[8:11], s46 offen offset:0 nt lds
    buffer_load_dwordx4 v9, s[8:11], s46 offen offset:1024 nt lds
    buffer_load_dwordx4 v10, s[8:11], s46 offen offset:2048 nt lds
    s_add_u32 m0, s42, 18432
    s_add_u32 s46, s38, 1179648
    buffer_load_dwordx4 v8, s[8:11], s46 offen offset:0 nt lds
    buffer_load_dwordx4 v9, s[8:11], s46 offen offset:1024 nt lds
    buffer_load_dwordx4 v10, s[8:11], s46 offen offset:2048 nt lds
    v_lshrrev_b32 v18, 1, v16
    v_xor_b32 v18, v18, v17
    v_lshlrev_b32 v18, 4, v18
    v_mul_u32_u24 v19, 384, v16
    v_add_u32 v2, v18, v19
    v_xor_b32 v3, 64, v2
    v_lshrrev_b32 v18, 5, v0
    v_mul_u32_u24 v18, 196608, v18
    v_and_b32 v19, 1, v17
    v_mul_u32_u24 v19, 1536, v19
    v_lshlrev_b32 v20, 3, v16
    v_add3_u32 v12, v18, v19, v20
    s_lshl_b32 s60, s37, 7
    v_add_u32 v12, s60, v12
    v_lshrrev_b32 v18, 3, v16
    v_mul_u32_u24 v18, 196608, v18
    v_and_b32 v19, 7, v16
    v_mul_u32_u24 v19, 384, v19
    v_lshlrev_b32 v20, 4, v17
    v_add3_u32 v21, v18, v19, v20
    s_lshl_b32 s60, s37, 6
    s_add_u32 s60, s60, 256
    v_add_u32 v16, s60, v21
    v_add_u32 v13, 393216, v12
    v_add_u32 v17, 393216, v16
    v_add_u32 v14, 786432, v12
    v_add_u32 v18, 786432, v16
    v_add_u32 v15, 1179648, v12
    v_add_u32 v19, 1179648, v16
    v_add_u32 v6, 98304, v1
    v_mov_b32 v4, v2
    v_mov_b32 v5, v3
    s_mov_b32 s12, s6
    s_mov_b32 s13, s7
    s_mov_b32 s14, 100663296
    s_mov_b32 s15, 0x00020000
    s_mov_b32 s41, 0
    s_mov_b32 s44, 100663296
    s_mov_b32 s45, s38
    s_add_u32 s43, s38, 18874368
    s_mov_b32 s48, 0
    s_getpc_b64 s[56:57]
L_pc:
    s_sub_u32 s56, s56, L_pc-L_mloop
    s_subb_u32 s57, s57, 0
    s_mov_b32 s58, L_codeend-L_mloop
    s_mov_b32 s59, 0x00020000
    s_lshr_b32 s60, s2, 3
    s_and_b32 s60, s60, 7
    s_lshl_b32 s60, s60, 1
    s_add_u32 s60, s60, s37
    s_lshl_b32 s60, s60, 10
    buffer_load_dwordx4 v[28:31], v1, s[56:59], s60 offen
    s_waitcnt vmcnt(1)
    s_barrier
    s_add_u32 m0, s42, 24576
    s_add_u32 s46, s38, 6291456
    buffer_load_dwordx4 v8, s[8:11], s46 offen offset:0 nt lds
    buffer_load_dwordx4 v9, s[8:11], s46 offen offset:1024 nt lds
    buffer_load_dwordx4 v10, s[8:11], s46 offen offset:2048 nt lds
    s_add_u32 m0, s42, 30720
    s_add_u32 s46, s38, 6684672
    buffer_load_dwordx4 v8, s[8:11], s46 offen offset:0 nt lds
    buffer_load_dwordx4 v9, s[8:11], s46 offen offset:1024 nt lds
    buffer_load_dwordx4 v10, s[8:11], s46 offen offset:2048 nt lds
    s_add_u32 m0, s42, 36864
    s_add_u32 s46, s38, 7077888
    buffer_load_dwordx4 v8, s[8:11], s46 offen offset:0 nt lds
    buffer_load_dwordx4 v9, s[8:11], s46 offen offset:1024 nt lds
    buffer_load_dwordx4 v10, s[8:11], s46 offen offset:2048 nt lds
    s_add_u32 m0, s42, 43008
    s_add_u32 s46, s38, 7471104
    buffer_load_dwordx4 v8, s[8:11], s46 offen offset:0 nt lds
    buffer_load_dwordx4 v9, s[8:11], s46 offen offset:1024 nt lds
    buffer_load_dwordx4 v10, s[8:11], s46 offen offset:2048 nt lds
    s_mul_i32 s61, s37, 36864
    s_add_u32 s61, s61, 73728
    buffer_load_dwordx4 a[0:3], v1, s[52:55], s61 offen offset:0
    buffer_load_dwordx4 a[4:7], v1, s[52:55], s61 offen offset:1024
    buffer_load_dwordx4 a[8:11], v1, s[52:55], s61 offen offset:2048
    buffer_load_dwordx4 a[12:15], v1, s[52:55], s61 offen offset:3072
    s_add_u32 s61, s61, 4096
    buffer_load_dwordx4 a[16:19], v1, s[52:55], s61 offen offset:0
    buffer_load_dwordx4 a[20:23], v1, s[52:55], s61 offen offset:1024
    buffer_load_dwordx4 a[24:27], v1, s[52:55], s61 offen offset:2048
    buffer_load_dwordx4 a[28:31], v1, s[52:55], s61 offen offset:3072
    s_add_u32 s61, s61, 4096
    buffer_load_dwordx4 a[32:35], v1, s[52:55], s61 offen offset:0
    buffer_load_dwordx4 a[36:39], v1, s[52:55], s61 offen offset:1024
    buffer_load_dwordx4 a[40:43], v1, s[52:55], s61 offen offset:2048
    buffer_load_dwordx4 a[44:47], v1, s[52:55], s61 offen offset:3072
    s_add_u32 s61, s61, 4096
    buffer_load_dwordx4 a[48:51], v1, s[52:55], s61 offen offset:0
    buffer_load_dwordx4 a[52:55], v1, s[52:55], s61 offen offset:1024
    buffer_load_dwordx4 a[56:59], v1, s[52:55], s61 offen offset:2048
    buffer_load_dwordx4 a[60:63], v1, s[52:55], s61 offen offset:3072
    s_add_u32 s61, s61, 4096
    buffer_load_dwordx4 a[64:67], v1, s[52:55], s61 offen offset:0
    buffer_load_dwordx4 a[68:71], v1, s[52:55], s61 offen offset:1024
    buffer_load_dwordx4 a[72:75], v1, s[52:55], s61 offen offset:2048
    buffer_load_dwordx4 a[76:79], v1, s[52:55], s61 offen offset:3072
    s_add_u32 s61, s61, 4096
    buffer_load_dwordx4 a[80:83], v1, s[52:55], s61 offen offset:0
    buffer_load_dwordx4 a[84:87], v1, s[52:55], s61 offen offset:1024
    buffer_load_dwordx4 a[88:91], v1, s[52:55], s61 offen offset:2048
    buffer_load_dwordx4 a[92:95], v1, s[52:55], s61 offen offset:3072
    s_add_u32 s61, s61, 4096
    buffer_load_dwordx4 a[96:99], v1, s[52:55], s61 offen offset:0
    buffer_load_dwordx4 a[100:103], v1, s[52:55], s61 offen offset:1024
    buffer_load_dwordx4 a[104:107], v1, s[52:55], s61 offen offset:2048
    buffer_load_dwordx4 a[108:111], v1, s[52:55], s61 offen offset:3072
    s_add_u32 s61, s61, 4096
    buffer_load_dwordx4 a[112:115], v1, s[52:55], s61 offen offset:0
    buffer_load_dwordx4 a[116:119], v1, s[52:55], s61 offen offset:1024
    buffer_load_dwordx4 a[120:123], v1, s[52:55], s61 offen offset:2048
    buffer_load_dwordx4 a[124:127], v1, s[52:55], s61 offen offset:3072
    s_add_u32 s61, s61, 4096
    buffer_load_dwordx4 a[128:131], v1, s[52:55], s61 offen offset:0
    buffer_load_dwordx4 a[132:135], v1, s[52:55], s61 offen offset:1024
    buffer_load_dwordx4 a[136:139], v1, s[52:55], s61 offen offset:2048
    buffer_load_dwordx4 a[140:143], v1, s[52:55], s61 offen offset:3072
    s_add_u32 m0, s42, 49152
    s_add_u32 s46, s38, 12582912
    buffer_load_dwordx4 v8, s[8:11], s46 offen offset:0 nt lds
    buffer_load_dwordx4 v9, s[8:11], s46 offen offset:1024 nt lds
    buffer_load_dwordx4 v10, s[8:11], s46 offen offset:2048 nt lds
    s_add_u32 m0, s42, 55296
    s_add_u32 s46, s38, 12976128
    buffer_load_dwordx4 v8, s[8:11], s46 offen offset:0 nt lds
    buffer_load_dwordx4 v9, s[8:11], s46 offen offset:1024 nt lds
    buffer_load_dwordx4 v10, s[8:11], s46 offen offset:2048 nt lds
    s_add_u32 m0, s42, 61440
    s_add_u32 s46, s38, 13369344
    buffer_load_dwordx4 v8, s[8:11], s46 offen offset:0 nt lds
    buffer_load_dwordx4 v9, s[8:11], s46 offen offset:1024 nt lds
    buffer_load_dwordx4 v10, s[8:11], s46 offen offset:2048 nt lds
    s_add_u32 m0, s42, 67584
    s_add_u32 s46, s38, 13762560
    buffer_load_dwordx4 v8, s[8:11], s46 offen offset:0 nt lds
    buffer_load_dwordx4 v9, s[8:11], s46 offen offset:1024 nt lds
    buffer_load_dwordx4 v10, s[8:11], s46 offen offset:2048 nt lds
    s_waitcnt vmcnt(48)
    s_mov_b32 s36, s42
    s_add_u32 s42, s42, 73728
    s_barrier
    s_mov_b64 vcc, -1
    .p2align 6
L_nloop:
    v_mfma_f32_16x16x32_bf16 v[120:123], a[144:147], a[120:123], 0
    ds_read_b128 v[88:91], v6 offset:0
    v_mfma_f32_16x16x32_bf16 v[120:123], a[148:151], a[124:127], v[120:123]
    ds_read_b128 v[92:95], v6 offset:1024
    v_cvt_pk_bf16_f32 v78, v148, v149
    v_mfma_f32_16x16x32_bf16 v[120:123], a[152:155], a[128:131], v[120:123]
    ds_read_b128 v[96:99], v6 offset:2048
    s_add_u32 m0, s42, 0
    v_mfma_f32_16x16x32_bf16 v[120:123], a[156:159], a[132:135], v[120:123]
    ds_read_b128 v[100:103], v6 offset:3072
    s_add_u32 s46, s43, 0
    v_mfma_f32_16x16x32_bf16 v[120:123], a[160:163], a[136:139], v[120:123]
    buffer_load_dwordx4 v8, s[8:11], s46 offen offset:0 nt lds
    v_mfma_f32_16x16x32_bf16 v[120:123], a[164:167], a[140:143], v[120:123]
    ds_read_b128 v[104:107], v6 offset:4096
    v_cvt_pk_bf16_f32 v79, v150, v151
    v_mfma_f32_16x16x32_bf16 v[124:127], a[168:171], a[120:123], 0
    ds_read_b128 v[108:111], v6 offset:5120
    v_mfma_f32_16x16x32_bf16 v[124:127], a[172:175], a[124:127], v[124:127]
    ds_read_b128 v[112:115], v6 offset:6144
    v_mfma_f32_16x16x32_bf16 v[124:127], a[176:179], a[128:131], v[124:127]
    ds_read_b128 v[116:119], v6 offset:7168
    v_cvt_pk_bf16_f32 v80, v120, v121
    v_mfma_f32_16x16x32_bf16 v[124:127], a[180:183], a[132:135], v[124:127]
    v_cvt_pk_bf16_f32 v81, v122, v123
    v_xor_b32 v6, 8192, v6
    v_mfma_f32_16x16x32_bf16 v[124:127], a[184:187], a[136:139], v[124:127]
    ds_read_b128 a[144:147], v4 offset:0
    v_mfma_f32_16x16x32_bf16 v[124:127], a[188:191], a[140:143], v[124:127]
    ds_read_b128 a[148:151], v5 offset:0
    v_mfma_f32_16x16x32_bf16 v[128:131], a[192:195], a[120:123], 0
    ds_read_b128 a[152:155], v4 offset:128
    v_mfma_f32_16x16x32_bf16 v[128:131], a[196:199], a[124:127], v[128:131]
    ds_read_b128 a[156:159], v5 offset:128
    v_mfma_f32_16x16x32_bf16 v[128:131], a[200:203], a[128:131], v[128:131]
    v_cvt_pk_bf16_f32 v82, v124, v125
    v_cvt_pk_bf16_f32 v83, v126, v127
    v_mfma_f32_16x16x32_bf16 v[128:131], a[204:207], a[132:135], v[128:131]
    ds_read_b128 a[160:163], v4 offset:256
    v_mfma_f32_16x16x32_bf16 v[128:131], a[208:211], a[136:139], v[128:131]
    ds_read_b128 a[164:167], v5 offset:256
    v_mfma_f32_16x16x32_bf16 v[128:131], a[212:215], a[140:143], v[128:131]
    ds_read_b128 a[168:171], v4 offset:6144
    v_mfma_f32_16x16x32_bf16 v[132:135], a[216:219], a[120:123], 0
    ds_read_b128 a[172:175], v5 offset:6144
    v_mfma_f32_16x16x32_bf16 v[132:135], a[220:223], a[124:127], v[132:135]
    buffer_load_dwordx4 v9, s[8:11], s46 offen offset:1024 nt lds
    v_mfma_f32_16x16x32_bf16 v[132:135], a[224:227], a[128:131], v[132:135]
    v_cvt_pk_bf16_f32 v84, v128, v129
    v_cvt_pk_bf16_f32 v85, v130, v131
    v_mfma_f32_16x16x32_bf16 v[132:135], a[228:231], a[132:135], v[132:135]
    ds_read_b128 a[176:179], v4 offset:6272
    v_mfma_f32_16x16x32_bf16 v[132:135], a[232:235], a[136:139], v[132:135]
    ds_read_b128 a[180:183], v5 offset:6272
    v_mfma_f32_16x16x32_bf16 v[132:135], a[236:239], a[140:143], v[132:135]
    ds_read_b128 a[184:187], v4 offset:6400
    s_waitcnt lgkmcnt(10)
    v_mfma_f32_16x16x32_bf16 v[152:155], v[88:91], v[40:43], 0
    ds_read_b128 a[188:191], v5 offset:6400
    v_mfma_f32_16x16x32_bf16 v[152:155], v[92:95], v[44:47], v[152:155]
    ds_read_b128 a[192:195], v4 offset:12288
    v_mfma_f32_16x16x32_bf16 v[156:159], v[88:91], v[48:51], 0
    v_cvt_pk_bf16_f32 v86, v132, v133
    v_cvt_pk_bf16_f32 v87, v134, v135
    v_mfma_f32_16x16x32_bf16 v[156:159], v[92:95], v[52:55], v[156:159]
    ds_read_b128 a[196:199], v5 offset:12288
    v_mfma_f32_16x16x32_bf16 v[160:163], v[88:91], v[56:59], 0
    ds_read_b128 a[200:203], v4 offset:12416
    v_mfma_f32_16x16x32_bf16 v[160:163], v[92:95], v[60:63], v[160:163]
    ds_read_b128 a[204:207], v5 offset:12416
    v_mfma_f32_16x16x32_bf16 v[164:167], v[88:91], v[64:67], 0
    v_cvt_pk_bf16_f32 v200, v152, v156
    v_cvt_pk_bf16_f32 v202, v153, v157
    v_mfma_f32_16x16x32_bf16 v[164:167], v[92:95], v[68:71], v[164:167]
    v_cvt_pk_bf16_f32 v204, v154, v158
    v_cvt_pk_bf16_f32 v206, v155, v159
    v_mfma_f32_16x16x32_bf16 v[168:171], v[72:75], v[88:91], 0
    ds_read_b128 a[208:211], v4 offset:12544
    v_mfma_f32_16x16x32_bf16 v[168:171], v[76:79], v[92:95], v[168:171]
    ds_read_b128 a[212:215], v5 offset:12544
    v_mfma_f32_16x16x32_bf16 v[172:175], v[80:83], v[88:91], 0
    v_cvt_pk_bf16_f32 v201, v160, v164
    v_cvt_pk_bf16_f32 v203, v161, v165
    v_mfma_f32_16x16x32_bf16 v[172:175], v[84:87], v[92:95], v[172:175]
    buffer_load_dwordx4 v10, s[8:11], s46 offen offset:2048 nt lds
    v_mfma_f32_16x16x32_bf16 v[176:179], v[96:99], v[40:43], 0
    v_cvt_pk_bf16_f32 v205, v162, v166
    v_cvt_pk_bf16_f32 v207, v163, v167
    v_mfma_f32_16x16x32_bf16 v[176:179], v[100:103], v[44:47], v[176:179]
    ds_read_b128 a[216:219], v4 offset:18432
    v_cvt_pk_bf16_f32 v208, v168, v169
    v_mfma_f32_16x16x32_bf16 v[180:183], v[96:99], v[48:51], 0
    ds_read_b128 a[220:223], v5 offset:18432
    v_cvt_pk_bf16_f32 v209, v170, v171
    v_mfma_f32_16x16x32_bf16 v[180:183], v[100:103], v[52:55], v[180:183]
    ds_read_b128 a[224:227], v4 offset:18560
    v_cvt_pk_bf16_f32 v210, v172, v173
    v_mfma_f32_16x16x32_bf16 v[184:187], v[96:99], v[56:59], 0
    buffer_store_dwordx2 v[200:201], v12, s[12:15], s44 offen offset:0 sc1
    v_mfma_f32_16x16x32_bf16 v[184:187], v[100:103], v[60:63], v[184:187]
    ds_read_b128 a[228:231], v5 offset:18560
    v_cvt_pk_bf16_f32 v211, v174, v175
    v_mfma_f32_16x16x32_bf16 v[188:191], v[96:99], v[64:67], 0
    ds_read_b128 a[232:235], v4 offset:18688
    v_cvt_pk_bf16_f32 v212, v176, v180
    v_mfma_f32_16x16x32_bf16 v[188:191], v[100:103], v[68:71], v[188:191]
    ds_read_b128 a[236:239], v5 offset:18688
    v_cvt_pk_bf16_f32 v214, v177, v181
    v_mfma_f32_16x16x32_bf16 v[192:195], v[72:75], v[96:99], 0
    v_cvt_pk_bf16_f32 v216, v178, v182
    v_cvt_pk_bf16_f32 v218, v179, v183
    v_mfma_f32_16x16x32_bf16 v[192:195], v[76:79], v[100:103], v[192:195]
    v_mfma_f32_16x16x32_bf16 v[196:199], v[80:83], v[96:99], 0
    v_cvt_pk_bf16_f32 v213, v184, v188
    v_cvt_pk_bf16_f32 v215, v185, v189
    v_mfma_f32_16x16x32_bf16 v[196:199], v[84:87], v[100:103], v[196:199]
    buffer_store_dwordx2 v[202:203], v12, s[12:15], s44 offen offset:384 sc1
    v_mfma_f32_16x16x32_bf16 v[152:155], v[104:107], v[40:43], 0
    s_add_u32 m0, s42, 6144
    s_add_u32 s46, s43, 393216
    v_mfma_f32_16x16x32_bf16 v[152:155], v[108:111], v[44:47], v[152:155]
    v_cvt_pk_bf16_f32 v217, v186, v190
    v_cvt_pk_bf16_f32 v219, v187, v191
    v_mfma_f32_16x16x32_bf16 v[156:159], v[104:107], v[48:51], 0
    buffer_load_dwordx4 v8, s[8:11], s46 offen offset:0 nt lds
    v_mfma_f32_16x16x32_bf16 v[156:159], v[108:111], v[52:55], v[156:159]
    v_cvt_pk_bf16_f32 v220, v192, v193
    v_cvt_pk_bf16_f32 v221, v194, v195
    v_mfma_f32_16x16x32_bf16 v[160:163], v[104:107], v[56:59], 0
    v_cvt_pk_bf16_f32 v222, v196, v197
    v_cvt_pk_bf16_f32 v223, v198, v199
    v_mfma_f32_16x16x32_bf16 v[160:163], v[108:111], v[60:63], v[160:163]
    v_mfma_f32_16x16x32_bf16 v[164:167], v[104:107], v[64:67], 0
    v_cvt_pk_bf16_f32 v224, v152, v156
    v_cvt_pk_bf16_f32 v226, v153, v157
    v_mfma_f32_16x16x32_bf16 v[164:167], v[108:111], v[68:71], v[164:167]
    buffer_store_dwordx2 v[204:205], v12, s[12:15], s44 offen offset:768 sc1
    v_mfma_f32_16x16x32_bf16 v[168:171], v[72:75], v[104:107], 0
    v_cvt_pk_bf16_f32 v228, v154, v158
    v_cvt_pk_bf16_f32 v230, v155, v159
    v_mfma_f32_16x16x32_bf16 v[168:171], v[76:79], v[108:111], v[168:171]
    v_mfma_f32_16x16x32_bf16 v[172:175], v[80:83], v[104:107], 0
    v_cvt_pk_bf16_f32 v225, v160, v164
    v_cvt_pk_bf16_f32 v227, v161, v165
    v_mfma_f32_16x16x32_bf16 v[172:175], v[84:87], v[108:111], v[172:175]
    v_cvt_pk_bf16_f32 v229, v162, v166
    v_cvt_pk_bf16_f32 v231, v163, v167
    v_mfma_f32_16x16x32_bf16 v[176:179], v[112:115], v[40:43], 0
    v_cvt_pk_bf16_f32 v232, v168, v169
    v_cvt_pk_bf16_f32 v233, v170, v171
    v_mfma_f32_16x16x32_bf16 v[176:179], v[116:119], v[44:47], v[176:179]
    v_mfma_f32_16x16x32_bf16 v[180:183], v[112:115], v[48:51], 0
    buffer_store_dwordx2 v[206:207], v12, s[12:15], s44 offen offset:1152 sc1
    v_mfma_f32_16x16x32_bf16 v[180:183], v[116:119], v[52:55], v[180:183]
    v_cvt_pk_bf16_f32 v234, v172, v173
    v_cvt_pk_bf16_f32 v235, v174, v175
    v_mfma_f32_16x16x32_bf16 v[184:187], v[112:115], v[56:59], 0
    v_mfma_f32_16x16x32_bf16 v[184:187], v[116:119], v[60:63], v[184:187]
    v_mfma_f32_16x16x32_bf16 v[188:191], v[112:115], v[64:67], 0
    buffer_load_dwordx4 v9, s[8:11], s46 offen offset:1024 nt lds
    v_mfma_f32_16x16x32_bf16 v[188:191], v[116:119], v[68:71], v[188:191]
    v_cvt_pk_bf16_f32 v236, v176, v180
    v_cvt_pk_bf16_f32 v238, v177, v181
    v_mfma_f32_16x16x32_bf16 v[192:195], v[72:75], v[112:115], 0
    s_cbranch_vccnz L_nw
L_nw_back:
    v_cvt_pk_bf16_f32 v240, v178, v182
    v_mfma_f32_16x16x32_bf16 v[192:195], v[76:79], v[116:119], v[192:195]
    v_cvt_pk_bf16_f32 v242, v179, v183
    v_mfma_f32_16x16x32_bf16 v[196:199], v[80:83], v[112:115], 0
    buffer_store_dwordx4 v[208:211], v16, s[12:15], s44 offen sc1
    v_mfma_f32_16x16x32_bf16 v[196:199], v[84:87], v[116:119], v[196:199]
    v_cvt_pk_bf16_f32 v237, v184, v188
    v_cvt_pk_bf16_f32 v239, v185, v189
    v_mfma_f32_16x16x32_bf16 v[136:139], a[144:147], a[0:3], 0
    v_cvt_pk_bf16_f32 v241, v186, v190
    s_waitcnt lgkmcnt(0)
    v_mfma_f32_16x16x32_bf16 v[136:139], a[148:151], a[4:7], v[136:139]
    v_cvt_pk_bf16_f32 v243, v187, v191
    v_cvt_pk_bf16_f32 v244, v192, v193
    v_mfma_f32_16x16x32_bf16 v[136:139], a[152:155], a[8:11], v[136:139]
    v_cvt_pk_bf16_f32 v245, v194, v195
    v_cvt_pk_bf16_f32 v246, v196, v197
    v_mfma_f32_16x16x32_bf16 v[136:139], a[156:159], a[12:15], v[136:139]
    v_cvt_pk_bf16_f32 v247, v198, v199
    s_cmp_eq_u32 s48, 16
    s_cbranch_scc1 L_nepi
    v_mfma_f32_16x16x32_bf16 v[136:139], a[160:163], a[16:19], v[136:139]
    v_mfma_f32_16x16x32_bf16 v[136:139], a[164:167], a[20:23], v[136:139]
    v_mfma_f32_16x16x32_bf16 v[140:143], a[168:171], a[0:3], 0
    buffer_store_dwordx2 v[212:213], v13, s[12:15], s44 offen offset:0 sc1
    v_mfma_f32_16x16x32_bf16 v[140:143], a[172:175], a[4:7], v[140:143]
    v_mfma_f32_16x16x32_bf16 v[140:143], a[176:179], a[8:11], v[140:143]
    v_cvt_pk_bf16_f32 v40, v136, v137
    v_cvt_pk_bf16_f32 v41, v138, v139
    v_mfma_f32_16x16x32_bf16 v[140:143], a[180:183], a[12:15], v[140:143]
    buffer_load_dwordx4 v10, s[8:11], s46 offen offset:2048 nt lds
    v_mfma_f32_16x16x32_bf16 v[140:143], a[184:187], a[16:19], v[140:143]
    v_mfma_f32_16x16x32_bf16 v[140:143], a[188:191], a[20:23], v[140:143]
    v_mfma_f32_16x16x32_bf16 v[144:147], a[192:195], a[0:3], 0
    v_mfma_f32_16x16x32_bf16 v[144:147], a[196:199], a[4:7], v[144:147]
    buffer_store_dwordx2 v[214:215], v13, s[12:15], s44 offen offset:384 sc1
    v_mfma_f32_16x16x32_bf16 v[144:147], a[200:203], a[8:11], v[144:147]
    v_cvt_pk_bf16_f32 v42, v140, v141
    v_cvt_pk_bf16_f32 v43, v142, v143
    v_mfma_f32_16x16x32_bf16 v[144:147], a[204:207], a[12:15], v[144:147]
    v_mfma_f32_16x16x32_bf16 v[144:147], a[208:211], a[16:19], v[144:147]
    v_mfma_f32_16x16x32_bf16 v[144:147], a[212:215], a[20:23], v[144:147]
    v_mfma_f32_16x16x32_bf16 v[148:151], a[216:219], a[0:3], 0
    v_mfma_f32_16x16x32_bf16 v[148:151], a[220:223], a[4:7], v[148:151]
    v_mfma_f32_16x16x32_bf16 v[148:151], a[224:227], a[8:11], v[148:151]
    v_cvt_pk_bf16_f32 v44, v144, v145
    v_cvt_pk_bf16_f32 v45, v146, v147
    v_mfma_f32_16x16x32_bf16 v[148:151], a[228:231], a[12:15], v[148:151]
    buffer_store_dwordx2 v[216:217], v13, s[12:15], s44 offen offset:768 sc1
    v_mfma_f32_16x16x32_bf16 v[148:151], a[232:235], a[16:19], v[148:151]
    v_mfma_f32_16x16x32_bf16 v[148:151], a[236:239], a[20:23], v[148:151]
    s_add_u32 m0, s42, 12288
    s_add_u32 s46, s43, 786432
    v_mfma_f32_16x16x32_bf16 v[120:123], a[144:147], a[24:27], 0
    v_mfma_f32_16x16x32_bf16 v[120:123], a[148:151], a[28:31], v[120:123]
    buffer_load_dwordx4 v8, s[8:11], s46 offen offset:0 nt lds
    v_mfma_f32_16x16x32_bf16 v[120:123], a[152:155], a[32:35], v[120:123]
    v_cvt_pk_bf16_f32 v46, v148, v149
    v_cvt_pk_bf16_f32 v47, v150, v151
    v_mfma_f32_16x16x32_bf16 v[120:123], a[156:159], a[36:39], v[120:123]
    v_mfma_f32_16x16x32_bf16 v[120:123], a[160:163], a[40:43], v[120:123]
    buffer_store_dwordx2 v[218:219], v13, s[12:15], s44 offen offset:1152 sc1
    v_mfma_f32_16x16x32_bf16 v[120:123], a[164:167], a[44:47], v[120:123]
    s_add_u32 s41, s41, 24576
    s_cmp_ge_u32 s41, 98304
    s_cselect_b32 s56, 98304, 0
    s_sub_u32 s41, s41, s56
    v_add_u32 v4, s41, v2
    v_mfma_f32_16x16x32_bf16 v[124:127], a[168:171], a[24:27], 0
    v_add_u32 v5, s41, v3
    v_mfma_f32_16x16x32_bf16 v[124:127], a[172:175], a[28:31], v[124:127]
    v_mfma_f32_16x16x32_bf16 v[124:127], a[176:179], a[32:35], v[124:127]
    v_cvt_pk_bf16_f32 v48, v120, v121
    v_cvt_pk_bf16_f32 v49, v122, v123
    v_mfma_f32_16x16x32_bf16 v[124:127], a[180:183], a[36:39], v[124:127]
    v_mfma_f32_16x16x32_bf16 v[124:127], a[184:187], a[40:43], v[124:127]
    v_mfma_f32_16x16x32_bf16 v[124:127], a[188:191], a[44:47], v[124:127]
    v_mfma_f32_16x16x32_bf16 v[128:131], a[192:195], a[24:27], 0
    buffer_store_dwordx4 v[220:223], v17, s[12:15], s44 offen sc1
    v_mfma_f32_16x16x32_bf16 v[128:131], a[196:199], a[28:31], v[128:131]
    v_mfma_f32_16x16x32_bf16 v[128:131], a[200:203], a[32:35], v[128:131]
    v_cvt_pk_bf16_f32 v50, v124, v125
    v_cvt_pk_bf16_f32 v51, v126, v127
    v_mfma_f32_16x16x32_bf16 v[128:131], a[204:207], a[36:39], v[128:131]
    v_mfma_f32_16x16x32_bf16 v[128:131], a[208:211], a[40:43], v[128:131]
    buffer_load_dwordx4 v9, s[8:11], s46 offen offset:1024 nt lds
    v_mfma_f32_16x16x32_bf16 v[128:131], a[212:215], a[44:47], v[128:131]
    v_mfma_f32_16x16x32_bf16 v[132:135], a[216:219], a[24:27], 0
    v_mfma_f32_16x16x32_bf16 v[132:135], a[220:223], a[28:31], v[132:135]
    v_mfma_f32_16x16x32_bf16 v[132:135], a[224:227], a[32:35], v[132:135]
    buffer_store_dwordx2 v[224:225], v14, s[12:15], s44 offen offset:0 sc1
    v_mfma_f32_16x16x32_bf16 v[132:135], a[228:231], a[36:39], v[132:135]
    v_cvt_pk_bf16_f32 v52, v128, v129
    v_cvt_pk_bf16_f32 v53, v130, v131
    v_mfma_f32_16x16x32_bf16 v[132:135], a[232:235], a[40:43], v[132:135]
    v_mfma_f32_16x16x32_bf16 v[132:135], a[236:239], a[44:47], v[132:135]
    v_mfma_f32_16x16x32_bf16 v[136:139], a[144:147], a[48:51], 0
    v_mfma_f32_16x16x32_bf16 v[136:139], a[148:151], a[52:55], v[136:139]
    v_mfma_f32_16x16x32_bf16 v[136:139], a[152:155], a[56:59], v[136:139]
    v_cvt_pk_bf16_f32 v54, v132, v133
    v_cvt_pk_bf16_f32 v55, v134, v135
    v_mfma_f32_16x16x32_bf16 v[136:139], a[156:159], a[60:63], v[136:139]
    buffer_store_dwordx2 v[226:227], v14, s[12:15], s44 offen offset:384 sc1
    v_mfma_f32_16x16x32_bf16 v[136:139], a[160:163], a[64:67], v[136:139]
    v_mfma_f32_16x16x32_bf16 v[136:139], a[164:167], a[68:71], v[136:139]
    v_mfma_f32_16x16x32_bf16 v[140:143], a[168:171], a[48:51], 0
    v_mfma_f32_16x16x32_bf16 v[140:143], a[172:175], a[52:55], v[140:143]
    v_mfma_f32_16x16x32_bf16 v[140:143], a[176:179], a[56:59], v[140:143]
    buffer_load_dwordx4 v10, s[8:11], s46 offen offset:2048 nt lds
    v_mfma_f32_16x16x32_bf16 v[140:143], a[180:183], a[60:63], v[140:143]
    v_cvt_pk_bf16_f32 v56, v136, v137
    v_cvt_pk_bf16_f32 v57, v138, v139
    v_mfma_f32_16x16x32_bf16 v[140:143], a[184:187], a[64:67], v[140:143]
    v_mfma_f32_16x16x32_bf16 v[140:143], a[188:191], a[68:71], v[140:143]
    buffer_store_dwordx2 v[228:229], v14, s[12:15], s44 offen offset:768 sc1
    v_mfma_f32_16x16x32_bf16 v[144:147], a[192:195], a[48:51], 0
    v_mfma_f32_16x16x32_bf16 v[144:147], a[196:199], a[52:55], v[144:147]
    v_mfma_f32_16x16x32_bf16 v[144:147], a[200:203], a[56:59], v[144:147]
    v_cvt_pk_bf16_f32 v58, v140, v141
    v_cvt_pk_bf16_f32 v59, v142, v143
    v_mfma_f32_16x16x32_bf16 v[144:147], a[204:207], a[60:63], v[144:147]
    v_mfma_f32_16x16x32_bf16 v[144:147], a[208:211], a[64:67], v[144:147]
    v_mfma_f32_16x16x32_bf16 v[144:147], a[212:215], a[68:71], v[144:147]
    v_mfma_f32_16x16x32_bf16 v[148:151], a[216:219], a[48:51], 0
    buffer_store_dwordx2 v[230:231], v14, s[12:15], s44 offen offset:1152 sc1
    v_mfma_f32_16x16x32_bf16 v[148:151], a[220:223], a[52:55], v[148:151]
    v_mfma_f32_16x16x32_bf16 v[148:151], a[224:227], a[56:59], v[148:151]
    v_cvt_pk_bf16_f32 v60, v144, v145
    v_cvt_pk_bf16_f32 v61, v146, v147
    v_mfma_f32_16x16x32_bf16 v[148:151], a[228:231], a[60:63], v[148:151]
    s_add_u32 m0, s42, 18432
    s_add_u32 s46, s43, 1179648
    v_mfma_f32_16x16x32_bf16 v[148:151], a[232:235], a[64:67], v[148:151]
    v_mfma_f32_16x16x32_bf16 v[148:151], a[236:239], a[68:71], v[148:151]
    buffer_load_dwordx4 v8, s[8:11], s46 offen offset:0 nt lds
    v_mfma_f32_16x16x32_bf16 v[120:123], a[144:147], a[72:75], 0
    v_mfma_f32_16x16x32_bf16 v[120:123], a[148:151], a[76:79], v[120:123]
    v_mfma_f32_16x16x32_bf16 v[120:123], a[152:155], a[80:83], v[120:123]
    buffer_store_dwordx4 v[232:235], v18, s[12:15], s44 offen sc1
    v_mfma_f32_16x16x32_bf16 v[120:123], a[156:159], a[84:87], v[120:123]
    v_cvt_pk_bf16_f32 v62, v148, v149
    v_cvt_pk_bf16_f32 v63, v150, v151
    v_mfma_f32_16x16x32_bf16 v[120:123], a[160:163], a[88:91], v[120:123]
    v_mfma_f32_16x16x32_bf16 v[120:123], a[164:167], a[92:95], v[120:123]
    v_mfma_f32_16x16x32_bf16 v[124:127], a[168:171], a[72:75], 0
    v_mfma_f32_16x16x32_bf16 v[124:127], a[172:175], a[76:79], v[124:127]
    v_mfma_f32_16x16x32_bf16 v[124:127], a[176:179], a[80:83], v[124:127]
    v_cvt_pk_bf16_f32 v64, v120, v121
    v_cvt_pk_bf16_f32 v65, v122, v123
    v_mfma_f32_16x16x32_bf16 v[124:127], a[180:183], a[84:87], v[124:127]
    v_mfma_f32_16x16x32_bf16 v[124:127], a[184:187], a[88:91], v[124:127]
    buffer_store_dwordx2 v[236:237], v15, s[12:15], s44 offen offset:0 sc1
    v_mfma_f32_16x16x32_bf16 v[124:127], a[188:191], a[92:95], v[124:127]
    v_mfma_f32_16x16x32_bf16 v[128:131], a[192:195], a[72:75], 0
    v_mfma_f32_16x16x32_bf16 v[128:131], a[196:199], a[76:79], v[128:131]
    v_mfma_f32_16x16x32_bf16 v[128:131], a[200:203], a[80:83], v[128:131]
    v_cvt_pk_bf16_f32 v66, v124, v125
    v_cvt_pk_bf16_f32 v67, v126, v127
    v_mfma_f32_16x16x32_bf16 v[128:131], a[204:207], a[84:87], v[128:131]
    buffer_load_dwordx4 v9, s[8:11], s46 offen offset:1024 nt lds
    v_mfma_f32_16x16x32_bf16 v[128:131], a[208:211], a[88:91], v[128:131]
    v_mfma_f32_16x16x32_bf16 v[128:131], a[212:215], a[92:95], v[128:131]
    buffer_store_dwordx2 v[238:239], v15, s[12:15], s44 offen offset:384 sc1
    v_mfma_f32_16x16x32_bf16 v[132:135], a[216:219], a[72:75], 0
    s_add_u32 s42, s42, 24576
    s_cmp_ge_u32 s42, 98304
    s_cselect_b32 s57, 98304, 0
    s_sub_u32 s42, s42, s57
    s_add_u32 s43, s43, 6291456
    v_mfma_f32_16x16x32_bf16 v[132:135], a[220:223], a[76:79], v[132:135]
    v_mfma_f32_16x16x32_bf16 v[132:135], a[224:227], a[80:83], v[132:135]
    v_cvt_pk_bf16_f32 v68, v128, v129
    v_cvt_pk_bf16_f32 v69, v130, v131
    v_mfma_f32_16x16x32_bf16 v[132:135], a[228:231], a[84:87], v[132:135]
    v_mfma_f32_16x16x32_bf16 v[132:135], a[232:235], a[88:91], v[132:135]
    v_mfma_f32_16x16x32_bf16 v[132:135], a[236:239], a[92:95], v[132:135]
    v_mfma_f32_16x16x32_bf16 v[136:139], a[144:147], a[96:99], 0
    v_mfma_f32_16x16x32_bf16 v[136:139], a[148:151], a[100:103], v[136:139]
    buffer_store_dwordx2 v[240:241], v15, s[12:15], s44 offen offset:768 sc1
    v_mfma_f32_16x16x32_bf16 v[136:139], a[152:155], a[104:107], v[136:139]
    v_cvt_pk_bf16_f32 v70, v132, v133
    v_cvt_pk_bf16_f32 v71, v134, v135
    v_mfma_f32_16x16x32_bf16 v[136:139], a[156:159], a[108:111], v[136:139]
    v_mfma_f32_16x16x32_bf16 v[136:139], a[160:163], a[112:115], v[136:139]
    v_mfma_f32_16x16x32_bf16 v[136:139], a[164:167], a[116:119], v[136:139]
    v_mfma_f32_16x16x32_bf16 v[140:143], a[168:171], a[96:99], 0
    buffer_load_dwordx4 v10, s[8:11], s46 offen offset:2048 nt lds
    v_mfma_f32_16x16x32_bf16 v[140:143], a[172:175], a[100:103], v[140:143]
    v_mfma_f32_16x16x32_bf16 v[140:143], a[176:179], a[104:107], v[140:143]
    buffer_store_dwordx2 v[242:243], v15, s[12:15], s44 offen offset:1152 sc1
    v_mfma_f32_16x16x32_bf16 v[140:143], a[180:183], a[108:111], v[140:143]
    v_cvt_pk_bf16_f32 v72, v136, v137
    v_cvt_pk_bf16_f32 v73, v138, v139
    v_mfma_f32_16x16x32_bf16 v[140:143], a[184:187], a[112:115], v[140:143]
    v_mfma_f32_16x16x32_bf16 v[140:143], a[188:191], a[116:119], v[140:143]
    v_mfma_f32_16x16x32_bf16 v[144:147], a[192:195], a[96:99], 0
    v_mfma_f32_16x16x32_bf16 v[144:147], a[196:199], a[100:103], v[144:147]
    v_mfma_f32_16x16x32_bf16 v[144:147], a[200:203], a[104:107], v[144:147]
    v_cvt_pk_bf16_f32 v74, v140, v141
    v_cvt_pk_bf16_f32 v75, v142, v143
    v_mfma_f32_16x16x32_bf16 v[144:147], a[204:207], a[108:111], v[144:147]
    v_mfma_f32_16x16x32_bf16 v[144:147], a[208:211], a[112:115], v[144:147]
    buffer_store_dwordx4 v[244:247], v19, s[12:15], s44 offen sc1
    v_mfma_f32_16x16x32_bf16 v[144:147], a[212:215], a[116:119], v[144:147]
    s_nop 0
    s_mov_b32 s44, s45
    s_add_u32 s45, s45, 6291456
    v_mfma_f32_16x16x32_bf16 v[148:151], a[216:219], a[96:99], 0
    v_mfma_f32_16x16x32_bf16 v[148:151], a[220:223], a[100:103], v[148:151]
    v_mfma_f32_16x16x32_bf16 v[148:151], a[224:227], a[104:107], v[148:151]
    v_cvt_pk_bf16_f32 v76, v144, v145
    v_cvt_pk_bf16_f32 v77, v146, v147
    v_mfma_f32_16x16x32_bf16 v[148:151], a[228:231], a[108:111], v[148:151]
    v_mfma_f32_16x16x32_bf16 v[148:151], a[232:235], a[112:115], v[148:151]
    v_mfma_f32_16x16x32_bf16 v[148:151], a[236:239], a[116:119], v[148:151]
    s_waitcnt vmcnt(32)
    s_barrier
    s_add_u32 s48, s48, 1
    s_branch L_nloop
L_nw:
    s_waitcnt vmcnt(21)
    s_mov_b64 vcc, 0
    s_branch L_nw_back
L_nepi:
    buffer_store_dwordx2 v[212:213], v13, s[12:15], s44 offen offset:0 sc1
    buffer_store_dwordx2 v[214:215], v13, s[12:15], s44 offen offset:384 sc1
    buffer_store_dwordx2 v[216:217], v13, s[12:15], s44 offen offset:768 sc1
    buffer_store_dwordx2 v[218:219], v13, s[12:15], s44 offen offset:1152 sc1
    buffer_store_dwordx4 v[220:223], v17, s[12:15], s44 offen sc1
    buffer_store_dwordx2 v[224:225], v14, s[12:15], s44 offen offset:0 sc1
    buffer_store_dwordx2 v[226:227], v14, s[12:15], s44 offen offset:384 sc1
    buffer_store_dwordx2 v[228:229], v14, s[12:15], s44 offen offset:768 sc1
    buffer_store_dwordx2 v[230:231], v14, s[12:15], s44 offen offset:1152 sc1
    buffer_store_dwordx4 v[232:235], v18, s[12:15], s44 offen sc1
    buffer_store_dwordx2 v[236:237], v15, s[12:15], s44 offen offset:0 sc1
    buffer_store_dwordx2 v[238:239], v15, s[12:15], s44 offen offset:384 sc1
    buffer_store_dwordx2 v[240:241], v15, s[12:15], s44 offen offset:768 sc1
    buffer_store_dwordx2 v[242:243], v15, s[12:15], s44 offen offset:1152 sc1
    buffer_store_dwordx4 v[244:247], v19, s[12:15], s44 offen sc1
L_fin:
L_end:
    s_endpgm
L_codeend:
.section .rodata,"a"
.p2align 6
.amdhsa_kernel swin_prep_kernel
  .amdhsa_next_free_vgpr 136
  .amdhsa_next_free_sgpr 40
  .amdhsa_accum_offset 136
  .amdhsa_group_segment_fixed_size 0
  .amdhsa_kernarg_size 48
  .amdhsa_user_sgpr_count 2
  .amdhsa_user_sgpr_kernarg_segment_ptr 1
  .amdhsa_system_sgpr_workgroup_id_x 1
.end_amdhsa_kernel
.p2align 6
.amdhsa_kernel standalone__swin_window_attn__vision_kernel
  .amdhsa_next_free_vgpr 512
  .amdhsa_next_free_sgpr 100
  .amdhsa_accum_offset 256
  .amdhsa_group_segment_fixed_size 0
  .amdhsa_kernarg_size 48
  .amdhsa_user_sgpr_count 2
  .amdhsa_user_sgpr_kernarg_segment_ptr 1
  .amdhsa_system_sgpr_workgroup_id_x 1
.end_amdhsa_kernel
```

```asm
; @launch kernel=swin_prep_kernel grid=(144,1,1) block=(64,1,1) lds=6144
; @launch kernel=standalone__swin_window_attn__vision_kernel grid=(256,1,1) block=(256,1,1) lds=114752
.amdgcn_target "amdgcn-amd-amdhsa--gfx950"
.text
.globl swin_prep_kernel
.p2align 8
.type swin_prep_kernel,@function
swin_prep_kernel:
    s_cmp_ge_u32 s2, 144
    s_cbranch_scc1 L_prep_end
    s_load_dwordx4 s[4:7], s[0:1], 8
    s_load_dwordx2 s[8:9], s[0:1], 40
    v_and_b32 v1, 15, v0
    v_lshrrev_b32 v2, 4, v0
    v_lshrrev_b32 v3, 2, v1
    v_lshlrev_b32 v3, 3, v3
    v_and_b32 v4, 3, v1
    v_add_u32 v3, v3, v4
    s_cmp_ge_u32 s2, 72
    s_cselect_b32 s20, 1, 0
    s_cselect_b32 s21, 72, 0
    s_sub_u32 s21, s2, s21
    s_mul_i32 s22, s21, 43
    s_lshr_b32 s22, s22, 8
    s_mul_i32 s23, s22, 6
    s_sub_u32 s23, s21, s23
    s_waitcnt lgkmcnt(0)
    s_mov_b32 s12, s4
    s_mov_b32 s13, s5
    s_mov_b32 s14, 221184
    s_mov_b32 s15, 0x00020000
    s_mov_b32 s16, s6
    s_mov_b32 s17, s7
    s_mov_b32 s18, 73728
    s_mov_b32 s19, 0x00020000
    s_mov_b32 s24, s8
    s_mov_b32 s25, s9
    s_mov_b32 s26, 149504
    s_mov_b32 s27, 0x00020000
    s_lshl_b32 s28, s23, 5
    v_add_u32 v6, s28, v3
    s_movk_i32 s29, 1152
    v_mul_lo_u32 v6, v6, s29
    v_lshl_add_u32 v6, v2, 4, v6
    s_mul_i32 s30, s20, 768
    v_add_u32 v6, s30, v6
    v_add_u32 v7, 4608, v6
    buffer_load_dwordx4 v[16:19], v6, s[12:15], 0 offen offset:0
    buffer_load_dwordx4 v[40:43], v7, s[12:15], 0 offen offset:0
    buffer_load_dwordx4 v[20:23], v6, s[12:15], 0 offen offset:64
    buffer_load_dwordx4 v[44:47], v7, s[12:15], 0 offen offset:64
    buffer_load_dwordx4 v[24:27], v6, s[12:15], 0 offen offset:128
    buffer_load_dwordx4 v[48:51], v7, s[12:15], 0 offen offset:128
    buffer_load_dwordx4 v[28:31], v6, s[12:15], 0 offen offset:192
    buffer_load_dwordx4 v[52:55], v7, s[12:15], 0 offen offset:192
    buffer_load_dwordx4 v[32:35], v6, s[12:15], 0 offen offset:256
    buffer_load_dwordx4 v[56:59], v7, s[12:15], 0 offen offset:256
    buffer_load_dwordx4 v[36:39], v6, s[12:15], 0 offen offset:320
    buffer_load_dwordx4 v[60:63], v7, s[12:15], 0 offen offset:320
    s_cmp_eq_u32 s20, 1
    s_cbranch_scc1 L_prep_N
    s_lshr_b32 s28, s22, 1
    s_lshl_b32 s28, s28, 5
    s_and_b32 s31, s22, 1
    s_lshl_b32 s31, s31, 2
    s_add_u32 s28, s28, s31
    v_add_u32 v8, s28, v3
    v_mul_lo_u32 v8, v8, s29
    v_lshl_add_u32 v8, v2, 4, v8
    buffer_load_dwordx4 v[64:67], v8, s[12:15], 0 offen offset:384
    buffer_load_dwordx4 v[68:71], v8, s[12:15], 0 offen offset:448
    buffer_load_dwordx4 v[72:75], v8, s[12:15], 0 offen offset:512
    buffer_load_dwordx4 v[76:79], v8, s[12:15], 0 offen offset:576
    buffer_load_dwordx4 v[80:83], v8, s[12:15], 0 offen offset:640
    buffer_load_dwordx4 v[84:87], v8, s[12:15], 0 offen offset:704
    s_lshl_b32 s28, s21, 10
    v_lshlrev_b32 v9, 4, v0
    s_branch L_prep_mm
L_prep_N:
    v_lshrrev_b32 v8, 1, v0
    v_mul_u32_u24 v8, 384, v8
    v_and_b32 v9, 1, v0
    v_lshl_add_u32 v8, v9, 4, v8
    s_lshl_b32 s28, s22, 5
    s_mov_b32 m0, 0
    s_add_u32 s34, s28, 0
    buffer_load_dwordx4 v8, s[16:19], s34 offen lds
    s_mov_b32 m0, 1024
    s_add_u32 s34, s28, 12288
    buffer_load_dwordx4 v8, s[16:19], s34 offen lds
    s_mov_b32 m0, 2048
    s_add_u32 s34, s28, 24576
    buffer_load_dwordx4 v8, s[16:19], s34 offen lds
    s_mov_b32 m0, 3072
    s_add_u32 s34, s28, 36864
    buffer_load_dwordx4 v8, s[16:19], s34 offen lds
    s_mov_b32 m0, 4096
    s_add_u32 s34, s28, 49152
    buffer_load_dwordx4 v8, s[16:19], s34 offen lds
    s_mov_b32 m0, 5120
    s_add_u32 s34, s28, 61440
    buffer_load_dwordx4 v8, s[16:19], s34 offen lds
    v_lshlrev_b32 v8, 3, v2
    v_lshrrev_b32 v9, 2, v0
    v_and_b32 v9, 3, v9
    v_add_u32 v8, v8, v9
    v_lshlrev_b32 v8, 5, v8
    v_and_b32 v10, 3, v0
    v_lshl_add_u32 v8, v10, 3, v8
    s_waitcnt vmcnt(0)
    ds_read_b64_tr_b16 v[64:65], v8 offset:0
    ds_read_b64_tr_b16 v[66:67], v8 offset:128
    ds_read_b64_tr_b16 v[68:69], v8 offset:1024
    ds_read_b64_tr_b16 v[70:71], v8 offset:1152
    ds_read_b64_tr_b16 v[72:73], v8 offset:2048
    ds_read_b64_tr_b16 v[74:75], v8 offset:2176
    ds_read_b64_tr_b16 v[76:77], v8 offset:3072
    ds_read_b64_tr_b16 v[78:79], v8 offset:3200
    ds_read_b64_tr_b16 v[80:81], v8 offset:4096
    ds_read_b64_tr_b16 v[82:83], v8 offset:4224
    ds_read_b64_tr_b16 v[84:85], v8 offset:5120
    ds_read_b64_tr_b16 v[86:87], v8 offset:5248
    v_and_b32 v9, 3, v1
    v_lshlrev_b32 v10, 8, v2
    v_lshrrev_b32 v11, 2, v1
    s_lshl_b32 s33, s23, 10
    s_add_u32 s33, s33, 73728
    s_cmp_ge_u32 s22, 8
    s_cbranch_scc1 L_prep_N2
    v_mul_u32_u24 v9, 6144, v9
    v_lshlrev_b32 v11, 4, v11
    v_add3_u32 v9, v9, v10, v11
    s_lshr_b32 s28, s22, 2
    s_mul_i32 s28, s28, 36864
    s_and_b32 s34, s22, 3
    s_lshl_b32 s34, s34, 6
    s_branch L_prep_N3
L_prep_N2:
    v_lshlrev_b32 v9, 4, v9
    v_and_b32 v12, 1, v11
    v_mul_u32_u24 v12, 6144, v12
    v_lshrrev_b32 v11, 3, v1
    v_lshlrev_b32 v11, 6, v11
    v_add3_u32 v9, v9, v10, v11
    v_add_u32 v9, v9, v12
    s_sub_u32 s34, s22, 8
    s_lshr_b32 s28, s34, 1
    s_mul_i32 s28, s28, 36864
    s_add_u32 s28, s28, 24576
    s_and_b32 s34, s34, 1
    s_lshl_b32 s34, s34, 7
L_prep_N3:
    s_add_u32 s28, s28, s34
    s_add_u32 s28, s28, s33
    s_waitcnt lgkmcnt(0)
L_prep_mm:
    s_waitcnt vmcnt(0)
    v_mfma_f32_16x16x32_bf16 v[112:115], v[16:19], v[64:67], 0
    v_mfma_f32_16x16x32_bf16 v[116:119], v[40:43], v[64:67], 0
    v_mfma_f32_16x16x32_bf16 v[112:115], v[20:23], v[68:71], v[112:115]
    v_mfma_f32_16x16x32_bf16 v[116:119], v[44:47], v[68:71], v[116:119]
    v_mfma_f32_16x16x32_bf16 v[112:115], v[24:27], v[72:75], v[112:115]
    v_mfma_f32_16x16x32_bf16 v[116:119], v[48:51], v[72:75], v[116:119]
    v_mfma_f32_16x16x32_bf16 v[112:115], v[28:31], v[76:79], v[112:115]
    v_mfma_f32_16x16x32_bf16 v[116:119], v[52:55], v[76:79], v[116:119]
    v_mfma_f32_16x16x32_bf16 v[112:115], v[32:35], v[80:83], v[112:115]
    v_mfma_f32_16x16x32_bf16 v[116:119], v[56:59], v[80:83], v[116:119]
    v_mfma_f32_16x16x32_bf16 v[112:115], v[36:39], v[84:87], v[112:115]
    v_mfma_f32_16x16x32_bf16 v[116:119], v[60:63], v[84:87], v[116:119]
    s_nop 15
    v_cvt_pk_bf16_f32 v128, v112, v113
    v_cvt_pk_bf16_f32 v129, v114, v115
    v_cvt_pk_bf16_f32 v130, v116, v117
    v_cvt_pk_bf16_f32 v131, v118, v119
    buffer_store_dwordx4 v[128:131], v9, s[24:27], s28 offen
    s_cmp_lg_u32 s2, 143
    s_cbranch_scc1 L_prep_end
    v_lshlrev_b32 v9, 5, v0
    v_mov_b32 v10, 0
    s_mov_b32 s28, 147456
    buffer_store_dword v10, v9, s[24:27], s28 offen
L_prep_end:
    s_endpgm
.globl standalone__swin_window_attn__vision_kernel
.p2align 8
.type standalone__swin_window_attn__vision_kernel,@function
standalone__swin_window_attn__vision_kernel:
    s_cmp_ge_u32 s2, 256
    s_cbranch_scc1 L_end
    s_load_dwordx2 s[4:5], s[0:1], 0
    s_load_dwordx2 s[6:7], s[0:1], 24
    s_load_dwordx2 s[50:51], s[0:1], 40
    v_lshrrev_b32 v16, 6, v0
    v_and_b32 v0, 63, v0
    s_lshr_b32 s53, s2, 6
    v_readfirstlane_b32 s49, v16
    v_lshlrev_b32 v1, 4, v0
    v_and_b32 v16, 15, v0
    v_lshrrev_b32 v17, 4, v0
    s_mul_i32 s53, s53, 1572864
    s_and_b32 s54, s2, 63
    s_mul_i32 s54, s54, 3072
    s_add_u32 s38, s53, s54
    s_and_b32 s37, s49, 1
    s_mov_b32 s54, 147456
    s_mov_b32 s55, 0x00020000
    s_cmp_ge_u32 s49, 2
    s_cbranch_scc1 L_nrole
    s_waitcnt lgkmcnt(0)
    s_mov_b32 s52, s50
    s_mov_b32 s53, s51
    s_mov_b32 s60, 0
    buffer_load_dwordx4 a[0:3], v1, s[52:55], s60 offen offset:0
    buffer_load_dwordx4 a[4:7], v1, s[52:55], s60 offen offset:1024
    buffer_load_dwordx4 a[8:11], v1, s[52:55], s60 offen offset:2048
    buffer_load_dwordx4 a[12:15], v1, s[52:55], s60 offen offset:3072
    s_mov_b32 s60, 4096
    buffer_load_dwordx4 a[16:19], v1, s[52:55], s60 offen offset:0
    buffer_load_dwordx4 a[20:23], v1, s[52:55], s60 offen offset:1024
    buffer_load_dwordx4 a[24:27], v1, s[52:55], s60 offen offset:2048
    buffer_load_dwordx4 a[28:31], v1, s[52:55], s60 offen offset:3072
    s_mov_b32 s60, 8192
    buffer_load_dwordx4 a[32:35], v1, s[52:55], s60 offen offset:0
    buffer_load_dwordx4 a[36:39], v1, s[52:55], s60 offen offset:1024
    buffer_load_dwordx4 a[40:43], v1, s[52:55], s60 offen offset:2048
    buffer_load_dwordx4 a[44:47], v1, s[52:55], s60 offen offset:3072
    s_mov_b32 s60, 12288
    buffer_load_dwordx4 a[48:51], v1, s[52:55], s60 offen offset:0
    buffer_load_dwordx4 a[52:55], v1, s[52:55], s60 offen offset:1024
    buffer_load_dwordx4 a[56:59], v1, s[52:55], s60 offen offset:2048
    buffer_load_dwordx4 a[60:63], v1, s[52:55], s60 offen offset:3072
    s_mov_b32 s60, 16384
    buffer_load_dwordx4 a[64:67], v1, s[52:55], s60 offen offset:0
    buffer_load_dwordx4 a[68:71], v1, s[52:55], s60 offen offset:1024
    buffer_load_dwordx4 a[72:75], v1, s[52:55], s60 offen offset:2048
    buffer_load_dwordx4 a[76:79], v1, s[52:55], s60 offen offset:3072
    s_mov_b32 s60, 20480
    buffer_load_dwordx4 a[80:83], v1, s[52:55], s60 offen offset:0
    buffer_load_dwordx4 a[84:87], v1, s[52:55], s60 offen offset:1024
    buffer_load_dwordx4 a[88:91], v1, s[52:55], s60 offen offset:2048
    buffer_load_dwordx4 a[92:95], v1, s[52:55], s60 offen offset:3072
    s_mov_b32 s60, 24576
    buffer_load_dwordx4 a[96:99], v1, s[52:55], s60 offen offset:0
    buffer_load_dwordx4 a[100:103], v1, s[52:55], s60 offen offset:1024
    buffer_load_dwordx4 a[104:107], v1, s[52:55], s60 offen offset:2048
    buffer_load_dwordx4 a[108:111], v1, s[52:55], s60 offen offset:3072
    s_mov_b32 s60, 28672
    buffer_load_dwordx4 a[112:115], v1, s[52:55], s60 offen offset:0
    buffer_load_dwordx4 a[116:119], v1, s[52:55], s60 offen offset:1024
    buffer_load_dwordx4 a[120:123], v1, s[52:55], s60 offen offset:2048
    buffer_load_dwordx4 a[124:127], v1, s[52:55], s60 offen offset:3072
    s_mov_b32 s60, 32768
    buffer_load_dwordx4 a[128:131], v1, s[52:55], s60 offen offset:0
    buffer_load_dwordx4 a[132:135], v1, s[52:55], s60 offen offset:1024
    buffer_load_dwordx4 a[136:139], v1, s[52:55], s60 offen offset:2048
    buffer_load_dwordx4 a[140:143], v1, s[52:55], s60 offen offset:3072
    s_mov_b32 s60, 36864
    buffer_load_dwordx4 a[144:147], v1, s[52:55], s60 offen offset:0
    buffer_load_dwordx4 a[148:151], v1, s[52:55], s60 offen offset:1024
    buffer_load_dwordx4 a[152:155], v1, s[52:55], s60 offen offset:2048
    buffer_load_dwordx4 a[156:159], v1, s[52:55], s60 offen offset:3072
    s_mov_b32 s60, 40960
    buffer_load_dwordx4 a[160:163], v1, s[52:55], s60 offen offset:0
    buffer_load_dwordx4 a[164:167], v1, s[52:55], s60 offen offset:1024
    buffer_load_dwordx4 a[168:171], v1, s[52:55], s60 offen offset:2048
    buffer_load_dwordx4 a[172:175], v1, s[52:55], s60 offen offset:3072
    s_mov_b32 s60, 45056
    buffer_load_dwordx4 a[176:179], v1, s[52:55], s60 offen offset:0
    buffer_load_dwordx4 a[180:183], v1, s[52:55], s60 offen offset:1024
    buffer_load_dwordx4 a[184:187], v1, s[52:55], s60 offen offset:2048
    buffer_load_dwordx4 a[188:191], v1, s[52:55], s60 offen offset:3072
    s_mov_b32 s60, 49152
    buffer_load_dwordx4 a[192:195], v1, s[52:55], s60 offen offset:0
    buffer_load_dwordx4 a[196:199], v1, s[52:55], s60 offen offset:1024
    buffer_load_dwordx4 a[200:203], v1, s[52:55], s60 offen offset:2048
    buffer_load_dwordx4 a[204:207], v1, s[52:55], s60 offen offset:3072
    s_mov_b32 s60, 53248
    buffer_load_dwordx4 a[208:211], v1, s[52:55], s60 offen offset:0
    buffer_load_dwordx4 a[212:215], v1, s[52:55], s60 offen offset:1024
    buffer_load_dwordx4 a[216:219], v1, s[52:55], s60 offen offset:2048
    buffer_load_dwordx4 a[220:223], v1, s[52:55], s60 offen offset:3072
    s_mov_b32 s60, 57344
    buffer_load_dwordx4 a[224:227], v1, s[52:55], s60 offen offset:0
    buffer_load_dwordx4 a[228:231], v1, s[52:55], s60 offen offset:1024
    buffer_load_dwordx4 a[232:235], v1, s[52:55], s60 offen offset:2048
    buffer_load_dwordx4 a[236:239], v1, s[52:55], s60 offen offset:3072
    s_mov_b32 s60, 61440
    buffer_load_dwordx4 a[240:243], v1, s[52:55], s60 offen offset:0
    buffer_load_dwordx4 a[244:247], v1, s[52:55], s60 offen offset:1024
    buffer_load_dwordx4 a[248:251], v1, s[52:55], s60 offen offset:2048
    buffer_load_dwordx4 a[252:255], v1, s[52:55], s60 offen offset:3072
    s_mov_b32 s60, 65536
    buffer_load_dwordx4 v[224:227], v1, s[52:55], s60 offen offset:0
    buffer_load_dwordx4 v[228:231], v1, s[52:55], s60 offen offset:1024
    buffer_load_dwordx4 v[232:235], v1, s[52:55], s60 offen offset:2048
    buffer_load_dwordx4 v[236:239], v1, s[52:55], s60 offen offset:3072
    s_mov_b32 s60, 69632
    buffer_load_dwordx4 v[240:243], v1, s[52:55], s60 offen offset:0
    buffer_load_dwordx4 v[244:247], v1, s[52:55], s60 offen offset:1024
    buffer_load_dwordx4 v[248:251], v1, s[52:55], s60 offen offset:2048
    buffer_load_dwordx4 v[252:255], v1, s[52:55], s60 offen offset:3072
    v_lshrrev_b32 v18, 1, v16
    v_xor_b32 v18, v18, v17
    v_lshlrev_b32 v18, 4, v18
    v_mul_u32_u24 v19, 384, v16
    v_add_u32 v2, v18, v19
    v_xor_b32 v3, 64, v2
    s_mul_i32 s47, s37, 12288
    s_sub_u32 s39, 12288, s47
    s_mov_b32 s41, 73728
    s_mul_i32 s60, s37, 5120
    s_add_u32 s60, s60, 106496
    v_add_u32 v8, s60, v1
    v_xor_b32 v9, 1024, v8
    s_mov_b32 s40, 0x3dd53b95
    s_mov_b32 s48, -1
    v_mov_b32 v23, 114692
    s_mov_b32 s16, -1
    s_barrier
    .p2align 6
L_mloop:
    v_mfma_f32_16x16x32_bf16 v[32:35], v[128:131], v[80:83], 0
    ds_read_b32 v22, v23
    s_add_u32 s41, s41, 24576
    s_cmp_ge_u32 s41, 98304
    s_cselect_b32 s56, 98304, 0
    s_sub_u32 s41, s41, s56
    v_mfma_f32_16x16x32_bf16 v[32:35], v[132:135], v[84:87], v[32:35]
    v_cvt_pk_bf16_f32 v126, v76, v77
    v_cvt_pk_bf16_f32 v127, v78, v79
    v_mfma_f32_16x16x32_bf16 v[32:35], v[136:139], v[88:91], v[32:35]
    s_add_u32 s46, s41, s47
    v_add_u32 v4, s46, v2
    v_mfma_f32_16x16x32_bf16 v[32:35], v[140:143], v[92:95], v[32:35]
    v_add_u32 v5, s46, v3
    s_add_u32 s57, s41, s39
    v_mfma_f32_16x16x32_bf16 v[32:35], v[144:147], v[96:99], v[32:35]
    v_add_u32 v6, s57, v2
    v_add_u32 v7, s57, v3
    v_mfma_f32_16x16x32_bf16 v[32:35], v[148:151], v[100:103], v[32:35]
    v_xor_b32 v8, 8192, v8
    v_xor_b32 v9, 8192, v9
    v_mfma_f32_16x16x32_bf16 v[48:51], v[128:131], v[104:107], 0
    ds_read_b128 v[128:131], v4 offset:0
    v_xor_b32 v23, 4, v23
    v_mfma_f32_16x16x32_bf16 v[48:51], v[132:135], v[108:111], v[48:51]
    ds_read_b128 v[132:135], v5 offset:0
    v_mfma_f32_16x16x32_bf16 v[48:51], v[136:139], v[112:115], v[48:51]
    ds_read_b128 v[136:139], v4 offset:128
    v_max3_f32 v12, v32, v33, v34
    v_mfma_f32_16x16x32_bf16 v[48:51], v[140:143], v[116:119], v[48:51]
    ds_read_b128 v[140:143], v5 offset:128
    v_mfma_f32_16x16x32_bf16 v[48:51], v[144:147], v[120:123], v[48:51]
    ds_read_b128 v[144:147], v4 offset:256
    v_mfma_f32_16x16x32_bf16 v[48:51], v[148:151], v[124:127], v[48:51]
    ds_read_b128 v[148:151], v5 offset:256
    v_mfma_f32_16x16x32_bf16 v[36:39], v[152:155], v[80:83], 0
    v_mfma_f32_16x16x32_bf16 v[36:39], v[156:159], v[84:87], v[36:39]
    v_mfma_f32_16x16x32_bf16 v[36:39], v[160:163], v[88:91], v[36:39]
    v_max3_f32 v13, v48, v49, v50
    v_mfma_f32_16x16x32_bf16 v[36:39], v[164:167], v[92:95], v[36:39]
    v_mfma_f32_16x16x32_bf16 v[36:39], v[168:171], v[96:99], v[36:39]
    v_mfma_f32_16x16x32_bf16 v[36:39], v[172:175], v[100:103], v[36:39]
    v_mfma_f32_16x16x32_bf16 v[52:55], v[152:155], v[104:107], 0
    ds_read_b128 v[152:155], v4 offset:6144
    v_mfma_f32_16x16x32_bf16 v[52:55], v[156:159], v[108:111], v[52:55]
    ds_read_b128 v[156:159], v5 offset:6144
    v_mfma_f32_16x16x32_bf16 v[52:55], v[160:163], v[112:115], v[52:55]
    ds_read_b128 v[160:163], v4 offset:6272
    v_max3_f32 v12, v12, v35, v36
    v_mfma_f32_16x16x32_bf16 v[52:55], v[164:167], v[116:119], v[52:55]
    ds_read_b128 v[164:167], v5 offset:6272
    v_max3_f32 v12, v12, v37, v38
    v_mfma_f32_16x16x32_bf16 v[52:55], v[168:171], v[120:123], v[52:55]
    ds_read_b128 v[168:171], v4 offset:6400
    v_mfma_f32_16x16x32_bf16 v[52:55], v[172:175], v[124:127], v[52:55]
    ds_read_b128 v[172:175], v5 offset:6400
    v_mfma_f32_16x16x32_bf16 v[40:43], v[176:179], v[80:83], 0
    v_mfma_f32_16x16x32_bf16 v[40:43], v[180:183], v[84:87], v[40:43]
    v_mfma_f32_16x16x32_bf16 v[40:43], v[184:187], v[88:91], v[40:43]
    s_waitcnt lgkmcnt(6)
    v_readfirstlane_b32 s60, v22
    s_nop 0
    s_cmp_lt_i32 s60, 352
    s_addc_u32 s16, s16, s16
    v_mfma_f32_16x16x32_bf16 v[40:43], v[188:191], v[92:95], v[40:43]
    v_max3_f32 v13, v13, v51, v52
    v_max3_f32 v13, v13, v53, v54
    v_mfma_f32_16x16x32_bf16 v[40:43], v[192:195], v[96:99], v[40:43]
    v_mfma_f32_16x16x32_bf16 v[40:43], v[196:199], v[100:103], v[40:43]
    v_mfma_f32_16x16x32_bf16 v[56:59], v[176:179], v[104:107], 0
    v_mfma_f32_16x16x32_bf16 v[56:59], v[180:183], v[108:111], v[56:59]
    v_mfma_f32_16x16x32_bf16 v[56:59], v[184:187], v[112:115], v[56:59]
    v_max3_f32 v12, v12, v39, v40
    v_max3_f32 v12, v12, v41, v42
    v_mfma_f32_16x16x32_bf16 v[56:59], v[188:191], v[116:119], v[56:59]
    v_mfma_f32_16x16x32_bf16 v[56:59], v[192:195], v[120:123], v[56:59]
    v_mfma_f32_16x16x32_bf16 v[56:59], v[196:199], v[124:127], v[56:59]
    v_mfma_f32_16x16x32_bf16 v[44:47], v[200:203], v[80:83], 0
    v_mfma_f32_16x16x32_bf16 v[44:47], v[204:207], v[84:87], v[44:47]
    v_mfma_f32_16x16x32_bf16 v[44:47], v[208:211], v[88:91], v[44:47]
    v_max3_f32 v13, v13, v55, v56
    v_max3_f32 v13, v13, v57, v58
    v_mfma_f32_16x16x32_bf16 v[44:47], v[212:215], v[92:95], v[44:47]
    v_mfma_f32_16x16x32_bf16 v[44:47], v[216:219], v[96:99], v[44:47]
    v_mfma_f32_16x16x32_bf16 v[44:47], v[220:223], v[100:103], v[44:47]
    v_mfma_f32_16x16x32_bf16 v[60:63], v[200:203], v[104:107], 0
    v_mfma_f32_16x16x32_bf16 v[60:63], v[204:207], v[108:111], v[60:63]
    v_mfma_f32_16x16x32_bf16 v[60:63], v[208:211], v[112:115], v[60:63]
    s_waitcnt vmcnt(0)
    v_max3_f32 v12, v12, v43, v44
    v_mfma_f32_16x16x32_bf16 v[60:63], v[212:215], v[116:119], v[60:63]
    v_max3_f32 v12, v12, v45, v46
    v_max_f32 v12, v12, v47
    v_mfma_f32_16x16x32_bf16 v[60:63], v[216:219], v[120:123], v[60:63]
    v_mfma_f32_16x16x32_bf16 v[60:63], v[220:223], v[124:127], v[60:63]
    v_mfma_f32_16x16x32_bf16 v[64:67], a[0:3], v[128:131], 0
    v_mfma_f32_16x16x32_bf16 v[64:67], a[4:7], v[132:135], v[64:67]
    v_mfma_f32_16x16x32_bf16 v[64:67], a[8:11], v[136:139], v[64:67]
    v_max3_f32 v13, v13, v59, v60
    v_max3_f32 v13, v13, v61, v62
    v_mfma_f32_16x16x32_bf16 v[64:67], a[12:15], v[140:143], v[64:67]
    v_max_f32 v13, v13, v63
    v_mfma_f32_16x16x32_bf16 v[64:67], a[16:19], v[144:147], v[64:67]
    v_mfma_f32_16x16x32_bf16 v[64:67], a[20:23], v[148:151], v[64:67]
    v_permlane16_swap_b32 v12, v13
    s_waitcnt lgkmcnt(0)
    v_mfma_f32_16x16x32_bf16 v[68:71], a[0:3], v[152:155], 0
    v_max_f32 v12, v12, v13
    v_mov_b32 v13, v12
    v_mfma_f32_16x16x32_bf16 v[68:71], a[4:7], v[156:159], v[68:71]
    v_mfma_f32_16x16x32_bf16 v[68:71], a[8:11], v[160:163], v[68:71]
    v_cvt_pk_bf16_f32 v80, v64, v65
    v_cvt_pk_bf16_f32 v81, v66, v67
    v_mfma_f32_16x16x32_bf16 v[68:71], a[12:15], v[164:167], v[68:71]
    v_permlane32_swap_b32 v12, v13
    v_max_f32 v12, v12, v13
    v_mfma_f32_16x16x32_bf16 v[68:71], a[16:19], v[168:171], v[68:71]
    v_mul_f32 v12, s40, v12
    v_mov_b32 v13, v12
    v_mfma_f32_16x16x32_bf16 v[68:71], a[20:23], v[172:175], v[68:71]
    v_mfma_f32_16x16x32_bf16 v[72:75], a[24:27], v[128:131], 0
    v_permlane16_swap_b32 v12, v13
    v_fma_f32 v32, v32, s40, -v12
    v_mfma_f32_16x16x32_bf16 v[72:75], a[28:31], v[132:135], v[72:75]
    v_fma_f32 v48, v48, s40, -v13
    v_fma_f32 v33, v33, s40, -v12
    v_mfma_f32_16x16x32_bf16 v[72:75], a[32:35], v[136:139], v[72:75]
    v_cvt_pk_bf16_f32 v104, v68, v69
    v_cvt_pk_bf16_f32 v105, v70, v71
    v_mfma_f32_16x16x32_bf16 v[72:75], a[36:39], v[140:143], v[72:75]
    v_fma_f32 v49, v49, s40, -v13
    v_fma_f32 v34, v34, s40, -v12
    v_mfma_f32_16x16x32_bf16 v[72:75], a[40:43], v[144:147], v[72:75]
    v_exp_f32 v32, v32
    v_mfma_f32_16x16x32_bf16 v[72:75], a[44:47], v[148:151], v[72:75]
    v_exp_f32 v48, v48
    v_mfma_f32_16x16x32_bf16 v[76:79], a[24:27], v[152:155], 0
    v_exp_f32 v33, v33
    v_mfma_f32_16x16x32_bf16 v[76:79], a[28:31], v[156:159], v[76:79]
    v_exp_f32 v49, v49
    v_mfma_f32_16x16x32_bf16 v[76:79], a[32:35], v[160:163], v[76:79]
    v_cvt_pk_bf16_f32 v82, v72, v73
    v_cvt_pk_bf16_f32 v83, v74, v75
    v_mfma_f32_16x16x32_bf16 v[76:79], a[36:39], v[164:167], v[76:79]
    v_fma_f32 v50, v50, s40, -v13
    v_fma_f32 v35, v35, s40, -v12
    v_mfma_f32_16x16x32_bf16 v[76:79], a[40:43], v[168:171], v[76:79]
    v_exp_f32 v34, v34
    v_mfma_f32_16x16x32_bf16 v[76:79], a[44:47], v[172:175], v[76:79]
    v_exp_f32 v50, v50
    v_mfma_f32_16x16x32_bf16 v[64:67], a[48:51], v[128:131], 0
    v_fma_f32 v51, v51, s40, -v13
    v_fma_f32 v36, v36, s40, -v12
    v_mfma_f32_16x16x32_bf16 v[64:67], a[52:55], v[132:135], v[64:67]
    v_exp_f32 v35, v35
    v_mfma_f32_16x16x32_bf16 v[64:67], a[56:59], v[136:139], v[64:67]
    v_cvt_pk_bf16_f32 v106, v76, v77
    v_cvt_pk_bf16_f32 v107, v78, v79
    v_mfma_f32_16x16x32_bf16 v[64:67], a[60:63], v[140:143], v[64:67]
    v_exp_f32 v51, v51
    v_mfma_f32_16x16x32_bf16 v[64:67], a[64:67], v[144:147], v[64:67]
    v_fma_f32 v52, v52, s40, -v13
    v_add_f32 v14, v32, v33
    v_mfma_f32_16x16x32_bf16 v[64:67], a[68:71], v[148:151], v[64:67]
    v_add_f32 v15, v48, v49
    v_fma_f32 v37, v37, s40, -v12
    v_mfma_f32_16x16x32_bf16 v[68:71], a[48:51], v[152:155], 0
    v_exp_f32 v36, v36
    v_mfma_f32_16x16x32_bf16 v[68:71], a[52:55], v[156:159], v[68:71]
    v_exp_f32 v52, v52
    v_mfma_f32_16x16x32_bf16 v[68:71], a[56:59], v[160:163], v[68:71]
    v_cvt_pk_bf16_f32 v84, v64, v65
    v_cvt_pk_bf16_f32 v85, v66, v67
    v_mfma_f32_16x16x32_bf16 v[68:71], a[60:63], v[164:167], v[68:71]
    v_fma_f32 v53, v53, s40, -v13
    v_add_f32 v14, v14, v34
    v_mfma_f32_16x16x32_bf16 v[68:71], a[64:67], v[168:171], v[68:71]
    v_add_f32 v15, v15, v50
    v_fma_f32 v38, v38, s40, -v12
    v_mfma_f32_16x16x32_bf16 v[68:71], a[68:71], v[172:175], v[68:71]
    v_exp_f32 v37, v37
    v_mfma_f32_16x16x32_bf16 v[72:75], a[72:75], v[128:131], 0
    v_exp_f32 v53, v53
    v_mfma_f32_16x16x32_bf16 v[72:75], a[76:79], v[132:135], v[72:75]
    v_fma_f32 v54, v54, s40, -v13
    v_add_f32 v14, v14, v35
    v_mfma_f32_16x16x32_bf16 v[72:75], a[80:83], v[136:139], v[72:75]
    v_cvt_pk_bf16_f32 v108, v68, v69
    v_cvt_pk_bf16_f32 v109, v70, v71
    v_mfma_f32_16x16x32_bf16 v[72:75], a[84:87], v[140:143], v[72:75]
    v_add_f32 v15, v15, v51
    v_fma_f32 v39, v39, s40, -v12
    v_mfma_f32_16x16x32_bf16 v[72:75], a[88:91], v[144:147], v[72:75]
    v_exp_f32 v38, v38
    v_mfma_f32_16x16x32_bf16 v[72:75], a[92:95], v[148:151], v[72:75]
    v_exp_f32 v54, v54
    v_mfma_f32_16x16x32_bf16 v[76:79], a[72:75], v[152:155], 0
    v_fma_f32 v55, v55, s40, -v13
    v_add_f32 v14, v14, v36
    v_mfma_f32_16x16x32_bf16 v[76:79], a[76:79], v[156:159], v[76:79]
    v_add_f32 v15, v15, v52
    v_fma_f32 v40, v40, s40, -v12
    v_mfma_f32_16x16x32_bf16 v[76:79], a[80:83], v[160:163], v[76:79]
    v_cvt_pk_bf16_f32 v86, v72, v73
    v_cvt_pk_bf16_f32 v87, v74, v75
    v_mfma_f32_16x16x32_bf16 v[76:79], a[84:87], v[164:167], v[76:79]
    v_exp_f32 v39, v39
    v_mfma_f32_16x16x32_bf16 v[76:79], a[88:91], v[168:171], v[76:79]
    v_exp_f32 v55, v55
    v_mfma_f32_16x16x32_bf16 v[76:79], a[92:95], v[172:175], v[76:79]
    v_fma_f32 v56, v56, s40, -v13
    v_add_f32 v14, v14, v37
    v_mfma_f32_16x16x32_bf16 v[64:67], a[96:99], v[128:131], 0
    v_add_f32 v15, v15, v53
    v_fma_f32 v41, v41, s40, -v12
    v_mfma_f32_16x16x32_bf16 v[64:67], a[100:103], v[132:135], v[64:67]
    v_exp_f32 v40, v40
    v_mfma_f32_16x16x32_bf16 v[64:67], a[104:107], v[136:139], v[64:67]
    v_cvt_pk_bf16_f32 v110, v76, v77
    v_cvt_pk_bf16_f32 v111, v78, v79
    v_mfma_f32_16x16x32_bf16 v[64:67], a[108:111], v[140:143], v[64:67]
    v_exp_f32 v56, v56
    v_mfma_f32_16x16x32_bf16 v[64:67], a[112:115], v[144:147], v[64:67]
    v_fma_f32 v57, v57, s40, -v13
    v_add_f32 v14, v14, v38
    v_mfma_f32_16x16x32_bf16 v[64:67], a[116:119], v[148:151], v[64:67]
    v_add_f32 v15, v15, v54
    v_fma_f32 v42, v42, s40, -v12
    v_mfma_f32_16x16x32_bf16 v[68:71], a[96:99], v[152:155], 0
    v_exp_f32 v41, v41
    v_mfma_f32_16x16x32_bf16 v[68:71], a[100:103], v[156:159], v[68:71]
    v_exp_f32 v57, v57
    v_mfma_f32_16x16x32_bf16 v[68:71], a[104:107], v[160:163], v[68:71]
    v_cvt_pk_bf16_f32 v88, v64, v65
    v_cvt_pk_bf16_f32 v89, v66, v67
    v_mfma_f32_16x16x32_bf16 v[68:71], a[108:111], v[164:167], v[68:71]
    v_fma_f32 v58, v58, s40, -v13
    v_add_f32 v14, v14, v39
    v_mfma_f32_16x16x32_bf16 v[68:71], a[112:115], v[168:171], v[68:71]
    v_add_f32 v15, v15, v55
    v_fma_f32 v43, v43, s40, -v12
    v_mfma_f32_16x16x32_bf16 v[68:71], a[116:119], v[172:175], v[68:71]
    v_exp_f32 v42, v42
    v_mfma_f32_16x16x32_bf16 v[72:75], a[120:123], v[128:131], 0
    v_exp_f32 v58, v58
    v_mfma_f32_16x16x32_bf16 v[72:75], a[124:127], v[132:135], v[72:75]
    v_fma_f32 v59, v59, s40, -v13
    v_add_f32 v14, v14, v40
    v_mfma_f32_16x16x32_bf16 v[72:75], a[128:131], v[136:139], v[72:75]
    v_cvt_pk_bf16_f32 v112, v68, v69
    v_cvt_pk_bf16_f32 v113, v70, v71
    v_mfma_f32_16x16x32_bf16 v[72:75], a[132:135], v[140:143], v[72:75]
    v_add_f32 v15, v15, v56
    v_fma_f32 v44, v44, s40, -v12
    v_mfma_f32_16x16x32_bf16 v[72:75], a[136:139], v[144:147], v[72:75]
    v_exp_f32 v43, v43
    v_mfma_f32_16x16x32_bf16 v[72:75], a[140:143], v[148:151], v[72:75]
    v_exp_f32 v59, v59
    v_mfma_f32_16x16x32_bf16 v[76:79], a[120:123], v[152:155], 0
    v_fma_f32 v60, v60, s40, -v13
    v_add_f32 v14, v14, v41
    v_mfma_f32_16x16x32_bf16 v[76:79], a[124:127], v[156:159], v[76:79]
    v_add_f32 v15, v15, v57
    v_fma_f32 v45, v45, s40, -v12
    v_mfma_f32_16x16x32_bf16 v[76:79], a[128:131], v[160:163], v[76:79]
    v_cvt_pk_bf16_f32 v90, v72, v73
    v_cvt_pk_bf16_f32 v91, v74, v75
    v_mfma_f32_16x16x32_bf16 v[76:79], a[132:135], v[164:167], v[76:79]
    v_exp_f32 v44, v44
    v_mfma_f32_16x16x32_bf16 v[76:79], a[136:139], v[168:171], v[76:79]
    v_exp_f32 v60, v60
    v_mfma_f32_16x16x32_bf16 v[76:79], a[140:143], v[172:175], v[76:79]
    v_fma_f32 v61, v61, s40, -v13
    v_add_f32 v14, v14, v42
    v_mfma_f32_16x16x32_bf16 v[64:67], a[144:147], v[128:131], 0
    ds_read_b128 v[176:179], v6 offset:0
    v_add_f32 v15, v15, v58
    v_mfma_f32_16x16x32_bf16 v[64:67], a[148:151], v[132:135], v[64:67]
    v_exp_f32 v45, v45
    v_mfma_f32_16x16x32_bf16 v[64:67], a[152:155], v[136:139], v[64:67]
    v_cvt_pk_bf16_f32 v114, v76, v77
    v_cvt_pk_bf16_f32 v115, v78, v79
    v_mfma_f32_16x16x32_bf16 v[64:67], a[156:159], v[140:143], v[64:67]
    v_exp_f32 v61, v61
    v_mfma_f32_16x16x32_bf16 v[64:67], a[160:163], v[144:147], v[64:67]
    v_fma_f32 v46, v46, s40, -v12
    v_fma_f32 v62, v62, s40, -v13
    v_mfma_f32_16x16x32_bf16 v[64:67], a[164:167], v[148:151], v[64:67]
    ds_read_b128 v[180:183], v7 offset:0
    v_add_f32 v14, v14, v43
    v_mfma_f32_16x16x32_bf16 v[68:71], a[144:147], v[152:155], 0
    v_add_f32 v15, v15, v59
    v_fma_f32 v47, v47, s40, -v12
    v_mfma_f32_16x16x32_bf16 v[68:71], a[148:151], v[156:159], v[68:71]
    v_exp_f32 v46, v46
    v_mfma_f32_16x16x32_bf16 v[68:71], a[152:155], v[160:163], v[68:71]
    v_cvt_pk_bf16_f32 v92, v64, v65
    v_cvt_pk_bf16_f32 v93, v66, v67
    v_mfma_f32_16x16x32_bf16 v[68:71], a[156:159], v[164:167], v[68:71]
    v_exp_f32 v62, v62
    v_mfma_f32_16x16x32_bf16 v[68:71], a[160:163], v[168:171], v[68:71]
    ds_read_b128 v[184:187], v6 offset:128
    v_fma_f32 v63, v63, s40, -v13
    v_mfma_f32_16x16x32_bf16 v[68:71], a[164:167], v[172:175], v[68:71]
    v_add_f32 v14, v14, v44
    v_add_f32 v15, v15, v60
    v_mfma_f32_16x16x32_bf16 v[72:75], a[168:171], v[128:131], 0
    v_exp_f32 v47, v47
    v_mfma_f32_16x16x32_bf16 v[72:75], a[172:175], v[132:135], v[72:75]
    v_exp_f32 v63, v63
    v_mfma_f32_16x16x32_bf16 v[72:75], a[176:179], v[136:139], v[72:75]
    v_cvt_pk_bf16_f32 v116, v68, v69
    v_cvt_pk_bf16_f32 v117, v70, v71
    v_mfma_f32_16x16x32_bf16 v[72:75], a[180:183], v[140:143], v[72:75]
    ds_read_b128 v[188:191], v7 offset:128
    v_add_f32 v14, v14, v45
    v_mfma_f32_16x16x32_bf16 v[72:75], a[184:187], v[144:147], v[72:75]
    v_add_f32 v15, v15, v61
    v_add_f32 v14, v14, v46
    v_mfma_f32_16x16x32_bf16 v[72:75], a[188:191], v[148:151], v[72:75]
    v_add_f32 v15, v15, v62
    v_add_f32 v14, v14, v47
    v_mfma_f32_16x16x32_bf16 v[76:79], a[168:171], v[152:155], 0
    v_add_f32 v15, v15, v63
    v_mfma_f32_16x16x32_bf16 v[76:79], a[172:175], v[156:159], v[76:79]
    v_mfma_f32_16x16x32_bf16 v[76:79], a[176:179], v[160:163], v[76:79]
    ds_read_b128 v[192:195], v6 offset:256
    v_cvt_pk_bf16_f32 v94, v72, v73
    v_mfma_f32_16x16x32_bf16 v[76:79], a[180:183], v[164:167], v[76:79]
    v_cvt_pk_bf16_f32 v95, v74, v75
    v_permlane16_swap_b32 v14, v15
    v_mfma_f32_16x16x32_bf16 v[76:79], a[184:187], v[168:171], v[76:79]
    v_add_f32 v14, v14, v15
    v_mov_b32 v15, v14
    v_mfma_f32_16x16x32_bf16 v[76:79], a[188:191], v[172:175], v[76:79]
    v_mfma_f32_16x16x32_bf16 v[64:67], a[192:195], v[128:131], 0
    v_permlane32_swap_b32 v14, v15
    v_add_f32 v14, v14, v15
    v_mfma_f32_16x16x32_bf16 v[64:67], a[196:199], v[132:135], v[64:67]
    ds_read_b128 v[196:199], v7 offset:256
    v_mfma_f32_16x16x32_bf16 v[64:67], a[200:203], v[136:139], v[64:67]
    v_cvt_pk_bf16_f32 v118, v76, v77
    v_cvt_pk_bf16_f32 v119, v78, v79
    v_mfma_f32_16x16x32_bf16 v[64:67], a[204:207], v[140:143], v[64:67]
    v_rcp_f32 v14, v14
    v_mfma_f32_16x16x32_bf16 v[64:67], a[208:211], v[144:147], v[64:67]
    v_mov_b32 v15, v14
    v_mfma_f32_16x16x32_bf16 v[64:67], a[212:215], v[148:151], v[64:67]
    v_mfma_f32_16x16x32_bf16 v[68:71], a[192:195], v[152:155], 0
    ds_read_b128 v[200:203], v6 offset:6144
    v_permlane16_swap_b32 v14, v15
    v_mfma_f32_16x16x32_bf16 v[68:71], a[196:199], v[156:159], v[68:71]
    v_mul_f32 v32, v32, v14
    v_mul_f32 v33, v33, v14
    v_mfma_f32_16x16x32_bf16 v[68:71], a[200:203], v[160:163], v[68:71]
    v_cvt_pk_bf16_f32 v96, v64, v65
    v_cvt_pk_bf16_f32 v97, v66, v67
    v_mfma_f32_16x16x32_bf16 v[68:71], a[204:207], v[164:167], v[68:71]
    v_mul_f32 v40, v40, v14
    v_mul_f32 v41, v41, v14
    v_mfma_f32_16x16x32_bf16 v[68:71], a[208:211], v[168:171], v[68:71]
    v_mul_f32 v48, v48, v15
    v_mul_f32 v49, v49, v15
    v_mfma_f32_16x16x32_bf16 v[68:71], a[212:215], v[172:175], v[68:71]
    ds_read_b128 v[204:207], v7 offset:6144
    v_mul_f32 v56, v56, v15
    v_mfma_f32_16x16x32_bf16 v[72:75], a[216:219], v[128:131], 0
    v_mul_f32 v57, v57, v15
    v_cvt_pk_bf16_f32 v32, v32, v33
    v_mfma_f32_16x16x32_bf16 v[72:75], a[220:223], v[132:135], v[72:75]
    v_mul_f32 v34, v34, v14
    v_mul_f32 v35, v35, v14
    v_mfma_f32_16x16x32_bf16 v[72:75], a[224:227], v[136:139], v[72:75]
    v_cvt_pk_bf16_f32 v120, v68, v69
    v_cvt_pk_bf16_f32 v121, v70, v71
    v_mfma_f32_16x16x32_bf16 v[72:75], a[228:231], v[140:143], v[72:75]
    v_cvt_pk_bf16_f32 v40, v40, v41
    v_mul_f32 v42, v42, v14
    v_mfma_f32_16x16x32_bf16 v[72:75], a[232:235], v[144:147], v[72:75]
    ds_read_b128 v[208:211], v6 offset:6272
    v_mul_f32 v43, v43, v14
    v_mfma_f32_16x16x32_bf16 v[72:75], a[236:239], v[148:151], v[72:75]
    v_cvt_pk_bf16_f32 v48, v48, v49
    v_mul_f32 v50, v50, v15
    v_mfma_f32_16x16x32_bf16 v[76:79], a[216:219], v[152:155], 0
    v_mul_f32 v51, v51, v15
    v_cvt_pk_bf16_f32 v56, v56, v57
    v_mfma_f32_16x16x32_bf16 v[76:79], a[220:223], v[156:159], v[76:79]
    v_mul_f32 v58, v58, v15
    v_mul_f32 v59, v59, v15
    v_mfma_f32_16x16x32_bf16 v[76:79], a[224:227], v[160:163], v[76:79]
    v_cvt_pk_bf16_f32 v98, v72, v73
    v_cvt_pk_bf16_f32 v99, v74, v75
    v_mfma_f32_16x16x32_bf16 v[76:79], a[228:231], v[164:167], v[76:79]
    ds_read_b128 v[212:215], v7 offset:6272
    v_cvt_pk_bf16_f32 v33, v34, v35
    v_mfma_f32_16x16x32_bf16 v[76:79], a[232:235], v[168:171], v[76:79]
    v_mul_f32 v36, v36, v14
    v_mul_f32 v37, v37, v14
    v_mfma_f32_16x16x32_bf16 v[76:79], a[236:239], v[172:175], v[76:79]
    v_mul_f32 v38, v38, v14
    v_mul_f32 v39, v39, v14
    v_mfma_f32_16x16x32_bf16 v[64:67], a[240:243], v[128:131], 0
    v_cvt_pk_bf16_f32 v41, v42, v43
    v_mul_f32 v44, v44, v14
    v_mfma_f32_16x16x32_bf16 v[64:67], a[244:247], v[132:135], v[64:67]
    v_mul_f32 v45, v45, v14
    v_mul_f32 v46, v46, v14
    v_mfma_f32_16x16x32_bf16 v[64:67], a[248:251], v[136:139], v[64:67]
    ds_read_b128 v[216:219], v6 offset:6400
    v_cvt_pk_bf16_f32 v122, v76, v77
    v_mfma_f32_16x16x32_bf16 v[64:67], a[252:255], v[140:143], v[64:67]
    v_cvt_pk_bf16_f32 v123, v78, v79
    v_mul_f32 v47, v47, v14
    v_mfma_f32_16x16x32_bf16 v[64:67], v[224:227], v[144:147], v[64:67]
    v_cvt_pk_bf16_f32 v49, v50, v51
    v_mul_f32 v52, v52, v15
    v_mfma_f32_16x16x32_bf16 v[64:67], v[228:231], v[148:151], v[64:67]
    v_mul_f32 v53, v53, v15
    v_mul_f32 v54, v54, v15
    v_mfma_f32_16x16x32_bf16 v[68:71], a[240:243], v[152:155], 0
    v_mul_f32 v55, v55, v15
    v_cvt_pk_bf16_f32 v57, v58, v59
    v_mfma_f32_16x16x32_bf16 v[68:71], a[244:247], v[156:159], v[68:71]
    ds_read_b128 v[220:223], v7 offset:6400
    v_mul_f32 v60, v60, v15
    v_mfma_f32_16x16x32_bf16 v[68:71], a[248:251], v[160:163], v[68:71]
    v_mul_f32 v61, v61, v15
    v_mul_f32 v62, v62, v15
    v_mfma_f32_16x16x32_bf16 v[68:71], a[252:255], v[164:167], v[68:71]
    v_mul_f32 v63, v63, v15
    v_cvt_pk_bf16_f32 v34, v36, v37
    v_mfma_f32_16x16x32_bf16 v[68:71], v[224:227], v[168:171], v[68:71]
    v_cvt_pk_bf16_f32 v35, v38, v39
    v_cvt_pk_bf16_f32 v42, v44, v45
    v_mfma_f32_16x16x32_bf16 v[68:71], v[228:231], v[172:175], v[68:71]
    ds_write_b128 v8, v[32:35] offset:0
    v_mfma_f32_16x16x32_bf16 v[72:75], v[232:235], v[128:131], 0
    v_cvt_pk_bf16_f32 v43, v46, v47
    v_cvt_pk_bf16_f32 v50, v52, v53
    v_mfma_f32_16x16x32_bf16 v[72:75], v[236:239], v[132:135], v[72:75]
    ds_write_b128 v9, v[40:43] offset:0
    v_mfma_f32_16x16x32_bf16 v[72:75], v[240:243], v[136:139], v[72:75]
    v_cvt_pk_bf16_f32 v51, v54, v55
    v_cvt_pk_bf16_f32 v58, v60, v61
    v_mfma_f32_16x16x32_bf16 v[72:75], v[244:247], v[140:143], v[72:75]
    ds_write_b128 v8, v[48:51] offset:2048
    v_mfma_f32_16x16x32_bf16 v[72:75], v[248:251], v[144:147], v[72:75]
    v_cvt_pk_bf16_f32 v59, v62, v63
    v_cvt_pk_bf16_f32 v100, v64, v65
    v_mfma_f32_16x16x32_bf16 v[72:75], v[252:255], v[148:151], v[72:75]
    ds_write_b128 v9, v[56:59] offset:2048
    v_mfma_f32_16x16x32_bf16 v[76:79], v[232:235], v[152:155], 0
    v_cvt_pk_bf16_f32 v101, v66, v67
    v_cvt_pk_bf16_f32 v124, v68, v69
    v_mfma_f32_16x16x32_bf16 v[76:79], v[236:239], v[156:159], v[76:79]
    v_cvt_pk_bf16_f32 v125, v70, v71
    v_mfma_f32_16x16x32_bf16 v[76:79], v[240:243], v[160:163], v[76:79]
    v_cvt_pk_bf16_f32 v102, v72, v73
    v_cvt_pk_bf16_f32 v103, v74, v75
    v_mfma_f32_16x16x32_bf16 v[76:79], v[244:247], v[164:167], v[76:79]
    v_mfma_f32_16x16x32_bf16 v[76:79], v[248:251], v[168:171], v[76:79]
    v_mfma_f32_16x16x32_bf16 v[76:79], v[252:255], v[172:175], v[76:79]
    s_waitcnt lgkmcnt(0)
    s_barrier
    s_bitcmp1_b32 s16, 2
    s_cbranch_scc1 L_mloop
    s_branch L_fin
L_nrole:
    v_add_u32 v18, 0, v0
    v_mul_u32_u24 v18, 171, v18
    v_lshrrev_b32 v18, 13, v18
    s_lshl_b32 s60, s37, 2
    v_or_b32 v18, s60, v18
    v_lshlrev_b32 v18, 4, v18
    v_xor_b32 v18, v18, v1
    s_mul_i32 s60, s37, 196608
    v_add_u32 v8, s60, v18
    v_add_u32 v18, 64, v0
    v_mul_u32_u24 v18, 171, v18
    v_lshrrev_b32 v18, 13, v18
    s_lshl_b32 s60, s37, 2
    v_or_b32 v18, s60, v18
    v_lshlrev_b32 v18, 4, v18
    v_xor_b32 v18, v18, v1
    s_mul_i32 s60, s37, 196608
    v_add_u32 v9, s60, v18
    v_add_u32 v18, 128, v0
    v_mul_u32_u24 v18, 171, v18
    v_lshrrev_b32 v18, 13, v18
    s_lshl_b32 s60, s37, 2
    v_or_b32 v18, s60, v18
    v_lshlrev_b32 v18, 4, v18
    v_xor_b32 v18, v18, v1
    s_mul_i32 s60, s37, 196608
    v_add_u32 v10, s60, v18
    s_mul_i32 s42, s37, 3072
    s_mov_b32 s10, 100663296
    s_mov_b32 s11, 0x00020000
    s_waitcnt lgkmcnt(0)
    s_mov_b32 s8, s4
    s_mov_b32 s9, s5
    s_mov_b32 s52, s50
    s_mov_b32 s53, s51
    s_add_u32 m0, s42, 0
    s_add_u32 s46, s38, 0
    buffer_load_dwordx4 v8, s[8:11], s46 offen offset:0 nt lds
    buffer_load_dwordx4 v9, s[8:11], s46 offen offset:1024 nt lds
    buffer_load_dwordx4 v10, s[8:11], s46 offen offset:2048 nt lds
    s_add_u32 m0, s42, 6144
    s_add_u32 s46, s38, 393216
    buffer_load_dwordx4 v8, s[8:11], s46 offen offset:0 nt lds
    buffer_load_dwordx4 v9, s[8:11], s46 offen offset:1024 nt lds
    buffer_load_dwordx4 v10, s[8:11], s46 offen offset:2048 nt lds
    s_add_u32 m0, s42, 12288
    s_add_u32 s46, s38, 786432
    buffer_load_dwordx4 v8, s[8:11], s46 offen offset:0 nt lds
    buffer_load_dwordx4 v9, s[8:11], s46 offen offset:1024 nt lds
    buffer_load_dwordx4 v10, s[8:11], s46 offen offset:2048 nt lds
    s_add_u32 m0, s42, 18432
    s_add_u32 s46, s38, 1179648
    buffer_load_dwordx4 v8, s[8:11], s46 offen offset:0 nt lds
    buffer_load_dwordx4 v9, s[8:11], s46 offen offset:1024 nt lds
    buffer_load_dwordx4 v10, s[8:11], s46 offen offset:2048 nt lds
    v_lshrrev_b32 v18, 1, v16
    v_xor_b32 v18, v18, v17
    v_lshlrev_b32 v18, 4, v18
    v_mul_u32_u24 v19, 384, v16
    v_add_u32 v2, v18, v19
    v_xor_b32 v3, 64, v2
    v_lshrrev_b32 v18, 5, v0
    v_mul_u32_u24 v18, 196608, v18
    v_and_b32 v19, 1, v17
    v_mul_u32_u24 v19, 1536, v19
    v_lshlrev_b32 v20, 3, v16
    v_add3_u32 v12, v18, v19, v20
    s_lshl_b32 s60, s37, 7
    v_add_u32 v12, s60, v12
    v_lshrrev_b32 v18, 3, v16
    v_mul_u32_u24 v18, 196608, v18
    v_and_b32 v19, 7, v16
    v_mul_u32_u24 v19, 384, v19
    v_lshlrev_b32 v20, 4, v17
    v_add3_u32 v21, v18, v19, v20
    s_lshl_b32 s60, s37, 6
    s_add_u32 s60, s60, 256
    v_add_u32 v16, s60, v21
    v_add_u32 v13, 393216, v12
    v_add_u32 v17, 393216, v16
    v_add_u32 v14, 786432, v12
    v_add_u32 v18, 786432, v16
    v_add_u32 v15, 1179648, v12
    v_add_u32 v19, 1179648, v16
    v_add_u32 v6, 98304, v1
    v_mov_b32 v4, v2
    v_mov_b32 v5, v3
    s_mov_b32 s12, s6
    s_mov_b32 s13, s7
    s_mov_b32 s14, 100663296
    s_mov_b32 s15, 0x00020000
    s_mov_b32 s41, 0
    s_mov_b32 s44, 100663296
    s_mov_b32 s45, s38
    s_add_u32 s43, s38, 18874368
    s_mov_b32 s48, 0
    s_mov_b32 s16, 100663296
    s_add_u32 s17, s38, 0
    s_add_u32 s18, s38, 6291456
    s_add_u32 s19, s38, 12582912
    s_lshr_b32 s60, s2, 3
    s_and_b32 s60, s60, 7
    s_mul_i32 s24, s60, 24576
    s_lshl_b32 s60, s60, 8
    s_add_u32 s60, s60, 147456
    s_cmp_eq_u32 s37, 0
    s_cselect_b32 s60, s60, 0x40000000
    v_mov_b32 v25, s60
    s_mov_b32 s54, 149504
    s_lshr_b32 s60, s2, 6
    s_lshl_b32 s60, s60, 3
    s_and_b32 s61, s2, 7
    s_add_u32 s60, s60, s61
    s_sub_u32 s60, s60, 64
    v_mov_b32 v28, s60
    v_mov_b32 v29, s60
    s_add_u32 s60, s60, 32
    v_mov_b32 v24, s60
    v_mov_b32 v23, 114688
    s_lshl_b32 s61, s37, 3
    v_add_u32 v11, s61, v23
    ds_write_b64 v11, v[28:29]
    v_add_u32 v11, 4, v11
    s_getpc_b64 s[56:57]
L_pc:
    s_sub_u32 s56, s56, L_pc-L_mloop
    s_subb_u32 s57, s57, 0
    s_mov_b32 s58, L_codeend-L_mloop
    s_mov_b32 s59, 0x00020000
    s_lshr_b32 s60, s2, 3
    s_and_b32 s60, s60, 7
    s_lshl_b32 s60, s60, 1
    s_add_u32 s60, s60, s37
    s_lshl_b32 s60, s60, 10
    buffer_load_dwordx4 v[28:31], v1, s[56:59], s60 offen
    s_waitcnt vmcnt(1) lgkmcnt(0)
    s_barrier
    s_add_u32 m0, s42, 24576
    s_add_u32 s46, s38, 6291456
    buffer_load_dwordx4 v8, s[8:11], s46 offen offset:0 nt lds
    buffer_load_dwordx4 v9, s[8:11], s46 offen offset:1024 nt lds
    buffer_load_dwordx4 v10, s[8:11], s46 offen offset:2048 nt lds
    s_add_u32 m0, s42, 30720
    s_add_u32 s46, s38, 6684672
    buffer_load_dwordx4 v8, s[8:11], s46 offen offset:0 nt lds
    buffer_load_dwordx4 v9, s[8:11], s46 offen offset:1024 nt lds
    buffer_load_dwordx4 v10, s[8:11], s46 offen offset:2048 nt lds
    s_add_u32 m0, s42, 36864
    s_add_u32 s46, s38, 7077888
    buffer_load_dwordx4 v8, s[8:11], s46 offen offset:0 nt lds
    buffer_load_dwordx4 v9, s[8:11], s46 offen offset:1024 nt lds
    buffer_load_dwordx4 v10, s[8:11], s46 offen offset:2048 nt lds
    s_add_u32 m0, s42, 43008
    s_add_u32 s46, s38, 7471104
    buffer_load_dwordx4 v8, s[8:11], s46 offen offset:0 nt lds
    buffer_load_dwordx4 v9, s[8:11], s46 offen offset:1024 nt lds
    buffer_load_dwordx4 v10, s[8:11], s46 offen offset:2048 nt lds
    s_mul_i32 s61, s37, 36864
    s_add_u32 s61, s61, 73728
    buffer_load_dwordx4 a[0:3], v1, s[52:55], s61 offen offset:0
    buffer_load_dwordx4 a[4:7], v1, s[52:55], s61 offen offset:1024
    buffer_load_dwordx4 a[8:11], v1, s[52:55], s61 offen offset:2048
    buffer_load_dwordx4 a[12:15], v1, s[52:55], s61 offen offset:3072
    s_add_u32 s61, s61, 4096
    buffer_load_dwordx4 a[16:19], v1, s[52:55], s61 offen offset:0
    buffer_load_dwordx4 a[20:23], v1, s[52:55], s61 offen offset:1024
    buffer_load_dwordx4 a[24:27], v1, s[52:55], s61 offen offset:2048
    buffer_load_dwordx4 a[28:31], v1, s[52:55], s61 offen offset:3072
    s_add_u32 s61, s61, 4096
    buffer_load_dwordx4 a[32:35], v1, s[52:55], s61 offen offset:0
    buffer_load_dwordx4 a[36:39], v1, s[52:55], s61 offen offset:1024
    buffer_load_dwordx4 a[40:43], v1, s[52:55], s61 offen offset:2048
    buffer_load_dwordx4 a[44:47], v1, s[52:55], s61 offen offset:3072
    s_add_u32 s61, s61, 4096
    buffer_load_dwordx4 a[48:51], v1, s[52:55], s61 offen offset:0
    buffer_load_dwordx4 a[52:55], v1, s[52:55], s61 offen offset:1024
    buffer_load_dwordx4 a[56:59], v1, s[52:55], s61 offen offset:2048
    buffer_load_dwordx4 a[60:63], v1, s[52:55], s61 offen offset:3072
    s_add_u32 s61, s61, 4096
    buffer_load_dwordx4 a[64:67], v1, s[52:55], s61 offen offset:0
    buffer_load_dwordx4 a[68:71], v1, s[52:55], s61 offen offset:1024
    buffer_load_dwordx4 a[72:75], v1, s[52:55], s61 offen offset:2048
    buffer_load_dwordx4 a[76:79], v1, s[52:55], s61 offen offset:3072
    s_add_u32 s61, s61, 4096
    buffer_load_dwordx4 a[80:83], v1, s[52:55], s61 offen offset:0
    buffer_load_dwordx4 a[84:87], v1, s[52:55], s61 offen offset:1024
    buffer_load_dwordx4 a[88:91], v1, s[52:55], s61 offen offset:2048
    buffer_load_dwordx4 a[92:95], v1, s[52:55], s61 offen offset:3072
    s_add_u32 s61, s61, 4096
    buffer_load_dwordx4 a[96:99], v1, s[52:55], s61 offen offset:0
    buffer_load_dwordx4 a[100:103], v1, s[52:55], s61 offen offset:1024
    buffer_load_dwordx4 a[104:107], v1, s[52:55], s61 offen offset:2048
    buffer_load_dwordx4 a[108:111], v1, s[52:55], s61 offen offset:3072
    s_add_u32 s61, s61, 4096
    buffer_load_dwordx4 a[112:115], v1, s[52:55], s61 offen offset:0
    buffer_load_dwordx4 a[116:119], v1, s[52:55], s61 offen offset:1024
    buffer_load_dwordx4 a[120:123], v1, s[52:55], s61 offen offset:2048
    buffer_load_dwordx4 a[124:127], v1, s[52:55], s61 offen offset:3072
    s_add_u32 s61, s61, 4096
    buffer_load_dwordx4 a[128:131], v1, s[52:55], s61 offen offset:0
    buffer_load_dwordx4 a[132:135], v1, s[52:55], s61 offen offset:1024
    buffer_load_dwordx4 a[136:139], v1, s[52:55], s61 offen offset:2048
    buffer_load_dwordx4 a[140:143], v1, s[52:55], s61 offen offset:3072
    s_add_u32 m0, s42, 49152
    s_add_u32 s46, s38, 12582912
    buffer_load_dwordx4 v8, s[8:11], s46 offen offset:0 nt lds
    buffer_load_dwordx4 v9, s[8:11], s46 offen offset:1024 nt lds
    buffer_load_dwordx4 v10, s[8:11], s46 offen offset:2048 nt lds
    s_add_u32 m0, s42, 55296
    s_add_u32 s46, s38, 12976128
    buffer_load_dwordx4 v8, s[8:11], s46 offen offset:0 nt lds
    buffer_load_dwordx4 v9, s[8:11], s46 offen offset:1024 nt lds
    buffer_load_dwordx4 v10, s[8:11], s46 offen offset:2048 nt lds
    s_add_u32 m0, s42, 61440
    s_add_u32 s46, s38, 13369344
    buffer_load_dwordx4 v8, s[8:11], s46 offen offset:0 nt lds
    buffer_load_dwordx4 v9, s[8:11], s46 offen offset:1024 nt lds
    buffer_load_dwordx4 v10, s[8:11], s46 offen offset:2048 nt lds
    s_add_u32 m0, s42, 67584
    s_add_u32 s46, s38, 13762560
    buffer_load_dwordx4 v8, s[8:11], s46 offen offset:0 nt lds
    buffer_load_dwordx4 v9, s[8:11], s46 offen offset:1024 nt lds
    buffer_load_dwordx4 v10, s[8:11], s46 offen offset:2048 nt lds
    s_waitcnt vmcnt(48)
    s_mov_b32 s36, s42
    s_add_u32 s42, s42, 73728
    s_barrier
    s_mov_b64 vcc, -1
    .p2align 6
L_nloop:
    v_mfma_f32_16x16x32_bf16 v[120:123], a[144:147], a[120:123], 0
    ds_read_b32 v22, v23
    v_xor_b32 v23, 4, v23
    v_mfma_f32_16x16x32_bf16 v[120:123], a[148:151], a[124:127], v[120:123]
    ds_read_b128 v[88:91], v6 offset:0
    v_cvt_pk_bf16_f32 v78, v148, v149
    v_mfma_f32_16x16x32_bf16 v[120:123], a[152:155], a[128:131], v[120:123]
    ds_read_b128 v[92:95], v6 offset:1024
    v_cvt_pk_bf16_f32 v79, v150, v151
    v_mfma_f32_16x16x32_bf16 v[120:123], a[156:159], a[132:135], v[120:123]
    ds_read_b128 v[96:99], v6 offset:2048
    v_mfma_f32_16x16x32_bf16 v[120:123], a[160:163], a[136:139], v[120:123]
    ds_read_b128 v[100:103], v6 offset:3072
    v_mfma_f32_16x16x32_bf16 v[120:123], a[164:167], a[140:143], v[120:123]
    ds_read_b128 v[104:107], v6 offset:4096
    v_mfma_f32_16x16x32_bf16 v[124:127], a[168:171], a[120:123], 0
    ds_read_b128 v[108:111], v6 offset:5120
    v_mfma_f32_16x16x32_bf16 v[124:127], a[172:175], a[124:127], v[124:127]
    ds_read_b128 v[112:115], v6 offset:6144
    v_mfma_f32_16x16x32_bf16 v[124:127], a[176:179], a[128:131], v[124:127]
    ds_read_b128 v[116:119], v6 offset:7168
    v_cvt_pk_bf16_f32 v80, v120, v121
    v_mfma_f32_16x16x32_bf16 v[124:127], a[180:183], a[132:135], v[124:127]
    s_waitcnt lgkmcnt(8)
    v_readfirstlane_b32 s60, v22
    s_nop 0
    s_add_u32 s60, s60, 160
    s_lshr_b32 s61, s60, 3
    v_mfma_f32_16x16x32_bf16 v[124:127], a[184:187], a[136:139], v[124:127]
    s_mul_i32 s61, s61, 1572864
    s_and_b32 s60, s60, 7
    s_mul_i32 s60, s60, 3072
    s_add_u32 s61, s61, s24
    v_mfma_f32_16x16x32_bf16 v[124:127], a[188:191], a[140:143], v[124:127]
    s_add_u32 s43, s61, s60
    v_cvt_pk_bf16_f32 v81, v122, v123
    v_mfma_f32_16x16x32_bf16 v[128:131], a[192:195], a[120:123], 0
    ds_read_b128 a[144:147], v4 offset:0
    v_xor_b32 v6, 8192, v6
    v_mfma_f32_16x16x32_bf16 v[128:131], a[196:199], a[124:127], v[128:131]
    ds_read_b128 a[148:151], v5 offset:0
    v_mfma_f32_16x16x32_bf16 v[128:131], a[200:203], a[128:131], v[128:131]
    s_add_u32 m0, s42, 0
    s_add_u32 s46, s43, 0
    v_mfma_f32_16x16x32_bf16 v[128:131], a[204:207], a[132:135], v[128:131]
    v_cvt_pk_bf16_f32 v82, v124, v125
    v_cvt_pk_bf16_f32 v83, v126, v127
    v_mfma_f32_16x16x32_bf16 v[128:131], a[208:211], a[136:139], v[128:131]
    buffer_load_dwordx4 v8, s[8:11], s46 offen offset:0 nt lds
    v_mfma_f32_16x16x32_bf16 v[128:131], a[212:215], a[140:143], v[128:131]
    ds_read_b128 a[152:155], v4 offset:128
    v_mfma_f32_16x16x32_bf16 v[132:135], a[216:219], a[120:123], 0
    ds_read_b128 a[156:159], v5 offset:128
    v_mfma_f32_16x16x32_bf16 v[132:135], a[220:223], a[124:127], v[132:135]
    ds_read_b128 a[160:163], v4 offset:256
    v_mfma_f32_16x16x32_bf16 v[132:135], a[224:227], a[128:131], v[132:135]
    v_cvt_pk_bf16_f32 v84, v128, v129
    v_cvt_pk_bf16_f32 v85, v130, v131
    v_mfma_f32_16x16x32_bf16 v[132:135], a[228:231], a[132:135], v[132:135]
    ds_read_b128 a[164:167], v5 offset:256
    v_mfma_f32_16x16x32_bf16 v[132:135], a[232:235], a[136:139], v[132:135]
    ds_read_b128 a[168:171], v4 offset:6144
    v_mfma_f32_16x16x32_bf16 v[132:135], a[236:239], a[140:143], v[132:135]
    ds_read_b128 a[172:175], v5 offset:6144
    s_waitcnt lgkmcnt(8)
    v_mfma_f32_16x16x32_bf16 v[152:155], v[88:91], v[40:43], 0
    ds_read_b128 a[176:179], v4 offset:6272
    v_mfma_f32_16x16x32_bf16 v[152:155], v[92:95], v[44:47], v[152:155]
    ds_read_b128 a[180:183], v5 offset:6272
    v_mfma_f32_16x16x32_bf16 v[156:159], v[88:91], v[48:51], 0
    s_waitcnt vmcnt(32)
    s_mov_b64 exec, 1
    ds_write_b32 v11, v24
    s_mov_b64 exec, -1
    v_mfma_f32_16x16x32_bf16 v[156:159], v[92:95], v[52:55], v[156:159]
    v_mov_b32 v24, 1
    v_cvt_pk_bf16_f32 v86, v132, v133
    v_mfma_f32_16x16x32_bf16 v[160:163], v[88:91], v[56:59], 0
    s_mov_b64 exec, 1
    buffer_atomic_add v24, v25, s[52:55], 0 offen sc0
    s_mov_b64 exec, -1
    v_mfma_f32_16x16x32_bf16 v[160:163], v[92:95], v[60:63], v[160:163]
    v_cvt_pk_bf16_f32 v87, v134, v135
    v_xor_b32 v11, 4, v11
    v_mfma_f32_16x16x32_bf16 v[164:167], v[88:91], v[64:67], 0
    buffer_load_dwordx4 v9, s[8:11], s46 offen offset:1024 nt lds
    v_mfma_f32_16x16x32_bf16 v[164:167], v[92:95], v[68:71], v[164:167]
    ds_read_b128 a[184:187], v4 offset:6400
    v_cvt_pk_bf16_f32 v200, v152, v156
    v_mfma_f32_16x16x32_bf16 v[168:171], v[72:75], v[88:91], 0
    ds_read_b128 a[188:191], v5 offset:6400
    v_cvt_pk_bf16_f32 v202, v153, v157
    v_mfma_f32_16x16x32_bf16 v[168:171], v[76:79], v[92:95], v[168:171]
    ds_read_b128 a[192:195], v4 offset:12288
    v_cvt_pk_bf16_f32 v204, v154, v158
    v_mfma_f32_16x16x32_bf16 v[172:175], v[80:83], v[88:91], 0
    v_cvt_pk_bf16_f32 v201, v160, v164
    v_cvt_pk_bf16_f32 v206, v155, v159
    v_mfma_f32_16x16x32_bf16 v[172:175], v[84:87], v[92:95], v[172:175]
    ds_read_b128 a[196:199], v5 offset:12288
    v_cvt_pk_bf16_f32 v203, v161, v165
    v_mfma_f32_16x16x32_bf16 v[176:179], v[96:99], v[40:43], 0
    ds_read_b128 a[200:203], v4 offset:12416
    v_cvt_pk_bf16_f32 v205, v162, v166
    v_mfma_f32_16x16x32_bf16 v[176:179], v[100:103], v[44:47], v[176:179]
    ds_read_b128 a[204:207], v5 offset:12416
    v_cvt_pk_bf16_f32 v207, v163, v167
    v_mfma_f32_16x16x32_bf16 v[180:183], v[96:99], v[48:51], 0
    ds_read_b128 a[208:211], v4 offset:12544
    v_cvt_pk_bf16_f32 v208, v168, v169
    v_mfma_f32_16x16x32_bf16 v[180:183], v[100:103], v[52:55], v[180:183]
    ds_read_b128 a[212:215], v5 offset:12544
    v_cvt_pk_bf16_f32 v209, v170, v171
    v_mfma_f32_16x16x32_bf16 v[184:187], v[96:99], v[56:59], 0
    buffer_store_dwordx2 v[200:201], v12, s[12:15], s16 offen offset:0 sc1
    v_mfma_f32_16x16x32_bf16 v[184:187], v[100:103], v[60:63], v[184:187]
    ds_read_b128 a[216:219], v4 offset:18432
    v_cvt_pk_bf16_f32 v210, v172, v173
    v_mfma_f32_16x16x32_bf16 v[188:191], v[96:99], v[64:67], 0
    ds_read_b128 a[220:223], v5 offset:18432
    v_cvt_pk_bf16_f32 v211, v174, v175
    v_mfma_f32_16x16x32_bf16 v[188:191], v[100:103], v[68:71], v[188:191]
    ds_read_b128 a[224:227], v4 offset:18560
    v_cvt_pk_bf16_f32 v212, v176, v180
    v_mfma_f32_16x16x32_bf16 v[192:195], v[72:75], v[96:99], 0
    ds_read_b128 a[228:231], v5 offset:18560
    v_cvt_pk_bf16_f32 v214, v177, v181
    v_mfma_f32_16x16x32_bf16 v[192:195], v[76:79], v[100:103], v[192:195]
    buffer_load_dwordx4 v10, s[8:11], s46 offen offset:2048 nt lds
    v_mfma_f32_16x16x32_bf16 v[196:199], v[80:83], v[96:99], 0
    ds_read_b128 a[232:235], v4 offset:18688
    v_cvt_pk_bf16_f32 v216, v178, v182
    v_mfma_f32_16x16x32_bf16 v[196:199], v[84:87], v[100:103], v[196:199]
    buffer_store_dwordx2 v[202:203], v12, s[12:15], s16 offen offset:384 sc1
    v_mfma_f32_16x16x32_bf16 v[152:155], v[104:107], v[40:43], 0
    ds_read_b128 a[236:239], v5 offset:18688
    v_cvt_pk_bf16_f32 v218, v179, v183
    v_mfma_f32_16x16x32_bf16 v[152:155], v[108:111], v[44:47], v[152:155]
    v_cvt_pk_bf16_f32 v213, v184, v188
    v_cvt_pk_bf16_f32 v215, v185, v189
    v_mfma_f32_16x16x32_bf16 v[156:159], v[104:107], v[48:51], 0
    v_cvt_pk_bf16_f32 v217, v186, v190
    v_cvt_pk_bf16_f32 v219, v187, v191
    v_mfma_f32_16x16x32_bf16 v[156:159], v[108:111], v[52:55], v[156:159]
    v_cvt_pk_bf16_f32 v220, v192, v193
    v_cvt_pk_bf16_f32 v221, v194, v195
    v_mfma_f32_16x16x32_bf16 v[160:163], v[104:107], v[56:59], 0
    v_cvt_pk_bf16_f32 v222, v196, v197
    v_cvt_pk_bf16_f32 v223, v198, v199
    v_mfma_f32_16x16x32_bf16 v[160:163], v[108:111], v[60:63], v[160:163]
    v_mfma_f32_16x16x32_bf16 v[164:167], v[104:107], v[64:67], 0
    v_cvt_pk_bf16_f32 v224, v152, v156
    v_cvt_pk_bf16_f32 v226, v153, v157
    v_mfma_f32_16x16x32_bf16 v[164:167], v[108:111], v[68:71], v[164:167]
    buffer_store_dwordx2 v[204:205], v12, s[12:15], s16 offen offset:768 sc1
    v_mfma_f32_16x16x32_bf16 v[168:171], v[72:75], v[104:107], 0
    v_cvt_pk_bf16_f32 v228, v154, v158
    v_cvt_pk_bf16_f32 v230, v155, v159
    v_mfma_f32_16x16x32_bf16 v[168:171], v[76:79], v[108:111], v[168:171]
    s_add_u32 m0, s42, 6144
    s_add_u32 s46, s43, 393216
    v_mfma_f32_16x16x32_bf16 v[172:175], v[80:83], v[104:107], 0
    v_cvt_pk_bf16_f32 v225, v160, v164
    v_cvt_pk_bf16_f32 v227, v161, v165
    v_mfma_f32_16x16x32_bf16 v[172:175], v[84:87], v[108:111], v[172:175]
    buffer_load_dwordx4 v8, s[8:11], s46 offen offset:0 nt lds
    v_mfma_f32_16x16x32_bf16 v[176:179], v[112:115], v[40:43], 0
    v_cvt_pk_bf16_f32 v229, v162, v166
    v_cvt_pk_bf16_f32 v231, v163, v167
    v_mfma_f32_16x16x32_bf16 v[176:179], v[116:119], v[44:47], v[176:179]
    v_cvt_pk_bf16_f32 v232, v168, v169
    v_cvt_pk_bf16_f32 v233, v170, v171
    v_mfma_f32_16x16x32_bf16 v[180:183], v[112:115], v[48:51], 0
    buffer_store_dwordx2 v[206:207], v12, s[12:15], s16 offen offset:1152 sc1
    v_mfma_f32_16x16x32_bf16 v[180:183], v[116:119], v[52:55], v[180:183]
    v_cvt_pk_bf16_f32 v234, v172, v173
    v_cvt_pk_bf16_f32 v235, v174, v175
    v_mfma_f32_16x16x32_bf16 v[184:187], v[112:115], v[56:59], 0
    v_mfma_f32_16x16x32_bf16 v[184:187], v[116:119], v[60:63], v[184:187]
    v_mfma_f32_16x16x32_bf16 v[188:191], v[112:115], v[64:67], 0
    v_cvt_pk_bf16_f32 v236, v176, v180
    v_cvt_pk_bf16_f32 v238, v177, v181
    v_mfma_f32_16x16x32_bf16 v[188:191], v[116:119], v[68:71], v[188:191]
    v_cvt_pk_bf16_f32 v240, v178, v182
    v_cvt_pk_bf16_f32 v242, v179, v183
    v_mfma_f32_16x16x32_bf16 v[192:195], v[72:75], v[112:115], 0
    s_cbranch_vccnz L_nw
L_nw_back:
    v_mfma_f32_16x16x32_bf16 v[192:195], v[76:79], v[116:119], v[192:195]
    v_mfma_f32_16x16x32_bf16 v[196:199], v[80:83], v[112:115], 0
    buffer_store_dwordx4 v[208:211], v16, s[12:15], s16 offen sc1
    v_mfma_f32_16x16x32_bf16 v[196:199], v[84:87], v[116:119], v[196:199]
    v_cvt_pk_bf16_f32 v237, v184, v188
    s_waitcnt lgkmcnt(0)
    v_mfma_f32_16x16x32_bf16 v[136:139], a[144:147], a[0:3], 0
    v_cvt_pk_bf16_f32 v239, v185, v189
    v_cvt_pk_bf16_f32 v241, v186, v190
    v_mfma_f32_16x16x32_bf16 v[136:139], a[148:151], a[4:7], v[136:139]
    v_cvt_pk_bf16_f32 v243, v187, v191
    v_cvt_pk_bf16_f32 v244, v192, v193
    v_mfma_f32_16x16x32_bf16 v[136:139], a[152:155], a[8:11], v[136:139]
    buffer_load_dwordx4 v9, s[8:11], s46 offen offset:1024 nt lds
    v_mfma_f32_16x16x32_bf16 v[136:139], a[156:159], a[12:15], v[136:139]
    v_cvt_pk_bf16_f32 v245, v194, v195
    v_cvt_pk_bf16_f32 v246, v196, v197
    s_cmp_ge_u32 s17, 100663296
    s_cbranch_scc1 L_nepi
    v_mfma_f32_16x16x32_bf16 v[136:139], a[160:163], a[16:19], v[136:139]
    v_cvt_pk_bf16_f32 v247, v198, v199
    v_mfma_f32_16x16x32_bf16 v[136:139], a[164:167], a[20:23], v[136:139]
    v_mfma_f32_16x16x32_bf16 v[140:143], a[168:171], a[0:3], 0
    buffer_store_dwordx2 v[212:213], v13, s[12:15], s16 offen offset:0 sc1
    v_mfma_f32_16x16x32_bf16 v[140:143], a[172:175], a[4:7], v[140:143]
    v_mfma_f32_16x16x32_bf16 v[140:143], a[176:179], a[8:11], v[140:143]
    v_cvt_pk_bf16_f32 v40, v136, v137
    v_cvt_pk_bf16_f32 v41, v138, v139
    v_mfma_f32_16x16x32_bf16 v[140:143], a[180:183], a[12:15], v[140:143]
    v_mfma_f32_16x16x32_bf16 v[140:143], a[184:187], a[16:19], v[140:143]
    v_mfma_f32_16x16x32_bf16 v[140:143], a[188:191], a[20:23], v[140:143]
    v_mfma_f32_16x16x32_bf16 v[144:147], a[192:195], a[0:3], 0
    v_mfma_f32_16x16x32_bf16 v[144:147], a[196:199], a[4:7], v[144:147]
    buffer_store_dwordx2 v[214:215], v13, s[12:15], s16 offen offset:384 sc1
    v_mfma_f32_16x16x32_bf16 v[144:147], a[200:203], a[8:11], v[144:147]
    v_cvt_pk_bf16_f32 v42, v140, v141
    v_cvt_pk_bf16_f32 v43, v142, v143
    v_mfma_f32_16x16x32_bf16 v[144:147], a[204:207], a[12:15], v[144:147]
    v_mfma_f32_16x16x32_bf16 v[144:147], a[208:211], a[16:19], v[144:147]
    v_mfma_f32_16x16x32_bf16 v[144:147], a[212:215], a[20:23], v[144:147]
    buffer_load_dwordx4 v10, s[8:11], s46 offen offset:2048 nt lds
    v_mfma_f32_16x16x32_bf16 v[148:151], a[216:219], a[0:3], 0
    v_mfma_f32_16x16x32_bf16 v[148:151], a[220:223], a[4:7], v[148:151]
    v_mfma_f32_16x16x32_bf16 v[148:151], a[224:227], a[8:11], v[148:151]
    v_cvt_pk_bf16_f32 v44, v144, v145
    v_cvt_pk_bf16_f32 v45, v146, v147
    v_mfma_f32_16x16x32_bf16 v[148:151], a[228:231], a[12:15], v[148:151]
    buffer_store_dwordx2 v[216:217], v13, s[12:15], s16 offen offset:768 sc1
    v_mfma_f32_16x16x32_bf16 v[148:151], a[232:235], a[16:19], v[148:151]
    v_mfma_f32_16x16x32_bf16 v[148:151], a[236:239], a[20:23], v[148:151]
    v_mfma_f32_16x16x32_bf16 v[120:123], a[144:147], a[24:27], 0
    v_mfma_f32_16x16x32_bf16 v[120:123], a[148:151], a[28:31], v[120:123]
    v_mfma_f32_16x16x32_bf16 v[120:123], a[152:155], a[32:35], v[120:123]
    v_cvt_pk_bf16_f32 v46, v148, v149
    v_cvt_pk_bf16_f32 v47, v150, v151
    v_mfma_f32_16x16x32_bf16 v[120:123], a[156:159], a[36:39], v[120:123]
    v_mfma_f32_16x16x32_bf16 v[120:123], a[160:163], a[40:43], v[120:123]
    buffer_store_dwordx2 v[218:219], v13, s[12:15], s16 offen offset:1152 sc1
    v_mfma_f32_16x16x32_bf16 v[120:123], a[164:167], a[44:47], v[120:123]
    s_add_u32 m0, s42, 12288
    s_add_u32 s46, s43, 786432
    v_mfma_f32_16x16x32_bf16 v[124:127], a[168:171], a[24:27], 0
    s_add_u32 s41, s41, 24576
    s_cmp_ge_u32 s41, 98304
    s_cselect_b32 s56, 98304, 0
    s_sub_u32 s41, s41, s56
    v_add_u32 v4, s41, v2
    v_mfma_f32_16x16x32_bf16 v[124:127], a[172:175], a[28:31], v[124:127]
    buffer_load_dwordx4 v8, s[8:11], s46 offen offset:0 nt lds
    v_mfma_f32_16x16x32_bf16 v[124:127], a[176:179], a[32:35], v[124:127]
    v_cvt_pk_bf16_f32 v48, v120, v121
    v_cvt_pk_bf16_f32 v49, v122, v123
    v_mfma_f32_16x16x32_bf16 v[124:127], a[180:183], a[36:39], v[124:127]
    v_add_u32 v5, s41, v3
    v_mfma_f32_16x16x32_bf16 v[124:127], a[184:187], a[40:43], v[124:127]
    v_mfma_f32_16x16x32_bf16 v[124:127], a[188:191], a[44:47], v[124:127]
    v_mfma_f32_16x16x32_bf16 v[128:131], a[192:195], a[24:27], 0
    buffer_store_dwordx4 v[220:223], v17, s[12:15], s16 offen sc1
    v_mfma_f32_16x16x32_bf16 v[128:131], a[196:199], a[28:31], v[128:131]
    v_mfma_f32_16x16x32_bf16 v[128:131], a[200:203], a[32:35], v[128:131]
    v_cvt_pk_bf16_f32 v50, v124, v125
    v_cvt_pk_bf16_f32 v51, v126, v127
    v_mfma_f32_16x16x32_bf16 v[128:131], a[204:207], a[36:39], v[128:131]
    v_mfma_f32_16x16x32_bf16 v[128:131], a[208:211], a[40:43], v[128:131]
    v_mfma_f32_16x16x32_bf16 v[128:131], a[212:215], a[44:47], v[128:131]
    v_mfma_f32_16x16x32_bf16 v[132:135], a[216:219], a[24:27], 0
    v_mfma_f32_16x16x32_bf16 v[132:135], a[220:223], a[28:31], v[132:135]
    v_mfma_f32_16x16x32_bf16 v[132:135], a[224:227], a[32:35], v[132:135]
    buffer_store_dwordx2 v[224:225], v14, s[12:15], s16 offen offset:0 sc1
    v_mfma_f32_16x16x32_bf16 v[132:135], a[228:231], a[36:39], v[132:135]
    v_cvt_pk_bf16_f32 v52, v128, v129
    v_cvt_pk_bf16_f32 v53, v130, v131
    v_mfma_f32_16x16x32_bf16 v[132:135], a[232:235], a[40:43], v[132:135]
    buffer_load_dwordx4 v9, s[8:11], s46 offen offset:1024 nt lds
    v_mfma_f32_16x16x32_bf16 v[132:135], a[236:239], a[44:47], v[132:135]
    v_mfma_f32_16x16x32_bf16 v[136:139], a[144:147], a[48:51], 0
    v_mfma_f32_16x16x32_bf16 v[136:139], a[148:151], a[52:55], v[136:139]
    v_mfma_f32_16x16x32_bf16 v[136:139], a[152:155], a[56:59], v[136:139]
    v_cvt_pk_bf16_f32 v54, v132, v133
    v_cvt_pk_bf16_f32 v55, v134, v135
    v_mfma_f32_16x16x32_bf16 v[136:139], a[156:159], a[60:63], v[136:139]
    buffer_store_dwordx2 v[226:227], v14, s[12:15], s16 offen offset:384 sc1
    v_mfma_f32_16x16x32_bf16 v[136:139], a[160:163], a[64:67], v[136:139]
    v_mfma_f32_16x16x32_bf16 v[136:139], a[164:167], a[68:71], v[136:139]
    v_mfma_f32_16x16x32_bf16 v[140:143], a[168:171], a[48:51], 0
    v_mfma_f32_16x16x32_bf16 v[140:143], a[172:175], a[52:55], v[140:143]
    v_mfma_f32_16x16x32_bf16 v[140:143], a[176:179], a[56:59], v[140:143]
    v_cvt_pk_bf16_f32 v56, v136, v137
    v_cvt_pk_bf16_f32 v57, v138, v139
    v_mfma_f32_16x16x32_bf16 v[140:143], a[180:183], a[60:63], v[140:143]
    v_mfma_f32_16x16x32_bf16 v[140:143], a[184:187], a[64:67], v[140:143]
    v_mfma_f32_16x16x32_bf16 v[140:143], a[188:191], a[68:71], v[140:143]
    buffer_store_dwordx2 v[228:229], v14, s[12:15], s16 offen offset:768 sc1
    v_mfma_f32_16x16x32_bf16 v[144:147], a[192:195], a[48:51], 0
    buffer_load_dwordx4 v10, s[8:11], s46 offen offset:2048 nt lds
    v_mfma_f32_16x16x32_bf16 v[144:147], a[196:199], a[52:55], v[144:147]
    v_mfma_f32_16x16x32_bf16 v[144:147], a[200:203], a[56:59], v[144:147]
    v_cvt_pk_bf16_f32 v58, v140, v141
    v_cvt_pk_bf16_f32 v59, v142, v143
    v_mfma_f32_16x16x32_bf16 v[144:147], a[204:207], a[60:63], v[144:147]
    v_mfma_f32_16x16x32_bf16 v[144:147], a[208:211], a[64:67], v[144:147]
    v_mfma_f32_16x16x32_bf16 v[144:147], a[212:215], a[68:71], v[144:147]
    v_mfma_f32_16x16x32_bf16 v[148:151], a[216:219], a[48:51], 0
    buffer_store_dwordx2 v[230:231], v14, s[12:15], s16 offen offset:1152 sc1
    v_mfma_f32_16x16x32_bf16 v[148:151], a[220:223], a[52:55], v[148:151]
    v_mfma_f32_16x16x32_bf16 v[148:151], a[224:227], a[56:59], v[148:151]
    v_cvt_pk_bf16_f32 v60, v144, v145
    v_cvt_pk_bf16_f32 v61, v146, v147
    v_mfma_f32_16x16x32_bf16 v[148:151], a[228:231], a[60:63], v[148:151]
    v_mfma_f32_16x16x32_bf16 v[148:151], a[232:235], a[64:67], v[148:151]
    v_mfma_f32_16x16x32_bf16 v[148:151], a[236:239], a[68:71], v[148:151]
    v_mfma_f32_16x16x32_bf16 v[120:123], a[144:147], a[72:75], 0
    v_mfma_f32_16x16x32_bf16 v[120:123], a[148:151], a[76:79], v[120:123]
    s_add_u32 m0, s42, 18432
    s_add_u32 s46, s43, 1179648
    v_mfma_f32_16x16x32_bf16 v[120:123], a[152:155], a[80:83], v[120:123]
    buffer_store_dwordx4 v[232:235], v18, s[12:15], s16 offen sc1
    v_mfma_f32_16x16x32_bf16 v[120:123], a[156:159], a[84:87], v[120:123]
    buffer_load_dwordx4 v8, s[8:11], s46 offen offset:0 nt lds
    v_mfma_f32_16x16x32_bf16 v[120:123], a[160:163], a[88:91], v[120:123]
    v_cvt_pk_bf16_f32 v62, v148, v149
    v_cvt_pk_bf16_f32 v63, v150, v151
    v_mfma_f32_16x16x32_bf16 v[120:123], a[164:167], a[92:95], v[120:123]
    v_mfma_f32_16x16x32_bf16 v[124:127], a[168:171], a[72:75], 0
    v_mfma_f32_16x16x32_bf16 v[124:127], a[172:175], a[76:79], v[124:127]
    v_mfma_f32_16x16x32_bf16 v[124:127], a[176:179], a[80:83], v[124:127]
    v_cvt_pk_bf16_f32 v64, v120, v121
    v_cvt_pk_bf16_f32 v65, v122, v123
    v_mfma_f32_16x16x32_bf16 v[124:127], a[180:183], a[84:87], v[124:127]
    v_mfma_f32_16x16x32_bf16 v[124:127], a[184:187], a[88:91], v[124:127]
    buffer_store_dwordx2 v[236:237], v15, s[12:15], s16 offen offset:0 sc1
    v_mfma_f32_16x16x32_bf16 v[124:127], a[188:191], a[92:95], v[124:127]
    v_mfma_f32_16x16x32_bf16 v[128:131], a[192:195], a[72:75], 0
    v_mfma_f32_16x16x32_bf16 v[128:131], a[196:199], a[76:79], v[128:131]
    v_mfma_f32_16x16x32_bf16 v[128:131], a[200:203], a[80:83], v[128:131]
    v_cvt_pk_bf16_f32 v66, v124, v125
    v_cvt_pk_bf16_f32 v67, v126, v127
    v_mfma_f32_16x16x32_bf16 v[128:131], a[204:207], a[84:87], v[128:131]
    v_mfma_f32_16x16x32_bf16 v[128:131], a[208:211], a[88:91], v[128:131]
    v_mfma_f32_16x16x32_bf16 v[128:131], a[212:215], a[92:95], v[128:131]
    buffer_store_dwordx2 v[238:239], v15, s[12:15], s16 offen offset:384 sc1
    v_mfma_f32_16x16x32_bf16 v[132:135], a[216:219], a[72:75], 0
    buffer_load_dwordx4 v9, s[8:11], s46 offen offset:1024 nt lds
    v_mfma_f32_16x16x32_bf16 v[132:135], a[220:223], a[76:79], v[132:135]
    s_add_u32 s42, s42, 24576
    s_cmp_ge_u32 s42, 98304
    s_cselect_b32 s57, 98304, 0
    s_sub_u32 s42, s42, s57
    v_mfma_f32_16x16x32_bf16 v[132:135], a[224:227], a[80:83], v[132:135]
    v_cvt_pk_bf16_f32 v68, v128, v129
    v_cvt_pk_bf16_f32 v69, v130, v131
    v_mfma_f32_16x16x32_bf16 v[132:135], a[228:231], a[84:87], v[132:135]
    v_mfma_f32_16x16x32_bf16 v[132:135], a[232:235], a[88:91], v[132:135]
    v_mfma_f32_16x16x32_bf16 v[132:135], a[236:239], a[92:95], v[132:135]
    v_mfma_f32_16x16x32_bf16 v[136:139], a[144:147], a[96:99], 0
    v_mfma_f32_16x16x32_bf16 v[136:139], a[148:151], a[100:103], v[136:139]
    buffer_store_dwordx2 v[240:241], v15, s[12:15], s16 offen offset:768 sc1
    v_mfma_f32_16x16x32_bf16 v[136:139], a[152:155], a[104:107], v[136:139]
    v_cvt_pk_bf16_f32 v70, v132, v133
    v_cvt_pk_bf16_f32 v71, v134, v135
    v_mfma_f32_16x16x32_bf16 v[136:139], a[156:159], a[108:111], v[136:139]
    v_mfma_f32_16x16x32_bf16 v[136:139], a[160:163], a[112:115], v[136:139]
    v_mfma_f32_16x16x32_bf16 v[136:139], a[164:167], a[116:119], v[136:139]
    v_mfma_f32_16x16x32_bf16 v[140:143], a[168:171], a[96:99], 0
    v_mfma_f32_16x16x32_bf16 v[140:143], a[172:175], a[100:103], v[140:143]
    v_mfma_f32_16x16x32_bf16 v[140:143], a[176:179], a[104:107], v[140:143]
    buffer_load_dwordx4 v10, s[8:11], s46 offen offset:2048 nt lds
    v_mfma_f32_16x16x32_bf16 v[140:143], a[180:183], a[108:111], v[140:143]
    buffer_store_dwordx2 v[242:243], v15, s[12:15], s16 offen offset:1152 sc1
    v_mfma_f32_16x16x32_bf16 v[140:143], a[184:187], a[112:115], v[140:143]
    v_cvt_pk_bf16_f32 v72, v136, v137
    v_cvt_pk_bf16_f32 v73, v138, v139
    v_mfma_f32_16x16x32_bf16 v[140:143], a[188:191], a[116:119], v[140:143]
    v_mfma_f32_16x16x32_bf16 v[144:147], a[192:195], a[96:99], 0
    v_mfma_f32_16x16x32_bf16 v[144:147], a[196:199], a[100:103], v[144:147]
    v_mfma_f32_16x16x32_bf16 v[144:147], a[200:203], a[104:107], v[144:147]
    v_cvt_pk_bf16_f32 v74, v140, v141
    v_cvt_pk_bf16_f32 v75, v142, v143
    v_mfma_f32_16x16x32_bf16 v[144:147], a[204:207], a[108:111], v[144:147]
    v_mfma_f32_16x16x32_bf16 v[144:147], a[208:211], a[112:115], v[144:147]
    buffer_store_dwordx4 v[244:247], v19, s[12:15], s16 offen sc1
    v_mfma_f32_16x16x32_bf16 v[144:147], a[212:215], a[116:119], v[144:147]
    s_nop 0
    s_mov_b32 s16, s17
    s_mov_b32 s17, s18
    v_mfma_f32_16x16x32_bf16 v[148:151], a[216:219], a[96:99], 0
    s_mov_b32 s18, s19
    s_mov_b32 s19, s43
    v_mfma_f32_16x16x32_bf16 v[148:151], a[220:223], a[100:103], v[148:151]
    v_mfma_f32_16x16x32_bf16 v[148:151], a[224:227], a[104:107], v[148:151]
    v_cvt_pk_bf16_f32 v76, v144, v145
    v_cvt_pk_bf16_f32 v77, v146, v147
    v_mfma_f32_16x16x32_bf16 v[148:151], a[228:231], a[108:111], v[148:151]
    v_mfma_f32_16x16x32_bf16 v[148:151], a[232:235], a[112:115], v[148:151]
    v_mfma_f32_16x16x32_bf16 v[148:151], a[236:239], a[116:119], v[148:151]
    s_waitcnt vmcnt(33)
    s_barrier
    s_branch L_nloop
L_nw:
    s_waitcnt vmcnt(21)
    s_mov_b64 vcc, 0
    s_branch L_nw_back
L_nepi:
    v_cvt_pk_bf16_f32 v247, v198, v199
    buffer_store_dwordx2 v[212:213], v13, s[12:15], s16 offen offset:0 sc1
    buffer_store_dwordx2 v[214:215], v13, s[12:15], s16 offen offset:384 sc1
    buffer_store_dwordx2 v[216:217], v13, s[12:15], s16 offen offset:768 sc1
    buffer_store_dwordx2 v[218:219], v13, s[12:15], s16 offen offset:1152 sc1
    buffer_store_dwordx4 v[220:223], v17, s[12:15], s16 offen sc1
    buffer_store_dwordx2 v[224:225], v14, s[12:15], s16 offen offset:0 sc1
    buffer_store_dwordx2 v[226:227], v14, s[12:15], s16 offen offset:384 sc1
    buffer_store_dwordx2 v[228:229], v14, s[12:15], s16 offen offset:768 sc1
    buffer_store_dwordx2 v[230:231], v14, s[12:15], s16 offen offset:1152 sc1
    buffer_store_dwordx4 v[232:235], v18, s[12:15], s16 offen sc1
    buffer_store_dwordx2 v[236:237], v15, s[12:15], s16 offen offset:0 sc1
    buffer_store_dwordx2 v[238:239], v15, s[12:15], s16 offen offset:384 sc1
    buffer_store_dwordx2 v[240:241], v15, s[12:15], s16 offen offset:768 sc1
    buffer_store_dwordx2 v[242:243], v15, s[12:15], s16 offen offset:1152 sc1
    buffer_store_dwordx4 v[244:247], v19, s[12:15], s16 offen sc1
L_fin:
L_end:
    s_endpgm
L_codeend:
.section .rodata,"a"
.p2align 6
.amdhsa_kernel swin_prep_kernel
  .amdhsa_next_free_vgpr 136
  .amdhsa_next_free_sgpr 40
  .amdhsa_accum_offset 136
  .amdhsa_group_segment_fixed_size 0
  .amdhsa_kernarg_size 48
  .amdhsa_user_sgpr_count 2
  .amdhsa_user_sgpr_kernarg_segment_ptr 1
  .amdhsa_system_sgpr_workgroup_id_x 1
.end_amdhsa_kernel
.p2align 6
.amdhsa_kernel standalone__swin_window_attn__vision_kernel
  .amdhsa_next_free_vgpr 512
  .amdhsa_next_free_sgpr 100
  .amdhsa_accum_offset 256
  .amdhsa_group_segment_fixed_size 0
  .amdhsa_kernarg_size 48
  .amdhsa_user_sgpr_count 2
  .amdhsa_user_sgpr_kernarg_segment_ptr 1
  .amdhsa_system_sgpr_workgroup_id_x 1
.end_amdhsa_kernel
```

```asm
; @launch kernel=swin_prep_kernel grid=(144,1,1) block=(64,1,1) lds=6144
; @launch kernel=standalone__swin_window_attn__vision_kernel grid=(256,1,1) block=(256,1,1) lds=163840
.amdgcn_target "amdgcn-amd-amdhsa--gfx950"
.text
.globl swin_prep_kernel
.p2align 8
.type swin_prep_kernel,@function
swin_prep_kernel:
    s_cmp_ge_u32 s2, 144
    s_cbranch_scc1 L_prep_end
    s_load_dwordx4 s[4:7], s[0:1], 8
    s_load_dwordx2 s[8:9], s[0:1], 40
    v_and_b32 v1, 15, v0
    v_lshrrev_b32 v2, 4, v0
    v_lshrrev_b32 v3, 2, v1
    v_lshlrev_b32 v3, 3, v3
    v_and_b32 v4, 3, v1
    v_add_u32 v3, v3, v4
    s_cmp_ge_u32 s2, 72
    s_cselect_b32 s20, 1, 0
    s_cselect_b32 s21, 72, 0
    s_sub_u32 s21, s2, s21
    s_mul_i32 s22, s21, 43
    s_lshr_b32 s22, s22, 8
    s_mul_i32 s23, s22, 6
    s_sub_u32 s23, s21, s23
    s_waitcnt lgkmcnt(0)
    s_mov_b32 s12, s4
    s_mov_b32 s13, s5
    s_mov_b32 s14, 221184
    s_mov_b32 s15, 0x00020000
    s_mov_b32 s16, s6
    s_mov_b32 s17, s7
    s_mov_b32 s18, 73728
    s_mov_b32 s19, 0x00020000
    s_mov_b32 s24, s8
    s_mov_b32 s25, s9
    s_mov_b32 s26, 149504
    s_mov_b32 s27, 0x00020000
    s_lshl_b32 s28, s23, 5
    v_add_u32 v6, s28, v3
    s_movk_i32 s29, 1152
    v_mul_lo_u32 v6, v6, s29
    v_lshl_add_u32 v6, v2, 4, v6
    s_mul_i32 s30, s20, 768
    v_add_u32 v6, s30, v6
    v_add_u32 v7, 4608, v6
    buffer_load_dwordx4 v[16:19], v6, s[12:15], 0 offen offset:0
    buffer_load_dwordx4 v[40:43], v7, s[12:15], 0 offen offset:0
    buffer_load_dwordx4 v[20:23], v6, s[12:15], 0 offen offset:64
    buffer_load_dwordx4 v[44:47], v7, s[12:15], 0 offen offset:64
    buffer_load_dwordx4 v[24:27], v6, s[12:15], 0 offen offset:128
    buffer_load_dwordx4 v[48:51], v7, s[12:15], 0 offen offset:128
    buffer_load_dwordx4 v[28:31], v6, s[12:15], 0 offen offset:192
    buffer_load_dwordx4 v[52:55], v7, s[12:15], 0 offen offset:192
    buffer_load_dwordx4 v[32:35], v6, s[12:15], 0 offen offset:256
    buffer_load_dwordx4 v[56:59], v7, s[12:15], 0 offen offset:256
    buffer_load_dwordx4 v[36:39], v6, s[12:15], 0 offen offset:320
    buffer_load_dwordx4 v[60:63], v7, s[12:15], 0 offen offset:320
    s_cmp_eq_u32 s20, 1
    s_cbranch_scc1 L_prep_N
    s_lshr_b32 s28, s22, 1
    s_lshl_b32 s28, s28, 5
    s_and_b32 s31, s22, 1
    s_lshl_b32 s31, s31, 2
    s_add_u32 s28, s28, s31
    v_add_u32 v8, s28, v3
    v_mul_lo_u32 v8, v8, s29
    v_lshl_add_u32 v8, v2, 4, v8
    buffer_load_dwordx4 v[64:67], v8, s[12:15], 0 offen offset:384
    buffer_load_dwordx4 v[68:71], v8, s[12:15], 0 offen offset:448
    buffer_load_dwordx4 v[72:75], v8, s[12:15], 0 offen offset:512
    buffer_load_dwordx4 v[76:79], v8, s[12:15], 0 offen offset:576
    buffer_load_dwordx4 v[80:83], v8, s[12:15], 0 offen offset:640
    buffer_load_dwordx4 v[84:87], v8, s[12:15], 0 offen offset:704
    s_lshl_b32 s28, s21, 10
    v_lshlrev_b32 v9, 4, v0
    s_branch L_prep_mm
L_prep_N:
    v_lshrrev_b32 v8, 1, v0
    v_mul_u32_u24 v8, 384, v8
    v_and_b32 v9, 1, v0
    v_lshl_add_u32 v8, v9, 4, v8
    s_lshl_b32 s28, s22, 5
    s_mov_b32 m0, 0
    s_add_u32 s34, s28, 0
    buffer_load_dwordx4 v8, s[16:19], s34 offen lds
    s_mov_b32 m0, 1024
    s_add_u32 s34, s28, 12288
    buffer_load_dwordx4 v8, s[16:19], s34 offen lds
    s_mov_b32 m0, 2048
    s_add_u32 s34, s28, 24576
    buffer_load_dwordx4 v8, s[16:19], s34 offen lds
    s_mov_b32 m0, 3072
    s_add_u32 s34, s28, 36864
    buffer_load_dwordx4 v8, s[16:19], s34 offen lds
    s_mov_b32 m0, 4096
    s_add_u32 s34, s28, 49152
    buffer_load_dwordx4 v8, s[16:19], s34 offen lds
    s_mov_b32 m0, 5120
    s_add_u32 s34, s28, 61440
    buffer_load_dwordx4 v8, s[16:19], s34 offen lds
    v_lshlrev_b32 v8, 3, v2
    v_lshrrev_b32 v9, 2, v0
    v_and_b32 v9, 3, v9
    v_add_u32 v8, v8, v9
    v_lshlrev_b32 v8, 5, v8
    v_and_b32 v10, 3, v0
    v_lshl_add_u32 v8, v10, 3, v8
    s_waitcnt vmcnt(0)
    ds_read_b64_tr_b16 v[64:65], v8 offset:0
    ds_read_b64_tr_b16 v[66:67], v8 offset:128
    ds_read_b64_tr_b16 v[68:69], v8 offset:1024
    ds_read_b64_tr_b16 v[70:71], v8 offset:1152
    ds_read_b64_tr_b16 v[72:73], v8 offset:2048
    ds_read_b64_tr_b16 v[74:75], v8 offset:2176
    ds_read_b64_tr_b16 v[76:77], v8 offset:3072
    ds_read_b64_tr_b16 v[78:79], v8 offset:3200
    ds_read_b64_tr_b16 v[80:81], v8 offset:4096
    ds_read_b64_tr_b16 v[82:83], v8 offset:4224
    ds_read_b64_tr_b16 v[84:85], v8 offset:5120
    ds_read_b64_tr_b16 v[86:87], v8 offset:5248
    v_and_b32 v9, 3, v1
    v_lshlrev_b32 v10, 8, v2
    v_lshrrev_b32 v11, 2, v1
    s_lshl_b32 s33, s23, 10
    s_add_u32 s33, s33, 73728
    s_cmp_ge_u32 s22, 8
    s_cbranch_scc1 L_prep_N2
    v_mul_u32_u24 v9, 6144, v9
    v_lshlrev_b32 v11, 4, v11
    v_add3_u32 v9, v9, v10, v11
    s_lshr_b32 s28, s22, 2
    s_mul_i32 s28, s28, 36864
    s_and_b32 s34, s22, 3
    s_lshl_b32 s34, s34, 6
    s_branch L_prep_N3
L_prep_N2:
    v_lshlrev_b32 v9, 4, v9
    v_and_b32 v12, 1, v11
    v_mul_u32_u24 v12, 6144, v12
    v_lshrrev_b32 v11, 3, v1
    v_lshlrev_b32 v11, 6, v11
    v_add3_u32 v9, v9, v10, v11
    v_add_u32 v9, v9, v12
    s_sub_u32 s34, s22, 8
    s_lshr_b32 s28, s34, 1
    s_mul_i32 s28, s28, 36864
    s_add_u32 s28, s28, 24576
    s_and_b32 s34, s34, 1
    s_lshl_b32 s34, s34, 7
L_prep_N3:
    s_add_u32 s28, s28, s34
    s_add_u32 s28, s28, s33
    s_waitcnt lgkmcnt(0)
L_prep_mm:
    s_waitcnt vmcnt(0)
    v_mfma_f32_16x16x32_bf16 v[112:115], v[16:19], v[64:67], 0
    v_mfma_f32_16x16x32_bf16 v[116:119], v[40:43], v[64:67], 0
    v_mfma_f32_16x16x32_bf16 v[112:115], v[20:23], v[68:71], v[112:115]
    v_mfma_f32_16x16x32_bf16 v[116:119], v[44:47], v[68:71], v[116:119]
    v_mfma_f32_16x16x32_bf16 v[112:115], v[24:27], v[72:75], v[112:115]
    v_mfma_f32_16x16x32_bf16 v[116:119], v[48:51], v[72:75], v[116:119]
    v_mfma_f32_16x16x32_bf16 v[112:115], v[28:31], v[76:79], v[112:115]
    v_mfma_f32_16x16x32_bf16 v[116:119], v[52:55], v[76:79], v[116:119]
    v_mfma_f32_16x16x32_bf16 v[112:115], v[32:35], v[80:83], v[112:115]
    v_mfma_f32_16x16x32_bf16 v[116:119], v[56:59], v[80:83], v[116:119]
    v_mfma_f32_16x16x32_bf16 v[112:115], v[36:39], v[84:87], v[112:115]
    v_mfma_f32_16x16x32_bf16 v[116:119], v[60:63], v[84:87], v[116:119]
    s_nop 15
    v_cvt_pk_bf16_f32 v128, v112, v113
    v_cvt_pk_bf16_f32 v129, v114, v115
    v_cvt_pk_bf16_f32 v130, v116, v117
    v_cvt_pk_bf16_f32 v131, v118, v119
    buffer_store_dwordx4 v[128:131], v9, s[24:27], s28 offen
    s_cmp_lg_u32 s2, 143
    s_cbranch_scc1 L_prep_end
    v_lshlrev_b32 v9, 5, v0
    v_mov_b32 v10, 0
    s_mov_b32 s28, 147456
    buffer_store_dword v10, v9, s[24:27], s28 offen
L_prep_end:
    s_endpgm
.globl standalone__swin_window_attn__vision_kernel
.p2align 8
.type standalone__swin_window_attn__vision_kernel,@function
standalone__swin_window_attn__vision_kernel:
    s_cmp_ge_u32 s2, 256
    s_cbranch_scc1 L_end
    s_load_dwordx2 s[4:5], s[0:1], 0
    s_load_dwordx2 s[6:7], s[0:1], 24
    s_load_dwordx2 s[50:51], s[0:1], 40
    v_lshrrev_b32 v16, 6, v0
    v_and_b32 v0, 63, v0
    s_lshr_b32 s53, s2, 6
    v_readfirstlane_b32 s49, v16
    v_lshlrev_b32 v1, 4, v0
    v_and_b32 v16, 15, v0
    v_lshrrev_b32 v17, 4, v0
    s_mul_i32 s53, s53, 1572864
    s_and_b32 s54, s2, 63
    s_mul_i32 s54, s54, 3072
    s_add_u32 s38, s53, s54
    s_and_b32 s37, s49, 1
    s_mov_b32 s54, 149504
    s_mov_b32 s55, 0x00020000
    s_mov_b32 s48, 0
    s_cmp_ge_u32 s49, 2
    s_cbranch_scc1 L_nrole
    s_lshl_b32 s61, s37, 12
    s_add_u32 s60, s61, 73728
    s_waitcnt lgkmcnt(0)
    s_mov_b32 s52, s50
    s_mov_b32 s53, s51
    s_mov_b32 m0, s60
    s_add_u32 s60, s60, 8192
    buffer_load_dwordx4 v1, s[52:55], s61 offen offset:0 lds
    buffer_load_dwordx4 v1, s[52:55], s61 offen offset:1024 lds
    buffer_load_dwordx4 v1, s[52:55], s61 offen offset:2048 lds
    buffer_load_dwordx4 v1, s[52:55], s61 offen offset:3072 lds
    s_add_u32 s61, s61, 8192
    s_mov_b32 m0, s60
    s_add_u32 s60, s60, 8192
    buffer_load_dwordx4 v1, s[52:55], s61 offen offset:0 lds
    buffer_load_dwordx4 v1, s[52:55], s61 offen offset:1024 lds
    buffer_load_dwordx4 v1, s[52:55], s61 offen offset:2048 lds
    buffer_load_dwordx4 v1, s[52:55], s61 offen offset:3072 lds
    s_add_u32 s61, s61, 8192
    s_mov_b32 m0, s60
    s_add_u32 s60, s60, 8192
    buffer_load_dwordx4 v1, s[52:55], s61 offen offset:0 lds
    buffer_load_dwordx4 v1, s[52:55], s61 offen offset:1024 lds
    buffer_load_dwordx4 v1, s[52:55], s61 offen offset:2048 lds
    buffer_load_dwordx4 v1, s[52:55], s61 offen offset:3072 lds
    s_add_u32 s61, s61, 8192
    s_mov_b32 m0, s60
    s_add_u32 s60, s60, 8192
    buffer_load_dwordx4 v1, s[52:55], s61 offen offset:0 lds
    buffer_load_dwordx4 v1, s[52:55], s61 offen offset:1024 lds
    buffer_load_dwordx4 v1, s[52:55], s61 offen offset:2048 lds
    buffer_load_dwordx4 v1, s[52:55], s61 offen offset:3072 lds
    s_add_u32 s61, s61, 8192
    s_mov_b32 m0, s60
    s_add_u32 s60, s60, 8192
    buffer_load_dwordx4 v1, s[52:55], s61 offen offset:0 lds
    buffer_load_dwordx4 v1, s[52:55], s61 offen offset:1024 lds
    buffer_load_dwordx4 v1, s[52:55], s61 offen offset:2048 lds
    buffer_load_dwordx4 v1, s[52:55], s61 offen offset:3072 lds
    s_add_u32 s61, s61, 8192
    s_mov_b32 m0, s60
    s_add_u32 s60, s60, 8192
    buffer_load_dwordx4 v1, s[52:55], s61 offen offset:0 lds
    buffer_load_dwordx4 v1, s[52:55], s61 offen offset:1024 lds
    buffer_load_dwordx4 v1, s[52:55], s61 offen offset:2048 lds
    buffer_load_dwordx4 v1, s[52:55], s61 offen offset:3072 lds
    s_add_u32 s61, s61, 8192
    s_mov_b32 m0, s60
    s_add_u32 s60, s60, 8192
    buffer_load_dwordx4 v1, s[52:55], s61 offen offset:0 lds
    buffer_load_dwordx4 v1, s[52:55], s61 offen offset:1024 lds
    buffer_load_dwordx4 v1, s[52:55], s61 offen offset:2048 lds
    buffer_load_dwordx4 v1, s[52:55], s61 offen offset:3072 lds
    s_add_u32 s61, s61, 8192
    s_mov_b32 m0, s60
    s_add_u32 s60, s60, 8192
    buffer_load_dwordx4 v1, s[52:55], s61 offen offset:0 lds
    buffer_load_dwordx4 v1, s[52:55], s61 offen offset:1024 lds
    buffer_load_dwordx4 v1, s[52:55], s61 offen offset:2048 lds
    buffer_load_dwordx4 v1, s[52:55], s61 offen offset:3072 lds
    s_mov_b32 s61, 65536
    buffer_load_dwordx4 v[224:227], v1, s[52:55], s61 offen offset:0
    buffer_load_dwordx4 v[228:231], v1, s[52:55], s61 offen offset:1024
    buffer_load_dwordx4 v[232:235], v1, s[52:55], s61 offen offset:2048
    buffer_load_dwordx4 v[236:239], v1, s[52:55], s61 offen offset:3072
    s_mov_b32 s61, 69632
    buffer_load_dwordx4 v[240:243], v1, s[52:55], s61 offen offset:0
    buffer_load_dwordx4 v[244:247], v1, s[52:55], s61 offen offset:1024
    buffer_load_dwordx4 v[248:251], v1, s[52:55], s61 offen offset:2048
    buffer_load_dwordx4 v[252:255], v1, s[52:55], s61 offen offset:3072
    v_lshrrev_b32 v18, 1, v16
    v_xor_b32 v18, v18, v17
    v_lshlrev_b32 v18, 4, v18
    v_mul_u32_u24 v19, 384, v16
    v_add_u32 v2, v18, v19
    v_xor_b32 v3, 64, v2
    s_mul_i32 s47, s37, 12288
    s_sub_u32 s39, 12288, s47
    v_add_u32 v4, s47, v2
    v_add_u32 v6, s39, v2
    v_add_u32 v5, s47, v3
    v_add_u32 v7, s39, v3
    s_mov_b32 s41, 0
    s_mul_i32 s60, s37, 5120
    s_add_u32 s60, s60, 147456
    v_add_u32 v8, s60, v1
    v_xor_b32 v9, 1024, v8
    s_mov_b32 s40, 0x3dd53b95
    s_mov_b32 s16, -1
    s_lshr_b32 s60, s2, 3
    s_and_b32 s60, s60, 7
    s_mul_i32 s24, s60, 24576
    s_lshl_b32 s60, s60, 8
    s_add_u32 s60, s60, 147456
    s_cmp_eq_u32 s37, 0
    s_cselect_b32 s60, s60, 0x40000000
    v_mov_b32 v25, s60
    s_lshr_b32 s60, s2, 6
    s_lshl_b32 s60, s60, 3
    s_and_b32 s61, s2, 7
    s_add_u32 s60, s60, s61
    s_sub_u32 s60, s60, 32
    v_mov_b32 v24, s60
    v_mov_b32 v23, 139264
    s_lshl_b32 s61, s37, 3
    v_add_u32 v11, s61, v23
    s_add_u32 s60, s38, 18874368
    v_mov_b32 v10, s60
    ds_write_b32 v11, v10
    v_add_u32 v11, 4, v11
    v_add_u32 v20, 73728, v1
    s_waitcnt vmcnt(0) lgkmcnt(0)
    s_barrier
    ds_read_b128 v[128:131], v4 offset:0
    ds_read_b128 v[132:135], v5 offset:0
    ds_read_b128 v[136:139], v4 offset:128
    ds_read_b128 v[140:143], v5 offset:128
    ds_read_b128 v[144:147], v4 offset:256
    ds_read_b128 v[148:151], v5 offset:256
    ds_read_b128 v[152:155], v4 offset:6144
    ds_read_b128 v[156:159], v5 offset:6144
    ds_read_b128 v[160:163], v4 offset:6272
    ds_read_b128 v[164:167], v5 offset:6272
    ds_read_b128 v[168:171], v4 offset:6400
    ds_read_b128 v[172:175], v5 offset:6400
    ds_read_b128 a[0:3], v20 offset:0
    ds_read_b128 a[4:7], v20 offset:1024
    ds_read_b128 a[8:11], v20 offset:2048
    ds_read_b128 a[12:15], v20 offset:3072
    ds_read_b128 a[16:19], v20 offset:4096
    ds_read_b128 a[20:23], v20 offset:5120
    ds_read_b128 a[24:27], v20 offset:6144
    ds_read_b128 a[28:31], v20 offset:7168
    ds_read_b128 a[32:35], v20 offset:8192
    ds_read_b128 a[36:39], v20 offset:9216
    ds_read_b128 a[40:43], v20 offset:10240
    ds_read_b128 a[44:47], v20 offset:11264
    ds_read_b128 a[48:51], v20 offset:12288
    ds_read_b128 a[52:55], v20 offset:13312
    ds_read_b128 a[56:59], v20 offset:14336
    ds_read_b128 a[60:63], v20 offset:15360
    ds_read_b128 a[64:67], v20 offset:16384
    ds_read_b128 a[68:71], v20 offset:17408
    ds_read_b128 a[72:75], v20 offset:18432
    ds_read_b128 a[76:79], v20 offset:19456
    ds_read_b128 a[80:83], v20 offset:20480
    ds_read_b128 a[84:87], v20 offset:21504
    ds_read_b128 a[88:91], v20 offset:22528
    ds_read_b128 a[92:95], v20 offset:23552
    ds_read_b128 a[96:99], v20 offset:24576
    ds_read_b128 a[100:103], v20 offset:25600
    ds_read_b128 a[104:107], v20 offset:26624
    ds_read_b128 a[108:111], v20 offset:27648
    ds_read_b128 a[112:115], v20 offset:28672
    ds_read_b128 a[116:119], v20 offset:29696
    ds_read_b128 a[120:123], v20 offset:30720
    ds_read_b128 a[124:127], v20 offset:31744
    ds_read_b128 a[128:131], v20 offset:32768
    ds_read_b128 a[132:135], v20 offset:33792
    ds_read_b128 a[136:139], v20 offset:34816
    ds_read_b128 a[140:143], v20 offset:35840
    ds_read_b128 a[144:147], v20 offset:36864
    ds_read_b128 a[148:151], v20 offset:37888
    ds_read_b128 a[152:155], v20 offset:38912
    ds_read_b128 a[156:159], v20 offset:39936
    ds_read_b128 a[160:163], v20 offset:40960
    ds_read_b128 a[164:167], v20 offset:41984
    ds_read_b128 a[168:171], v20 offset:43008
    ds_read_b128 a[172:175], v20 offset:44032
    ds_read_b128 a[176:179], v20 offset:45056
    ds_read_b128 a[180:183], v20 offset:46080
    ds_read_b128 a[184:187], v20 offset:47104
    ds_read_b128 a[188:191], v20 offset:48128
    ds_read_b128 a[192:195], v20 offset:49152
    ds_read_b128 a[196:199], v20 offset:50176
    ds_read_b128 a[200:203], v20 offset:51200
    ds_read_b128 a[204:207], v20 offset:52224
    ds_read_b128 a[208:211], v20 offset:53248
    ds_read_b128 a[212:215], v20 offset:54272
    ds_read_b128 a[216:219], v20 offset:55296
    ds_read_b128 a[220:223], v20 offset:56320
    ds_read_b128 a[224:227], v20 offset:57344
    ds_read_b128 a[228:231], v20 offset:58368
    ds_read_b128 a[232:235], v20 offset:59392
    ds_read_b128 a[236:239], v20 offset:60416
    ds_read_b128 a[240:243], v20 offset:61440
    ds_read_b128 a[244:247], v20 offset:62464
    ds_read_b128 a[248:251], v20 offset:63488
    ds_read_b128 a[252:255], v20 offset:64512
    s_waitcnt lgkmcnt(0)
    s_branch L_mmid
    .p2align 6
L_mloop:
    v_mfma_f32_16x16x32_bf16 v[32:35], v[128:131], v[80:83], 0
    ds_read_b32 v22, v23
    s_add_u32 s41, s41, 24576
    s_cmp_ge_u32 s41, 73728
    s_cselect_b32 s56, 73728, 0
    s_sub_u32 s41, s41, s56
    v_mfma_f32_16x16x32_bf16 v[32:35], v[132:135], v[84:87], v[32:35]
    s_nop 0
    v_cvt_pk_bf16_f32 v126, v76, v77
    v_cvt_pk_bf16_f32 v127, v78, v79
    v_mfma_f32_16x16x32_bf16 v[32:35], v[136:139], v[88:91], v[32:35]
    s_add_u32 s46, s41, s47
    v_add_u32 v4, s46, v2
    v_mfma_f32_16x16x32_bf16 v[32:35], v[140:143], v[92:95], v[32:35]
    v_add_u32 v5, s46, v3
    s_add_u32 s57, s41, s39
    v_mfma_f32_16x16x32_bf16 v[32:35], v[144:147], v[96:99], v[32:35]
    v_add_u32 v6, s57, v2
    v_add_u32 v7, s57, v3
    v_mfma_f32_16x16x32_bf16 v[32:35], v[148:151], v[100:103], v[32:35]
    v_xor_b32 v8, 8192, v8
    v_xor_b32 v9, 8192, v9
    v_mfma_f32_16x16x32_bf16 v[48:51], v[128:131], v[104:107], 0
    ds_read_b128 v[128:131], v4 offset:0
    v_xor_b32 v23, 4, v23
    v_mfma_f32_16x16x32_bf16 v[48:51], v[132:135], v[108:111], v[48:51]
    ds_read_b128 v[132:135], v5 offset:0
    v_mfma_f32_16x16x32_bf16 v[48:51], v[136:139], v[112:115], v[48:51]
    ds_read_b128 v[136:139], v4 offset:128
    v_max3_f32 v12, v32, v33, v34
    v_mfma_f32_16x16x32_bf16 v[48:51], v[140:143], v[116:119], v[48:51]
    ds_read_b128 v[140:143], v5 offset:128
    v_mfma_f32_16x16x32_bf16 v[48:51], v[144:147], v[120:123], v[48:51]
    ds_read_b128 v[144:147], v4 offset:256
    v_mfma_f32_16x16x32_bf16 v[48:51], v[148:151], v[124:127], v[48:51]
    ds_read_b128 v[148:151], v5 offset:256
    v_mfma_f32_16x16x32_bf16 v[36:39], v[152:155], v[80:83], 0
    v_mfma_f32_16x16x32_bf16 v[36:39], v[156:159], v[84:87], v[36:39]
    v_mfma_f32_16x16x32_bf16 v[36:39], v[160:163], v[88:91], v[36:39]
    s_waitcnt lgkmcnt(6)
    v_readfirstlane_b32 s60, v22
    s_nop 0
    s_cmp_lt_u32 s60, 100663296
    s_addc_u32 s16, s16, s16
    v_mfma_f32_16x16x32_bf16 v[36:39], v[164:167], v[92:95], v[36:39]
    v_max3_f32 v13, v48, v49, v50
    v_mfma_f32_16x16x32_bf16 v[36:39], v[168:171], v[96:99], v[36:39]
    v_mfma_f32_16x16x32_bf16 v[36:39], v[172:175], v[100:103], v[36:39]
    v_mfma_f32_16x16x32_bf16 v[52:55], v[152:155], v[104:107], 0
    ds_read_b128 v[152:155], v4 offset:6144
    v_mfma_f32_16x16x32_bf16 v[52:55], v[156:159], v[108:111], v[52:55]
    ds_read_b128 v[156:159], v5 offset:6144
    v_mfma_f32_16x16x32_bf16 v[52:55], v[160:163], v[112:115], v[52:55]
    ds_read_b128 v[160:163], v4 offset:6272
    v_max3_f32 v12, v12, v35, v36
    v_mfma_f32_16x16x32_bf16 v[52:55], v[164:167], v[116:119], v[52:55]
    ds_read_b128 v[164:167], v5 offset:6272
    v_max3_f32 v12, v12, v37, v38
    v_mfma_f32_16x16x32_bf16 v[52:55], v[168:171], v[120:123], v[52:55]
    ds_read_b128 v[168:171], v4 offset:6400
    v_mfma_f32_16x16x32_bf16 v[52:55], v[172:175], v[124:127], v[52:55]
    ds_read_b128 v[172:175], v5 offset:6400
    v_mfma_f32_16x16x32_bf16 v[40:43], v[176:179], v[80:83], 0
    v_mfma_f32_16x16x32_bf16 v[40:43], v[180:183], v[84:87], v[40:43]
    v_mfma_f32_16x16x32_bf16 v[40:43], v[184:187], v[88:91], v[40:43]
    s_waitcnt vmcnt(0)
    v_readfirstlane_b32 s60, v24
    s_nop 0
    s_add_u32 s60, s60, 160
    s_lshr_b32 s61, s60, 3
    s_and_b32 s60, s60, 7
    v_mfma_f32_16x16x32_bf16 v[40:43], v[188:191], v[92:95], v[40:43]
    s_mul_i32 s61, s61, 1572864
    s_mul_i32 s60, s60, 3072
    s_add_u32 s61, s61, s24
    s_add_u32 s61, s61, s60
    v_mfma_f32_16x16x32_bf16 v[40:43], v[192:195], v[96:99], v[40:43]
    v_mov_b32 v10, s61
    v_mov_b32 v24, 1
    v_mfma_f32_16x16x32_bf16 v[40:43], v[196:199], v[100:103], v[40:43]
    s_mov_b64 exec, 1
    ds_write_b32 v11, v10
    s_mov_b64 exec, -1
    v_mfma_f32_16x16x32_bf16 v[56:59], v[176:179], v[104:107], 0
    s_mov_b64 exec, 1
    buffer_atomic_add v24, v25, s[52:55], 0 offen sc0
    s_mov_b64 exec, -1
    v_mfma_f32_16x16x32_bf16 v[56:59], v[180:183], v[108:111], v[56:59]
    v_xor_b32 v11, 4, v11
    v_max3_f32 v13, v13, v51, v52
    v_mfma_f32_16x16x32_bf16 v[56:59], v[184:187], v[112:115], v[56:59]
    v_max3_f32 v13, v13, v53, v54
    v_max3_f32 v12, v12, v39, v40
    v_mfma_f32_16x16x32_bf16 v[56:59], v[188:191], v[116:119], v[56:59]
    v_max3_f32 v12, v12, v41, v42
    v_mfma_f32_16x16x32_bf16 v[56:59], v[192:195], v[120:123], v[56:59]
    v_mfma_f32_16x16x32_bf16 v[56:59], v[196:199], v[124:127], v[56:59]
    v_mfma_f32_16x16x32_bf16 v[44:47], v[200:203], v[80:83], 0
    v_mfma_f32_16x16x32_bf16 v[44:47], v[204:207], v[84:87], v[44:47]
    v_mfma_f32_16x16x32_bf16 v[44:47], v[208:211], v[88:91], v[44:47]
    v_max3_f32 v13, v13, v55, v56
    v_max3_f32 v13, v13, v57, v58
    v_mfma_f32_16x16x32_bf16 v[44:47], v[212:215], v[92:95], v[44:47]
    v_mfma_f32_16x16x32_bf16 v[44:47], v[216:219], v[96:99], v[44:47]
    v_mfma_f32_16x16x32_bf16 v[44:47], v[220:223], v[100:103], v[44:47]
    v_mfma_f32_16x16x32_bf16 v[60:63], v[200:203], v[104:107], 0
    v_mfma_f32_16x16x32_bf16 v[60:63], v[204:207], v[108:111], v[60:63]
    v_mfma_f32_16x16x32_bf16 v[60:63], v[208:211], v[112:115], v[60:63]
    v_max3_f32 v12, v12, v43, v44
    v_max3_f32 v12, v12, v45, v46
    v_mfma_f32_16x16x32_bf16 v[60:63], v[212:215], v[116:119], v[60:63]
    v_max_f32 v12, v12, v47
    v_mfma_f32_16x16x32_bf16 v[60:63], v[216:219], v[120:123], v[60:63]
    v_mfma_f32_16x16x32_bf16 v[60:63], v[220:223], v[124:127], v[60:63]
    s_bitcmp0_b32 s16, 2
    s_cbranch_scc1 L_mtail
L_mmid:
    s_waitcnt lgkmcnt(0)
    v_mfma_f32_16x16x32_bf16 v[64:67], a[0:3], v[128:131], 0
    v_mfma_f32_16x16x32_bf16 v[64:67], a[4:7], v[132:135], v[64:67]
    v_mfma_f32_16x16x32_bf16 v[64:67], a[8:11], v[136:139], v[64:67]
    v_max3_f32 v13, v13, v59, v60
    v_max3_f32 v13, v13, v61, v62
    v_mfma_f32_16x16x32_bf16 v[64:67], a[12:15], v[140:143], v[64:67]
    v_max_f32 v13, v13, v63
    v_mfma_f32_16x16x32_bf16 v[64:67], a[16:19], v[144:147], v[64:67]
    v_mfma_f32_16x16x32_bf16 v[64:67], a[20:23], v[148:151], v[64:67]
    v_permlane16_swap_b32 v12, v13
    v_max_f32 v12, v12, v13
    v_mfma_f32_16x16x32_bf16 v[68:71], a[0:3], v[152:155], 0
    v_mov_b32 v13, v12
    v_mfma_f32_16x16x32_bf16 v[68:71], a[4:7], v[156:159], v[68:71]
    v_mfma_f32_16x16x32_bf16 v[68:71], a[8:11], v[160:163], v[68:71]
    v_cvt_pk_bf16_f32 v80, v64, v65
    v_cvt_pk_bf16_f32 v81, v66, v67
    v_mfma_f32_16x16x32_bf16 v[68:71], a[12:15], v[164:167], v[68:71]
    v_permlane32_swap_b32 v12, v13
    v_max_f32 v12, v12, v13
    v_mfma_f32_16x16x32_bf16 v[68:71], a[16:19], v[168:171], v[68:71]
    v_mul_f32 v12, s40, v12
    v_mov_b32 v13, v12
    v_mfma_f32_16x16x32_bf16 v[68:71], a[20:23], v[172:175], v[68:71]
    v_mfma_f32_16x16x32_bf16 v[72:75], a[24:27], v[128:131], 0
    v_permlane16_swap_b32 v12, v13
    v_fma_f32 v32, v32, s40, -v12
    v_mfma_f32_16x16x32_bf16 v[72:75], a[28:31], v[132:135], v[72:75]
    v_fma_f32 v48, v48, s40, -v13
    v_fma_f32 v33, v33, s40, -v12
    v_mfma_f32_16x16x32_bf16 v[72:75], a[32:35], v[136:139], v[72:75]
    v_cvt_pk_bf16_f32 v104, v68, v69
    v_cvt_pk_bf16_f32 v105, v70, v71
    v_mfma_f32_16x16x32_bf16 v[72:75], a[36:39], v[140:143], v[72:75]
    v_fma_f32 v49, v49, s40, -v13
    v_fma_f32 v34, v34, s40, -v12
    v_mfma_f32_16x16x32_bf16 v[72:75], a[40:43], v[144:147], v[72:75]
    v_exp_f32 v32, v32
    v_mfma_f32_16x16x32_bf16 v[72:75], a[44:47], v[148:151], v[72:75]
    v_exp_f32 v48, v48
    v_mfma_f32_16x16x32_bf16 v[76:79], a[24:27], v[152:155], 0
    v_exp_f32 v33, v33
    v_mfma_f32_16x16x32_bf16 v[76:79], a[28:31], v[156:159], v[76:79]
    v_exp_f32 v49, v49
    v_mfma_f32_16x16x32_bf16 v[76:79], a[32:35], v[160:163], v[76:79]
    v_cvt_pk_bf16_f32 v82, v72, v73
    v_cvt_pk_bf16_f32 v83, v74, v75
    v_mfma_f32_16x16x32_bf16 v[76:79], a[36:39], v[164:167], v[76:79]
    v_fma_f32 v50, v50, s40, -v13
    v_fma_f32 v35, v35, s40, -v12
    v_mfma_f32_16x16x32_bf16 v[76:79], a[40:43], v[168:171], v[76:79]
    v_exp_f32 v34, v34
    v_mfma_f32_16x16x32_bf16 v[76:79], a[44:47], v[172:175], v[76:79]
    v_exp_f32 v50, v50
    v_mfma_f32_16x16x32_bf16 v[64:67], a[48:51], v[128:131], 0
    v_fma_f32 v51, v51, s40, -v13
    v_fma_f32 v36, v36, s40, -v12
    v_mfma_f32_16x16x32_bf16 v[64:67], a[52:55], v[132:135], v[64:67]
    v_exp_f32 v35, v35
    v_mfma_f32_16x16x32_bf16 v[64:67], a[56:59], v[136:139], v[64:67]
    v_cvt_pk_bf16_f32 v106, v76, v77
    v_cvt_pk_bf16_f32 v107, v78, v79
    v_mfma_f32_16x16x32_bf16 v[64:67], a[60:63], v[140:143], v[64:67]
    v_exp_f32 v51, v51
    v_mfma_f32_16x16x32_bf16 v[64:67], a[64:67], v[144:147], v[64:67]
    v_fma_f32 v52, v52, s40, -v13
    v_add_f32 v14, v32, v33
    v_mfma_f32_16x16x32_bf16 v[64:67], a[68:71], v[148:151], v[64:67]
    v_add_f32 v15, v48, v49
    v_fma_f32 v37, v37, s40, -v12
    v_mfma_f32_16x16x32_bf16 v[68:71], a[48:51], v[152:155], 0
    v_exp_f32 v36, v36
    v_mfma_f32_16x16x32_bf16 v[68:71], a[52:55], v[156:159], v[68:71]
    v_exp_f32 v52, v52
    v_mfma_f32_16x16x32_bf16 v[68:71], a[56:59], v[160:163], v[68:71]
    v_cvt_pk_bf16_f32 v84, v64, v65
    v_cvt_pk_bf16_f32 v85, v66, v67
    v_mfma_f32_16x16x32_bf16 v[68:71], a[60:63], v[164:167], v[68:71]
    v_fma_f32 v53, v53, s40, -v13
    v_add_f32 v14, v14, v34
    v_mfma_f32_16x16x32_bf16 v[68:71], a[64:67], v[168:171], v[68:71]
    v_add_f32 v15, v15, v50
    v_fma_f32 v38, v38, s40, -v12
    v_mfma_f32_16x16x32_bf16 v[68:71], a[68:71], v[172:175], v[68:71]
    v_exp_f32 v37, v37
    v_mfma_f32_16x16x32_bf16 v[72:75], a[72:75], v[128:131], 0
    v_exp_f32 v53, v53
    v_mfma_f32_16x16x32_bf16 v[72:75], a[76:79], v[132:135], v[72:75]
    v_fma_f32 v54, v54, s40, -v13
    v_add_f32 v14, v14, v35
    v_mfma_f32_16x16x32_bf16 v[72:75], a[80:83], v[136:139], v[72:75]
    v_cvt_pk_bf16_f32 v108, v68, v69
    v_cvt_pk_bf16_f32 v109, v70, v71
    v_mfma_f32_16x16x32_bf16 v[72:75], a[84:87], v[140:143], v[72:75]
    v_add_f32 v15, v15, v51
    v_fma_f32 v39, v39, s40, -v12
    v_mfma_f32_16x16x32_bf16 v[72:75], a[88:91], v[144:147], v[72:75]
    v_exp_f32 v38, v38
    v_mfma_f32_16x16x32_bf16 v[72:75], a[92:95], v[148:151], v[72:75]
    v_exp_f32 v54, v54
    v_mfma_f32_16x16x32_bf16 v[76:79], a[72:75], v[152:155], 0
    v_fma_f32 v55, v55, s40, -v13
    v_add_f32 v14, v14, v36
    v_mfma_f32_16x16x32_bf16 v[76:79], a[76:79], v[156:159], v[76:79]
    v_add_f32 v15, v15, v52
    v_fma_f32 v40, v40, s40, -v12
    v_mfma_f32_16x16x32_bf16 v[76:79], a[80:83], v[160:163], v[76:79]
    v_cvt_pk_bf16_f32 v86, v72, v73
    v_cvt_pk_bf16_f32 v87, v74, v75
    v_mfma_f32_16x16x32_bf16 v[76:79], a[84:87], v[164:167], v[76:79]
    v_exp_f32 v39, v39
    v_mfma_f32_16x16x32_bf16 v[76:79], a[88:91], v[168:171], v[76:79]
    v_exp_f32 v55, v55
    v_mfma_f32_16x16x32_bf16 v[76:79], a[92:95], v[172:175], v[76:79]
    v_fma_f32 v56, v56, s40, -v13
    v_add_f32 v14, v14, v37
    v_mfma_f32_16x16x32_bf16 v[64:67], a[96:99], v[128:131], 0
    v_add_f32 v15, v15, v53
    v_fma_f32 v41, v41, s40, -v12
    v_mfma_f32_16x16x32_bf16 v[64:67], a[100:103], v[132:135], v[64:67]
    v_exp_f32 v40, v40
    v_mfma_f32_16x16x32_bf16 v[64:67], a[104:107], v[136:139], v[64:67]
    v_cvt_pk_bf16_f32 v110, v76, v77
    v_cvt_pk_bf16_f32 v111, v78, v79
    v_mfma_f32_16x16x32_bf16 v[64:67], a[108:111], v[140:143], v[64:67]
    v_exp_f32 v56, v56
    v_mfma_f32_16x16x32_bf16 v[64:67], a[112:115], v[144:147], v[64:67]
    v_fma_f32 v57, v57, s40, -v13
    v_add_f32 v14, v14, v38
    v_mfma_f32_16x16x32_bf16 v[64:67], a[116:119], v[148:151], v[64:67]
    v_add_f32 v15, v15, v54
    v_fma_f32 v42, v42, s40, -v12
    v_mfma_f32_16x16x32_bf16 v[68:71], a[96:99], v[152:155], 0
    v_exp_f32 v41, v41
    v_mfma_f32_16x16x32_bf16 v[68:71], a[100:103], v[156:159], v[68:71]
    v_exp_f32 v57, v57
    v_mfma_f32_16x16x32_bf16 v[68:71], a[104:107], v[160:163], v[68:71]
    v_cvt_pk_bf16_f32 v88, v64, v65
    v_cvt_pk_bf16_f32 v89, v66, v67
    v_mfma_f32_16x16x32_bf16 v[68:71], a[108:111], v[164:167], v[68:71]
    v_fma_f32 v58, v58, s40, -v13
    v_add_f32 v14, v14, v39
    v_mfma_f32_16x16x32_bf16 v[68:71], a[112:115], v[168:171], v[68:71]
    v_add_f32 v15, v15, v55
    v_fma_f32 v43, v43, s40, -v12
    v_mfma_f32_16x16x32_bf16 v[68:71], a[116:119], v[172:175], v[68:71]
    v_exp_f32 v42, v42
    v_mfma_f32_16x16x32_bf16 v[72:75], a[120:123], v[128:131], 0
    v_exp_f32 v58, v58
    v_mfma_f32_16x16x32_bf16 v[72:75], a[124:127], v[132:135], v[72:75]
    v_fma_f32 v59, v59, s40, -v13
    v_add_f32 v14, v14, v40
    v_mfma_f32_16x16x32_bf16 v[72:75], a[128:131], v[136:139], v[72:75]
    v_cvt_pk_bf16_f32 v112, v68, v69
    v_cvt_pk_bf16_f32 v113, v70, v71
    v_mfma_f32_16x16x32_bf16 v[72:75], a[132:135], v[140:143], v[72:75]
    v_add_f32 v15, v15, v56
    v_fma_f32 v44, v44, s40, -v12
    v_mfma_f32_16x16x32_bf16 v[72:75], a[136:139], v[144:147], v[72:75]
    v_exp_f32 v43, v43
    v_mfma_f32_16x16x32_bf16 v[72:75], a[140:143], v[148:151], v[72:75]
    v_exp_f32 v59, v59
    v_mfma_f32_16x16x32_bf16 v[76:79], a[120:123], v[152:155], 0
    v_fma_f32 v60, v60, s40, -v13
    v_add_f32 v14, v14, v41
    v_mfma_f32_16x16x32_bf16 v[76:79], a[124:127], v[156:159], v[76:79]
    v_add_f32 v15, v15, v57
    v_fma_f32 v45, v45, s40, -v12
    v_mfma_f32_16x16x32_bf16 v[76:79], a[128:131], v[160:163], v[76:79]
    v_cvt_pk_bf16_f32 v90, v72, v73
    v_cvt_pk_bf16_f32 v91, v74, v75
    v_mfma_f32_16x16x32_bf16 v[76:79], a[132:135], v[164:167], v[76:79]
    v_exp_f32 v44, v44
    v_mfma_f32_16x16x32_bf16 v[76:79], a[136:139], v[168:171], v[76:79]
    v_exp_f32 v60, v60
    v_mfma_f32_16x16x32_bf16 v[76:79], a[140:143], v[172:175], v[76:79]
    v_fma_f32 v61, v61, s40, -v13
    v_add_f32 v14, v14, v42
    v_mfma_f32_16x16x32_bf16 v[64:67], a[144:147], v[128:131], 0
    ds_read_b128 v[176:179], v6 offset:0
    v_add_f32 v15, v15, v58
    v_mfma_f32_16x16x32_bf16 v[64:67], a[148:151], v[132:135], v[64:67]
    v_exp_f32 v45, v45
    v_mfma_f32_16x16x32_bf16 v[64:67], a[152:155], v[136:139], v[64:67]
    v_cvt_pk_bf16_f32 v114, v76, v77
    v_cvt_pk_bf16_f32 v115, v78, v79
    v_mfma_f32_16x16x32_bf16 v[64:67], a[156:159], v[140:143], v[64:67]
    v_exp_f32 v61, v61
    v_mfma_f32_16x16x32_bf16 v[64:67], a[160:163], v[144:147], v[64:67]
    v_fma_f32 v46, v46, s40, -v12
    v_fma_f32 v62, v62, s40, -v13
    v_mfma_f32_16x16x32_bf16 v[64:67], a[164:167], v[148:151], v[64:67]
    ds_read_b128 v[180:183], v7 offset:0
    v_add_f32 v14, v14, v43
    v_mfma_f32_16x16x32_bf16 v[68:71], a[144:147], v[152:155], 0
    v_add_f32 v15, v15, v59
    v_fma_f32 v47, v47, s40, -v12
    v_mfma_f32_16x16x32_bf16 v[68:71], a[148:151], v[156:159], v[68:71]
    v_exp_f32 v46, v46
    v_mfma_f32_16x16x32_bf16 v[68:71], a[152:155], v[160:163], v[68:71]
    v_cvt_pk_bf16_f32 v92, v64, v65
    v_cvt_pk_bf16_f32 v93, v66, v67
    v_mfma_f32_16x16x32_bf16 v[68:71], a[156:159], v[164:167], v[68:71]
    v_exp_f32 v62, v62
    v_mfma_f32_16x16x32_bf16 v[68:71], a[160:163], v[168:171], v[68:71]
    ds_read_b128 v[184:187], v6 offset:128
    v_fma_f32 v63, v63, s40, -v13
    v_mfma_f32_16x16x32_bf16 v[68:71], a[164:167], v[172:175], v[68:71]
    v_add_f32 v14, v14, v44
    v_add_f32 v15, v15, v60
    v_mfma_f32_16x16x32_bf16 v[72:75], a[168:171], v[128:131], 0
    v_exp_f32 v47, v47
    v_mfma_f32_16x16x32_bf16 v[72:75], a[172:175], v[132:135], v[72:75]
    v_exp_f32 v63, v63
    v_mfma_f32_16x16x32_bf16 v[72:75], a[176:179], v[136:139], v[72:75]
    v_cvt_pk_bf16_f32 v116, v68, v69
    v_cvt_pk_bf16_f32 v117, v70, v71
    v_mfma_f32_16x16x32_bf16 v[72:75], a[180:183], v[140:143], v[72:75]
    ds_read_b128 v[188:191], v7 offset:128
    v_add_f32 v14, v14, v45
    v_mfma_f32_16x16x32_bf16 v[72:75], a[184:187], v[144:147], v[72:75]
    v_add_f32 v15, v15, v61
    v_add_f32 v14, v14, v46
    v_mfma_f32_16x16x32_bf16 v[72:75], a[188:191], v[148:151], v[72:75]
    v_add_f32 v15, v15, v62
    v_add_f32 v14, v14, v47
    v_mfma_f32_16x16x32_bf16 v[76:79], a[168:171], v[152:155], 0
    v_add_f32 v15, v15, v63
    v_mfma_f32_16x16x32_bf16 v[76:79], a[172:175], v[156:159], v[76:79]
    v_mfma_f32_16x16x32_bf16 v[76:79], a[176:179], v[160:163], v[76:79]
    ds_read_b128 v[192:195], v6 offset:256
    v_cvt_pk_bf16_f32 v94, v72, v73
    v_mfma_f32_16x16x32_bf16 v[76:79], a[180:183], v[164:167], v[76:79]
    v_cvt_pk_bf16_f32 v95, v74, v75
    v_permlane16_swap_b32 v14, v15
    v_mfma_f32_16x16x32_bf16 v[76:79], a[184:187], v[168:171], v[76:79]
    v_add_f32 v14, v14, v15
    v_mov_b32 v15, v14
    v_mfma_f32_16x16x32_bf16 v[76:79], a[188:191], v[172:175], v[76:79]
    v_mfma_f32_16x16x32_bf16 v[64:67], a[192:195], v[128:131], 0
    v_permlane32_swap_b32 v14, v15
    v_add_f32 v14, v14, v15
    v_mfma_f32_16x16x32_bf16 v[64:67], a[196:199], v[132:135], v[64:67]
    ds_read_b128 v[196:199], v7 offset:256
    v_mfma_f32_16x16x32_bf16 v[64:67], a[200:203], v[136:139], v[64:67]
    v_cvt_pk_bf16_f32 v118, v76, v77
    v_cvt_pk_bf16_f32 v119, v78, v79
    v_mfma_f32_16x16x32_bf16 v[64:67], a[204:207], v[140:143], v[64:67]
    v_rcp_f32 v14, v14
    v_mfma_f32_16x16x32_bf16 v[64:67], a[208:211], v[144:147], v[64:67]
    v_mov_b32 v15, v14
    v_mfma_f32_16x16x32_bf16 v[64:67], a[212:215], v[148:151], v[64:67]
    v_mfma_f32_16x16x32_bf16 v[68:71], a[192:195], v[152:155], 0
    ds_read_b128 v[200:203], v6 offset:6144
    v_permlane16_swap_b32 v14, v15
    v_mfma_f32_16x16x32_bf16 v[68:71], a[196:199], v[156:159], v[68:71]
    v_mul_f32 v32, v32, v14
    v_mul_f32 v33, v33, v14
    v_mfma_f32_16x16x32_bf16 v[68:71], a[200:203], v[160:163], v[68:71]
    v_cvt_pk_bf16_f32 v96, v64, v65
    v_cvt_pk_bf16_f32 v97, v66, v67
    v_mfma_f32_16x16x32_bf16 v[68:71], a[204:207], v[164:167], v[68:71]
    v_mul_f32 v40, v40, v14
    v_mul_f32 v41, v41, v14
    v_mfma_f32_16x16x32_bf16 v[68:71], a[208:211], v[168:171], v[68:71]
    v_mul_f32 v48, v48, v15
    v_mul_f32 v49, v49, v15
    v_mfma_f32_16x16x32_bf16 v[68:71], a[212:215], v[172:175], v[68:71]
    ds_read_b128 v[204:207], v7 offset:6144
    v_mul_f32 v56, v56, v15
    v_mfma_f32_16x16x32_bf16 v[72:75], a[216:219], v[128:131], 0
    v_mul_f32 v57, v57, v15
    v_cvt_pk_bf16_f32 v32, v32, v33
    v_mfma_f32_16x16x32_bf16 v[72:75], a[220:223], v[132:135], v[72:75]
    v_mul_f32 v34, v34, v14
    v_mul_f32 v35, v35, v14
    v_mfma_f32_16x16x32_bf16 v[72:75], a[224:227], v[136:139], v[72:75]
    v_cvt_pk_bf16_f32 v120, v68, v69
    v_cvt_pk_bf16_f32 v121, v70, v71
    v_mfma_f32_16x16x32_bf16 v[72:75], a[228:231], v[140:143], v[72:75]
    v_cvt_pk_bf16_f32 v40, v40, v41
    v_mul_f32 v42, v42, v14
    v_mfma_f32_16x16x32_bf16 v[72:75], a[232:235], v[144:147], v[72:75]
    ds_read_b128 v[208:211], v6 offset:6272
    v_mul_f32 v43, v43, v14
    v_mfma_f32_16x16x32_bf16 v[72:75], a[236:239], v[148:151], v[72:75]
    v_cvt_pk_bf16_f32 v48, v48, v49
    v_mul_f32 v50, v50, v15
    v_mfma_f32_16x16x32_bf16 v[76:79], a[216:219], v[152:155], 0
    v_mul_f32 v51, v51, v15
    v_cvt_pk_bf16_f32 v56, v56, v57
    v_mfma_f32_16x16x32_bf16 v[76:79], a[220:223], v[156:159], v[76:79]
    v_mul_f32 v58, v58, v15
    v_mul_f32 v59, v59, v15
    v_mfma_f32_16x16x32_bf16 v[76:79], a[224:227], v[160:163], v[76:79]
    v_cvt_pk_bf16_f32 v98, v72, v73
    v_cvt_pk_bf16_f32 v99, v74, v75
    v_mfma_f32_16x16x32_bf16 v[76:79], a[228:231], v[164:167], v[76:79]
    ds_read_b128 v[212:215], v7 offset:6272
    v_cvt_pk_bf16_f32 v33, v34, v35
    v_mfma_f32_16x16x32_bf16 v[76:79], a[232:235], v[168:171], v[76:79]
    v_mul_f32 v36, v36, v14
    v_mul_f32 v37, v37, v14
    v_mfma_f32_16x16x32_bf16 v[76:79], a[236:239], v[172:175], v[76:79]
    v_mul_f32 v38, v38, v14
    v_mul_f32 v39, v39, v14
    v_mfma_f32_16x16x32_bf16 v[64:67], a[240:243], v[128:131], 0
    v_cvt_pk_bf16_f32 v41, v42, v43
    v_mul_f32 v44, v44, v14
    v_mfma_f32_16x16x32_bf16 v[64:67], a[244:247], v[132:135], v[64:67]
    v_mul_f32 v45, v45, v14
    v_mul_f32 v46, v46, v14
    v_mfma_f32_16x16x32_bf16 v[64:67], a[248:251], v[136:139], v[64:67]
    ds_read_b128 v[216:219], v6 offset:6400
    v_cvt_pk_bf16_f32 v122, v76, v77
    v_mfma_f32_16x16x32_bf16 v[64:67], a[252:255], v[140:143], v[64:67]
    v_cvt_pk_bf16_f32 v123, v78, v79
    v_mul_f32 v47, v47, v14
    v_mfma_f32_16x16x32_bf16 v[64:67], v[224:227], v[144:147], v[64:67]
    v_cvt_pk_bf16_f32 v49, v50, v51
    v_mul_f32 v52, v52, v15
    v_mfma_f32_16x16x32_bf16 v[64:67], v[228:231], v[148:151], v[64:67]
    v_mul_f32 v53, v53, v15
    v_mul_f32 v54, v54, v15
    v_mfma_f32_16x16x32_bf16 v[68:71], a[240:243], v[152:155], 0
    v_mul_f32 v55, v55, v15
    v_cvt_pk_bf16_f32 v57, v58, v59
    v_mfma_f32_16x16x32_bf16 v[68:71], a[244:247], v[156:159], v[68:71]
    ds_read_b128 v[220:223], v7 offset:6400
    v_mul_f32 v60, v60, v15
    v_mfma_f32_16x16x32_bf16 v[68:71], a[248:251], v[160:163], v[68:71]
    v_mul_f32 v61, v61, v15
    v_mul_f32 v62, v62, v15
    v_mfma_f32_16x16x32_bf16 v[68:71], a[252:255], v[164:167], v[68:71]
    v_mul_f32 v63, v63, v15
    v_cvt_pk_bf16_f32 v34, v36, v37
    v_mfma_f32_16x16x32_bf16 v[68:71], v[224:227], v[168:171], v[68:71]
    v_cvt_pk_bf16_f32 v35, v38, v39
    v_cvt_pk_bf16_f32 v42, v44, v45
    v_mfma_f32_16x16x32_bf16 v[68:71], v[228:231], v[172:175], v[68:71]
    ds_write_b128 v8, v[32:35] offset:0
    v_mfma_f32_16x16x32_bf16 v[72:75], v[232:235], v[128:131], 0
    v_cvt_pk_bf16_f32 v43, v46, v47
    v_cvt_pk_bf16_f32 v50, v52, v53
    v_mfma_f32_16x16x32_bf16 v[72:75], v[236:239], v[132:135], v[72:75]
    ds_write_b128 v9, v[40:43] offset:0
    v_mfma_f32_16x16x32_bf16 v[72:75], v[240:243], v[136:139], v[72:75]
    v_cvt_pk_bf16_f32 v51, v54, v55
    v_cvt_pk_bf16_f32 v58, v60, v61
    v_mfma_f32_16x16x32_bf16 v[72:75], v[244:247], v[140:143], v[72:75]
    ds_write_b128 v8, v[48:51] offset:2048
    v_mfma_f32_16x16x32_bf16 v[72:75], v[248:251], v[144:147], v[72:75]
    v_cvt_pk_bf16_f32 v59, v62, v63
    v_cvt_pk_bf16_f32 v100, v64, v65
    v_mfma_f32_16x16x32_bf16 v[72:75], v[252:255], v[148:151], v[72:75]
    ds_write_b128 v9, v[56:59] offset:2048
    v_mfma_f32_16x16x32_bf16 v[76:79], v[232:235], v[152:155], 0
    v_cvt_pk_bf16_f32 v101, v66, v67
    v_cvt_pk_bf16_f32 v124, v68, v69
    v_mfma_f32_16x16x32_bf16 v[76:79], v[236:239], v[156:159], v[76:79]
    v_cvt_pk_bf16_f32 v125, v70, v71
    v_mfma_f32_16x16x32_bf16 v[76:79], v[240:243], v[160:163], v[76:79]
    v_cvt_pk_bf16_f32 v102, v72, v73
    v_cvt_pk_bf16_f32 v103, v74, v75
    v_mfma_f32_16x16x32_bf16 v[76:79], v[244:247], v[164:167], v[76:79]
    v_mfma_f32_16x16x32_bf16 v[76:79], v[248:251], v[168:171], v[76:79]
    v_mfma_f32_16x16x32_bf16 v[76:79], v[252:255], v[172:175], v[76:79]
    s_waitcnt lgkmcnt(0)
    s_barrier
    s_branch L_mloop
L_mtail:
    s_nop 5
    v_max3_f32 v13, v13, v59, v60
    v_max3_f32 v13, v13, v61, v62
    v_max_f32 v13, v13, v63
    s_nop 1
    v_permlane16_swap_b32 v12, v13
    v_max_f32 v12, v12, v13
    v_mov_b32 v13, v12
    s_nop 1
    v_permlane32_swap_b32 v12, v13
    v_max_f32 v12, v12, v13
    v_mul_f32 v12, s40, v12
    v_mov_b32 v13, v12
    s_nop 1
    v_permlane16_swap_b32 v12, v13
    v_fma_f32 v32, v32, s40, -v12
    v_fma_f32 v48, v48, s40, -v13
    v_fma_f32 v33, v33, s40, -v12
    v_fma_f32 v49, v49, s40, -v13
    v_exp_f32 v32, v32
    v_exp_f32 v48, v48
    v_exp_f32 v33, v33
    v_exp_f32 v49, v49
    v_fma_f32 v34, v34, s40, -v12
    v_fma_f32 v50, v50, s40, -v13
    v_exp_f32 v34, v34
    v_exp_f32 v50, v50
    v_fma_f32 v35, v35, s40, -v12
    v_fma_f32 v51, v51, s40, -v13
    v_exp_f32 v35, v35
    v_exp_f32 v51, v51
    v_fma_f32 v36, v36, s40, -v12
    v_fma_f32 v52, v52, s40, -v13
    v_add_f32 v14, v32, v33
    v_add_f32 v15, v48, v49
    v_exp_f32 v36, v36
    v_exp_f32 v52, v52
    v_fma_f32 v37, v37, s40, -v12
    v_fma_f32 v53, v53, s40, -v13
    v_add_f32 v14, v14, v34
    v_add_f32 v15, v15, v50
    v_exp_f32 v37, v37
    v_exp_f32 v53, v53
    v_fma_f32 v38, v38, s40, -v12
    v_fma_f32 v54, v54, s40, -v13
    v_add_f32 v14, v14, v35
    v_add_f32 v15, v15, v51
    v_exp_f32 v38, v38
    v_exp_f32 v54, v54
    v_fma_f32 v39, v39, s40, -v12
    v_fma_f32 v55, v55, s40, -v13
    v_add_f32 v14, v14, v36
    v_add_f32 v15, v15, v52
    v_exp_f32 v39, v39
    v_exp_f32 v55, v55
    v_fma_f32 v40, v40, s40, -v12
    v_fma_f32 v56, v56, s40, -v13
    v_add_f32 v14, v14, v37
    v_add_f32 v15, v15, v53
    v_exp_f32 v40, v40
    v_exp_f32 v56, v56
    v_fma_f32 v41, v41, s40, -v12
    v_fma_f32 v57, v57, s40, -v13
    v_add_f32 v14, v14, v38
    v_add_f32 v15, v15, v54
    v_exp_f32 v41, v41
    v_exp_f32 v57, v57
    v_fma_f32 v42, v42, s40, -v12
    v_fma_f32 v58, v58, s40, -v13
    v_add_f32 v14, v14, v39
    v_add_f32 v15, v15, v55
    v_exp_f32 v42, v42
    v_exp_f32 v58, v58
    v_fma_f32 v43, v43, s40, -v12
    v_fma_f32 v59, v59, s40, -v13
    v_add_f32 v14, v14, v40
    v_add_f32 v15, v15, v56
    v_exp_f32 v43, v43
    v_exp_f32 v59, v59
    v_fma_f32 v44, v44, s40, -v12
    v_fma_f32 v60, v60, s40, -v13
    v_add_f32 v14, v14, v41
    v_add_f32 v15, v15, v57
    v_exp_f32 v44, v44
    v_exp_f32 v60, v60
    v_fma_f32 v45, v45, s40, -v12
    v_fma_f32 v61, v61, s40, -v13
    v_add_f32 v14, v14, v42
    v_add_f32 v15, v15, v58
    v_exp_f32 v45, v45
    v_exp_f32 v61, v61
    v_fma_f32 v46, v46, s40, -v12
    v_fma_f32 v62, v62, s40, -v13
    v_add_f32 v14, v14, v43
    v_add_f32 v15, v15, v59
    v_exp_f32 v46, v46
    v_exp_f32 v62, v62
    v_fma_f32 v47, v47, s40, -v12
    v_fma_f32 v63, v63, s40, -v13
    v_add_f32 v14, v14, v44
    v_add_f32 v15, v15, v60
    v_exp_f32 v47, v47
    v_exp_f32 v63, v63
    v_add_f32 v14, v14, v45
    v_add_f32 v15, v15, v61
    v_add_f32 v14, v14, v46
    v_add_f32 v15, v15, v62
    v_add_f32 v14, v14, v47
    v_add_f32 v15, v15, v63
    s_nop 1
    v_permlane16_swap_b32 v14, v15
    v_add_f32 v14, v14, v15
    v_mov_b32 v15, v14
    s_nop 1
    v_permlane32_swap_b32 v14, v15
    v_add_f32 v14, v14, v15
    v_rcp_f32 v14, v14
    s_nop 0
    v_mov_b32 v15, v14
    s_nop 1
    v_permlane16_swap_b32 v14, v15
    v_mul_f32 v32, v32, v14
    v_mul_f32 v33, v33, v14
    v_mul_f32 v40, v40, v14
    v_mul_f32 v41, v41, v14
    v_mul_f32 v48, v48, v15
    v_mul_f32 v49, v49, v15
    v_mul_f32 v56, v56, v15
    v_mul_f32 v57, v57, v15
    v_cvt_pk_bf16_f32 v32, v32, v33
    v_mul_f32 v34, v34, v14
    v_mul_f32 v35, v35, v14
    v_cvt_pk_bf16_f32 v40, v40, v41
    v_mul_f32 v42, v42, v14
    v_mul_f32 v43, v43, v14
    v_cvt_pk_bf16_f32 v48, v48, v49
    v_mul_f32 v50, v50, v15
    v_mul_f32 v51, v51, v15
    v_cvt_pk_bf16_f32 v56, v56, v57
    v_mul_f32 v58, v58, v15
    v_mul_f32 v59, v59, v15
    v_cvt_pk_bf16_f32 v33, v34, v35
    v_mul_f32 v36, v36, v14
    v_mul_f32 v37, v37, v14
    v_mul_f32 v38, v38, v14
    v_mul_f32 v39, v39, v14
    v_cvt_pk_bf16_f32 v41, v42, v43
    v_mul_f32 v44, v44, v14
    v_mul_f32 v45, v45, v14
    v_mul_f32 v46, v46, v14
    v_mul_f32 v47, v47, v14
    v_cvt_pk_bf16_f32 v49, v50, v51
    v_mul_f32 v52, v52, v15
    v_mul_f32 v53, v53, v15
    v_mul_f32 v54, v54, v15
    v_mul_f32 v55, v55, v15
    v_cvt_pk_bf16_f32 v57, v58, v59
    v_mul_f32 v60, v60, v15
    v_mul_f32 v61, v61, v15
    v_mul_f32 v62, v62, v15
    v_mul_f32 v63, v63, v15
    v_cvt_pk_bf16_f32 v34, v36, v37
    v_cvt_pk_bf16_f32 v35, v38, v39
    v_cvt_pk_bf16_f32 v42, v44, v45
    v_cvt_pk_bf16_f32 v43, v46, v47
    v_cvt_pk_bf16_f32 v50, v52, v53
    v_cvt_pk_bf16_f32 v51, v54, v55
    v_cvt_pk_bf16_f32 v58, v60, v61
    v_cvt_pk_bf16_f32 v59, v62, v63
    ds_write_b128 v8, v[32:35] offset:0
    ds_write_b128 v9, v[40:43] offset:0
    ds_write_b128 v8, v[48:51] offset:2048
    ds_write_b128 v9, v[56:59] offset:2048
    s_waitcnt lgkmcnt(0)
    s_barrier
    s_branch L_fin
L_nrole:
    v_add_u32 v18, 0, v0
    v_mul_u32_u24 v18, 171, v18
    v_lshrrev_b32 v18, 13, v18
    s_lshl_b32 s60, s37, 2
    v_or_b32 v18, s60, v18
    v_lshlrev_b32 v18, 4, v18
    v_xor_b32 v18, v18, v1
    s_mul_i32 s60, s37, 196608
    v_add_u32 v8, s60, v18
    v_add_u32 v18, 64, v0
    v_mul_u32_u24 v18, 171, v18
    v_lshrrev_b32 v18, 13, v18
    s_lshl_b32 s60, s37, 2
    v_or_b32 v18, s60, v18
    v_lshlrev_b32 v18, 4, v18
    v_xor_b32 v18, v18, v1
    s_mul_i32 s60, s37, 196608
    v_add_u32 v9, s60, v18
    v_add_u32 v18, 128, v0
    v_mul_u32_u24 v18, 171, v18
    v_lshrrev_b32 v18, 13, v18
    s_lshl_b32 s60, s37, 2
    v_or_b32 v18, s60, v18
    v_lshlrev_b32 v18, 4, v18
    v_xor_b32 v18, v18, v1
    s_mul_i32 s60, s37, 196608
    v_add_u32 v10, s60, v18
    s_mul_i32 s42, s37, 3072
    s_mov_b32 s10, 100663296
    s_mov_b32 s11, 0x00020000
    s_waitcnt lgkmcnt(0)
    s_mov_b32 s8, s4
    s_mov_b32 s9, s5
    s_mov_b32 s52, s50
    s_mov_b32 s53, s51
    s_add_u32 m0, s42, 0
    s_add_u32 s46, s38, 0
    buffer_load_dwordx4 v8, s[8:11], s46 offen offset:0 nt lds
    buffer_load_dwordx4 v9, s[8:11], s46 offen offset:1024 nt lds
    buffer_load_dwordx4 v10, s[8:11], s46 offen offset:2048 nt lds
    s_add_u32 m0, s42, 6144
    s_add_u32 s46, s38, 393216
    buffer_load_dwordx4 v8, s[8:11], s46 offen offset:0 nt lds
    buffer_load_dwordx4 v9, s[8:11], s46 offen offset:1024 nt lds
    buffer_load_dwordx4 v10, s[8:11], s46 offen offset:2048 nt lds
    s_add_u32 m0, s42, 12288
    s_add_u32 s46, s38, 786432
    buffer_load_dwordx4 v8, s[8:11], s46 offen offset:0 nt lds
    buffer_load_dwordx4 v9, s[8:11], s46 offen offset:1024 nt lds
    buffer_load_dwordx4 v10, s[8:11], s46 offen offset:2048 nt lds
    s_add_u32 m0, s42, 18432
    s_add_u32 s46, s38, 1179648
    buffer_load_dwordx4 v8, s[8:11], s46 offen offset:0 nt lds
    buffer_load_dwordx4 v9, s[8:11], s46 offen offset:1024 nt lds
    buffer_load_dwordx4 v10, s[8:11], s46 offen offset:2048 nt lds
    v_lshrrev_b32 v18, 1, v16
    v_xor_b32 v18, v18, v17
    v_lshlrev_b32 v18, 4, v18
    v_mul_u32_u24 v19, 384, v16
    v_add_u32 v2, v18, v19
    v_xor_b32 v3, 64, v2
    v_lshrrev_b32 v18, 5, v0
    v_mul_u32_u24 v18, 196608, v18
    v_and_b32 v19, 1, v17
    v_mul_u32_u24 v19, 1536, v19
    v_lshlrev_b32 v20, 3, v16
    v_add3_u32 v12, v18, v19, v20
    s_lshl_b32 s60, s37, 7
    v_add_u32 v12, s60, v12
    v_lshrrev_b32 v18, 3, v16
    v_mul_u32_u24 v18, 196608, v18
    v_and_b32 v19, 7, v16
    v_mul_u32_u24 v19, 384, v19
    v_lshlrev_b32 v20, 4, v17
    v_add3_u32 v21, v18, v19, v20
    s_lshl_b32 s60, s37, 6
    s_add_u32 s60, s60, 256
    v_add_u32 v16, s60, v21
    v_add_u32 v13, 393216, v12
    v_add_u32 v17, 393216, v16
    v_add_u32 v14, 786432, v12
    v_add_u32 v18, 786432, v16
    v_add_u32 v15, 1179648, v12
    v_add_u32 v19, 1179648, v16
    v_add_u32 v6, 147456, v1
    v_mov_b32 v23, 139264
    s_mov_b32 s12, s6
    s_mov_b32 s13, s7
    s_mov_b32 s14, 100663296
    s_mov_b32 s15, 0x00020000
    s_mov_b32 s41, 0
    s_mov_b32 s16, 100663296
    s_mov_b32 s17, 100663296
    s_add_u32 s18, s38, 0
    s_add_u32 s19, s38, 6291456
    s_add_u32 s43, s38, 12582912
    s_getpc_b64 s[56:57]
L_pc:
    s_sub_u32 s56, s56, L_pc-L_mloop
    s_subb_u32 s57, s57, 0
    s_mov_b32 s58, L_codeend-L_mloop
    s_mov_b32 s59, 0x00020000
    s_lshr_b32 s60, s2, 3
    s_and_b32 s60, s60, 7
    s_lshl_b32 s60, s60, 1
    s_add_u32 s60, s60, s37
    s_lshl_b32 s60, s60, 10
    buffer_load_dwordx4 v[28:31], v1, s[56:59], s60 offen
    s_mul_i32 s61, s37, 36864
    s_add_u32 s61, s61, 73728
    s_waitcnt vmcnt(1)
    s_barrier
    buffer_load_dwordx4 a[0:3], v1, s[52:55], s61 offen offset:0
    buffer_load_dwordx4 a[4:7], v1, s[52:55], s61 offen offset:1024
    buffer_load_dwordx4 a[8:11], v1, s[52:55], s61 offen offset:2048
    buffer_load_dwordx4 a[12:15], v1, s[52:55], s61 offen offset:3072
    s_add_u32 s61, s61, 4096
    buffer_load_dwordx4 a[16:19], v1, s[52:55], s61 offen offset:0
    buffer_load_dwordx4 a[20:23], v1, s[52:55], s61 offen offset:1024
    buffer_load_dwordx4 a[24:27], v1, s[52:55], s61 offen offset:2048
    buffer_load_dwordx4 a[28:31], v1, s[52:55], s61 offen offset:3072
    s_add_u32 s61, s61, 4096
    buffer_load_dwordx4 a[32:35], v1, s[52:55], s61 offen offset:0
    buffer_load_dwordx4 a[36:39], v1, s[52:55], s61 offen offset:1024
    buffer_load_dwordx4 a[40:43], v1, s[52:55], s61 offen offset:2048
    buffer_load_dwordx4 a[44:47], v1, s[52:55], s61 offen offset:3072
    s_add_u32 s61, s61, 4096
    buffer_load_dwordx4 a[48:51], v1, s[52:55], s61 offen offset:0
    buffer_load_dwordx4 a[52:55], v1, s[52:55], s61 offen offset:1024
    buffer_load_dwordx4 a[56:59], v1, s[52:55], s61 offen offset:2048
    buffer_load_dwordx4 a[60:63], v1, s[52:55], s61 offen offset:3072
    s_add_u32 s61, s61, 4096
    buffer_load_dwordx4 a[64:67], v1, s[52:55], s61 offen offset:0
    buffer_load_dwordx4 a[68:71], v1, s[52:55], s61 offen offset:1024
    buffer_load_dwordx4 a[72:75], v1, s[52:55], s61 offen offset:2048
    buffer_load_dwordx4 a[76:79], v1, s[52:55], s61 offen offset:3072
    s_add_u32 s61, s61, 4096
    buffer_load_dwordx4 a[80:83], v1, s[52:55], s61 offen offset:0
    buffer_load_dwordx4 a[84:87], v1, s[52:55], s61 offen offset:1024
    buffer_load_dwordx4 a[88:91], v1, s[52:55], s61 offen offset:2048
    buffer_load_dwordx4 a[92:95], v1, s[52:55], s61 offen offset:3072
    s_add_u32 s61, s61, 4096
    buffer_load_dwordx4 a[96:99], v1, s[52:55], s61 offen offset:0
    buffer_load_dwordx4 a[100:103], v1, s[52:55], s61 offen offset:1024
    buffer_load_dwordx4 a[104:107], v1, s[52:55], s61 offen offset:2048
    buffer_load_dwordx4 a[108:111], v1, s[52:55], s61 offen offset:3072
    s_add_u32 s61, s61, 4096
    buffer_load_dwordx4 a[112:115], v1, s[52:55], s61 offen offset:0
    buffer_load_dwordx4 a[116:119], v1, s[52:55], s61 offen offset:1024
    buffer_load_dwordx4 a[120:123], v1, s[52:55], s61 offen offset:2048
    buffer_load_dwordx4 a[124:127], v1, s[52:55], s61 offen offset:3072
    s_add_u32 s61, s61, 4096
    buffer_load_dwordx4 a[128:131], v1, s[52:55], s61 offen offset:0
    buffer_load_dwordx4 a[132:135], v1, s[52:55], s61 offen offset:1024
    buffer_load_dwordx4 a[136:139], v1, s[52:55], s61 offen offset:2048
    buffer_load_dwordx4 a[140:143], v1, s[52:55], s61 offen offset:3072
    ds_read_b128 a[144:147], v2 offset:0
    ds_read_b128 a[148:151], v3 offset:0
    ds_read_b128 a[152:155], v2 offset:128
    ds_read_b128 a[156:159], v3 offset:128
    ds_read_b128 a[160:163], v2 offset:256
    ds_read_b128 a[164:167], v3 offset:256
    ds_read_b128 a[168:171], v2 offset:6144
    ds_read_b128 a[172:175], v3 offset:6144
    ds_read_b128 a[176:179], v2 offset:6272
    ds_read_b128 a[180:183], v3 offset:6272
    ds_read_b128 a[184:187], v2 offset:6400
    ds_read_b128 a[188:191], v3 offset:6400
    ds_read_b128 a[192:195], v2 offset:12288
    ds_read_b128 a[196:199], v3 offset:12288
    ds_read_b128 a[200:203], v2 offset:12416
    ds_read_b128 a[204:207], v3 offset:12416
    ds_read_b128 a[208:211], v2 offset:12544
    ds_read_b128 a[212:215], v3 offset:12544
    ds_read_b128 a[216:219], v2 offset:18432
    ds_read_b128 a[220:223], v3 offset:18432
    ds_read_b128 a[224:227], v2 offset:18560
    ds_read_b128 a[228:231], v3 offset:18560
    ds_read_b128 a[232:235], v2 offset:18688
    ds_read_b128 a[236:239], v3 offset:18688
    s_add_u32 m0, s42, 24576
    s_add_u32 s46, s38, 6291456
    buffer_load_dwordx4 v8, s[8:11], s46 offen offset:0 nt lds
    buffer_load_dwordx4 v9, s[8:11], s46 offen offset:1024 nt lds
    buffer_load_dwordx4 v10, s[8:11], s46 offen offset:2048 nt lds
    s_add_u32 m0, s42, 30720
    s_add_u32 s46, s38, 6684672
    buffer_load_dwordx4 v8, s[8:11], s46 offen offset:0 nt lds
    buffer_load_dwordx4 v9, s[8:11], s46 offen offset:1024 nt lds
    buffer_load_dwordx4 v10, s[8:11], s46 offen offset:2048 nt lds
    s_add_u32 m0, s42, 36864
    s_add_u32 s46, s38, 7077888
    buffer_load_dwordx4 v8, s[8:11], s46 offen offset:0 nt lds
    buffer_load_dwordx4 v9, s[8:11], s46 offen offset:1024 nt lds
    buffer_load_dwordx4 v10, s[8:11], s46 offen offset:2048 nt lds
    s_add_u32 m0, s42, 43008
    s_add_u32 s46, s38, 7471104
    buffer_load_dwordx4 v8, s[8:11], s46 offen offset:0 nt lds
    buffer_load_dwordx4 v9, s[8:11], s46 offen offset:1024 nt lds
    buffer_load_dwordx4 v10, s[8:11], s46 offen offset:2048 nt lds
    buffer_load_dword v28, v1, s[8:11], s16 offen
    buffer_load_dword v28, v1, s[8:11], s16 offen
    buffer_load_dword v28, v1, s[8:11], s16 offen
    buffer_load_dword v28, v1, s[8:11], s16 offen
    buffer_load_dword v28, v1, s[8:11], s16 offen
    s_add_u32 m0, s42, 49152
    s_add_u32 s46, s38, 12582912
    buffer_load_dwordx4 v8, s[8:11], s46 offen offset:0 nt lds
    buffer_load_dwordx4 v9, s[8:11], s46 offen offset:1024 nt lds
    buffer_load_dwordx4 v10, s[8:11], s46 offen offset:2048 nt lds
    s_add_u32 m0, s42, 55296
    s_add_u32 s46, s38, 12976128
    buffer_load_dwordx4 v8, s[8:11], s46 offen offset:0 nt lds
    s_add_u32 s42, s42, 49152
    s_waitcnt vmcnt(21) lgkmcnt(0)
    s_branch L_nmid1
    .p2align 6
L_nloop0:
    v_mfma_f32_16x16x32_bf16 v[192:195], a[144:147], a[120:123], 0
    ds_read_b32 v22, v23
    v_xor_b32 v23, 4, v23
    v_mfma_f32_16x16x32_bf16 v[192:195], a[148:151], a[124:127], v[192:195]
    ds_read_b128 v[128:131], v6 offset:0
    v_cvt_pk_bf16_f32 v70, v204, v205
    v_mfma_f32_16x16x32_bf16 v[192:195], a[152:155], a[128:131], v[192:195]
    ds_read_b128 v[132:135], v6 offset:1024
    v_cvt_pk_bf16_f32 v71, v206, v207
    v_mfma_f32_16x16x32_bf16 v[192:195], a[156:159], a[132:135], v[192:195]
    ds_read_b128 v[136:139], v6 offset:2048
    v_mfma_f32_16x16x32_bf16 v[192:195], a[160:163], a[136:139], v[192:195]
    ds_read_b128 v[140:143], v6 offset:3072
    v_mfma_f32_16x16x32_bf16 v[192:195], a[164:167], a[140:143], v[192:195]
    ds_read_b128 v[144:147], v6 offset:4096
    v_mfma_f32_16x16x32_bf16 v[196:199], a[168:171], a[120:123], 0
    ds_read_b128 v[148:151], v6 offset:5120
    v_mfma_f32_16x16x32_bf16 v[196:199], a[172:175], a[124:127], v[196:199]
    ds_read_b128 v[152:155], v6 offset:6144
    v_mfma_f32_16x16x32_bf16 v[196:199], a[176:179], a[128:131], v[196:199]
    ds_read_b128 v[156:159], v6 offset:7168
    v_cvt_pk_bf16_f32 v72, v192, v193
    v_mfma_f32_16x16x32_bf16 v[196:199], a[180:183], a[132:135], v[196:199]
    s_waitcnt lgkmcnt(8)
    v_readfirstlane_b32 s43, v22
    v_mfma_f32_16x16x32_bf16 v[196:199], a[184:187], a[136:139], v[196:199]
    s_add_u32 m0, s42, 0
    s_add_u32 s46, s43, 0
    v_mfma_f32_16x16x32_bf16 v[196:199], a[188:191], a[140:143], v[196:199]
    v_cvt_pk_bf16_f32 v73, v194, v195
    v_xor_b32 v6, 8192, v6
    v_mfma_f32_16x16x32_bf16 v[200:203], a[192:195], a[120:123], 0
    buffer_load_dwordx4 v8, s[8:11], s46 offen offset:0 nt lds
    v_mfma_f32_16x16x32_bf16 v[200:203], a[196:199], a[124:127], v[200:203]
    ds_read_b128 a[144:147], v4 offset:0
    v_mfma_f32_16x16x32_bf16 v[200:203], a[200:203], a[128:131], v[200:203]
    v_cvt_pk_bf16_f32 v74, v196, v197
    v_cvt_pk_bf16_f32 v75, v198, v199
    v_mfma_f32_16x16x32_bf16 v[200:203], a[204:207], a[132:135], v[200:203]
    ds_read_b128 a[148:151], v5 offset:0
    v_mfma_f32_16x16x32_bf16 v[200:203], a[208:211], a[136:139], v[200:203]
    ds_read_b128 a[152:155], v4 offset:128
    v_mfma_f32_16x16x32_bf16 v[200:203], a[212:215], a[140:143], v[200:203]
    ds_read_b128 a[156:159], v5 offset:128
    v_mfma_f32_16x16x32_bf16 v[204:207], a[216:219], a[120:123], 0
    ds_read_b128 a[160:163], v4 offset:256
    v_mfma_f32_16x16x32_bf16 v[204:207], a[220:223], a[124:127], v[204:207]
    ds_read_b128 a[164:167], v5 offset:256
    v_mfma_f32_16x16x32_bf16 v[204:207], a[224:227], a[128:131], v[204:207]
    v_cvt_pk_bf16_f32 v76, v200, v201
    v_cvt_pk_bf16_f32 v77, v202, v203
    v_mfma_f32_16x16x32_bf16 v[204:207], a[228:231], a[132:135], v[204:207]
    ds_read_b128 a[168:171], v4 offset:6144
    v_mfma_f32_16x16x32_bf16 v[204:207], a[232:235], a[136:139], v[204:207]
    ds_read_b128 a[172:175], v5 offset:6144
    v_mfma_f32_16x16x32_bf16 v[204:207], a[236:239], a[140:143], v[204:207]
    ds_read_b128 a[176:179], v4 offset:6272
    s_waitcnt lgkmcnt(9)
    v_mfma_f32_16x16x32_bf16 v[184:187], v[128:131], v[80:83], 0
    ds_read_b128 a[180:183], v5 offset:6272
    v_mfma_f32_16x16x32_bf16 v[184:187], v[132:135], v[84:87], v[184:187]
    ds_read_b128 a[184:187], v4 offset:6400
    v_mfma_f32_16x16x32_bf16 v[188:191], v[128:131], v[88:91], 0
    v_cvt_pk_bf16_f32 v78, v204, v205
    v_cvt_pk_bf16_f32 v79, v206, v207
    v_mfma_f32_16x16x32_bf16 v[188:191], v[132:135], v[92:95], v[188:191]
    buffer_load_dwordx4 v9, s[8:11], s46 offen offset:1024 nt lds
    v_mfma_f32_16x16x32_bf16 v[192:195], v[128:131], v[96:99], 0
    ds_read_b128 a[188:191], v5 offset:6400
    v_mfma_f32_16x16x32_bf16 v[192:195], v[132:135], v[100:103], v[192:195]
    ds_read_b128 a[192:195], v4 offset:12288
    v_mfma_f32_16x16x32_bf16 v[196:199], v[128:131], v[104:107], 0
    v_cvt_pk_bf16_f32 v208, v184, v188
    v_cvt_pk_bf16_f32 v210, v185, v189
    v_mfma_f32_16x16x32_bf16 v[196:199], v[132:135], v[108:111], v[196:199]
    ds_read_b128 a[196:199], v5 offset:12288
    v_cvt_pk_bf16_f32 v212, v186, v190
    v_mfma_f32_16x16x32_bf16 v[200:203], v[112:115], v[128:131], 0
    ds_read_b128 a[200:203], v4 offset:12416
    v_cvt_pk_bf16_f32 v214, v187, v191
    v_mfma_f32_16x16x32_bf16 v[200:203], v[116:119], v[132:135], v[200:203]
    ds_read_b128 a[204:207], v5 offset:12416
    v_mfma_f32_16x16x32_bf16 v[204:207], v[120:123], v[128:131], 0
    v_cvt_pk_bf16_f32 v209, v192, v196
    v_cvt_pk_bf16_f32 v211, v193, v197
    v_mfma_f32_16x16x32_bf16 v[204:207], v[124:127], v[132:135], v[204:207]
    ds_read_b128 a[208:211], v4 offset:12544
    v_cvt_pk_bf16_f32 v213, v194, v198
    v_mfma_f32_16x16x32_bf16 v[160:163], v[136:139], v[80:83], 0
    ds_read_b128 a[212:215], v5 offset:12544
    v_cvt_pk_bf16_f32 v215, v195, v199
    v_mfma_f32_16x16x32_bf16 v[160:163], v[140:143], v[84:87], v[160:163]
    ds_read_b128 a[216:219], v4 offset:18432
    v_cvt_pk_bf16_f32 v216, v200, v201
    v_mfma_f32_16x16x32_bf16 v[164:167], v[136:139], v[88:91], 0
    ds_read_b128 a[220:223], v5 offset:18432
    v_cvt_pk_bf16_f32 v217, v202, v203
    v_mfma_f32_16x16x32_bf16 v[164:167], v[140:143], v[92:95], v[164:167]
    ds_read_b128 a[224:227], v4 offset:18560
    v_cvt_pk_bf16_f32 v218, v204, v205
    v_mfma_f32_16x16x32_bf16 v[168:171], v[136:139], v[96:99], 0
    buffer_store_dwordx2 v[208:209], v12, s[12:15], s16 offen offset:0 sc1
    v_mfma_f32_16x16x32_bf16 v[168:171], v[140:143], v[100:103], v[168:171]
    ds_read_b128 a[228:231], v5 offset:18560
    v_cvt_pk_bf16_f32 v219, v206, v207
    v_mfma_f32_16x16x32_bf16 v[172:175], v[136:139], v[104:107], 0
    buffer_load_dwordx4 v10, s[8:11], s46 offen offset:2048 nt lds
    v_mfma_f32_16x16x32_bf16 v[172:175], v[140:143], v[108:111], v[172:175]
    ds_read_b128 a[232:235], v4 offset:18688
    v_cvt_pk_bf16_f32 v220, v160, v164
    v_mfma_f32_16x16x32_bf16 v[176:179], v[112:115], v[136:139], 0
    ds_read_b128 a[236:239], v5 offset:18688
    v_cvt_pk_bf16_f32 v222, v161, v165
    v_mfma_f32_16x16x32_bf16 v[176:179], v[116:119], v[140:143], v[176:179]
    v_cvt_pk_bf16_f32 v224, v162, v166
    v_cvt_pk_bf16_f32 v226, v163, v167
    v_mfma_f32_16x16x32_bf16 v[180:183], v[120:123], v[136:139], 0
    v_cvt_pk_bf16_f32 v221, v168, v172
    v_cvt_pk_bf16_f32 v223, v169, v173
    v_mfma_f32_16x16x32_bf16 v[180:183], v[124:127], v[140:143], v[180:183]
    buffer_store_dwordx2 v[210:211], v12, s[12:15], s16 offen offset:384 sc1
    v_mfma_f32_16x16x32_bf16 v[184:187], v[144:147], v[80:83], 0
    v_cvt_pk_bf16_f32 v225, v170, v174
    v_cvt_pk_bf16_f32 v227, v171, v175
    v_mfma_f32_16x16x32_bf16 v[184:187], v[148:151], v[84:87], v[184:187]
    v_cvt_pk_bf16_f32 v228, v176, v177
    v_cvt_pk_bf16_f32 v229, v178, v179
    v_mfma_f32_16x16x32_bf16 v[188:191], v[144:147], v[88:91], 0
    v_cvt_pk_bf16_f32 v230, v180, v181
    v_cvt_pk_bf16_f32 v231, v182, v183
    v_mfma_f32_16x16x32_bf16 v[188:191], v[148:151], v[92:95], v[188:191]
    v_mfma_f32_16x16x32_bf16 v[192:195], v[144:147], v[96:99], 0
    v_mfma_f32_16x16x32_bf16 v[192:195], v[148:151], v[100:103], v[192:195]
    v_mfma_f32_16x16x32_bf16 v[196:199], v[144:147], v[104:107], 0
    v_cvt_pk_bf16_f32 v232, v184, v188
    v_cvt_pk_bf16_f32 v234, v185, v189
    v_mfma_f32_16x16x32_bf16 v[196:199], v[148:151], v[108:111], v[196:199]
    buffer_store_dwordx2 v[212:213], v12, s[12:15], s16 offen offset:768 sc1
    v_mfma_f32_16x16x32_bf16 v[200:203], v[112:115], v[144:147], 0
    s_add_u32 m0, s42, 6144
    s_add_u32 s46, s43, 393216
    v_mfma_f32_16x16x32_bf16 v[200:203], v[116:119], v[148:151], v[200:203]
    buffer_load_dwordx4 v8, s[8:11], s46 offen offset:0 nt lds
    v_mfma_f32_16x16x32_bf16 v[204:207], v[120:123], v[144:147], 0
    v_cvt_pk_bf16_f32 v233, v192, v196
    v_cvt_pk_bf16_f32 v235, v193, v197
    v_mfma_f32_16x16x32_bf16 v[204:207], v[124:127], v[148:151], v[204:207]
    v_cvt_pk_bf16_f32 v237, v194, v198
    v_cvt_pk_bf16_f32 v239, v195, v199
    v_mfma_f32_16x16x32_bf16 v[160:163], v[152:155], v[80:83], 0
    v_cvt_pk_bf16_f32 v240, v200, v201
    v_cvt_pk_bf16_f32 v241, v202, v203
    v_mfma_f32_16x16x32_bf16 v[160:163], v[156:159], v[84:87], v[160:163]
    v_cvt_pk_bf16_f32 v236, v186, v190
    v_cvt_pk_bf16_f32 v238, v187, v191
    v_mfma_f32_16x16x32_bf16 v[164:167], v[152:155], v[88:91], 0
    buffer_store_dwordx2 v[214:215], v12, s[12:15], s16 offen offset:1152 sc1
    v_mfma_f32_16x16x32_bf16 v[164:167], v[156:159], v[92:95], v[164:167]
    v_cvt_pk_bf16_f32 v242, v204, v205
    v_cvt_pk_bf16_f32 v243, v206, v207
    v_mfma_f32_16x16x32_bf16 v[168:171], v[152:155], v[96:99], 0
    v_mfma_f32_16x16x32_bf16 v[168:171], v[156:159], v[100:103], v[168:171]
    v_mfma_f32_16x16x32_bf16 v[172:175], v[152:155], v[104:107], 0
    v_cvt_pk_bf16_f32 v244, v160, v164
    v_cvt_pk_bf16_f32 v246, v161, v165
    v_mfma_f32_16x16x32_bf16 v[172:175], v[156:159], v[108:111], v[172:175]
    v_cvt_pk_bf16_f32 v248, v162, v166
    v_cvt_pk_bf16_f32 v250, v163, v167
    v_mfma_f32_16x16x32_bf16 v[176:179], v[112:115], v[152:155], 0
    v_mfma_f32_16x16x32_bf16 v[176:179], v[116:119], v[156:159], v[176:179]
    v_mfma_f32_16x16x32_bf16 v[180:183], v[120:123], v[152:155], 0
    buffer_store_dwordx4 v[216:219], v16, s[12:15], s16 offen sc1
    v_mfma_f32_16x16x32_bf16 v[180:183], v[124:127], v[156:159], v[180:183]
    v_cvt_pk_bf16_f32 v245, v168, v172
    s_cmp_ge_u32 s18, 100663296
    s_cbranch_scc1 L_nepi0
L_nmid0:
    s_waitcnt lgkmcnt(0)
    v_mfma_f32_16x16x32_bf16 v[192:195], a[144:147], a[0:3], 0
    buffer_load_dwordx4 v9, s[8:11], s46 offen offset:1024 nt lds
    v_mfma_f32_16x16x32_bf16 v[192:195], a[148:151], a[4:7], v[192:195]
    v_cvt_pk_bf16_f32 v247, v169, v173
    v_cvt_pk_bf16_f32 v249, v170, v174
    v_mfma_f32_16x16x32_bf16 v[192:195], a[152:155], a[8:11], v[192:195]
    v_cvt_pk_bf16_f32 v251, v171, v175
    v_cvt_pk_bf16_f32 v252, v176, v177
    v_mfma_f32_16x16x32_bf16 v[192:195], a[156:159], a[12:15], v[192:195]
    v_cvt_pk_bf16_f32 v253, v178, v179
    v_cvt_pk_bf16_f32 v254, v180, v181
    v_mfma_f32_16x16x32_bf16 v[192:195], a[160:163], a[16:19], v[192:195]
    v_cvt_pk_bf16_f32 v255, v182, v183
    v_mfma_f32_16x16x32_bf16 v[192:195], a[164:167], a[20:23], v[192:195]
    v_mfma_f32_16x16x32_bf16 v[196:199], a[168:171], a[0:3], 0
    buffer_store_dwordx2 v[220:221], v13, s[12:15], s16 offen offset:0 sc1
    v_mfma_f32_16x16x32_bf16 v[196:199], a[172:175], a[4:7], v[196:199]
    v_mfma_f32_16x16x32_bf16 v[196:199], a[176:179], a[8:11], v[196:199]
    v_cvt_pk_bf16_f32 v80, v192, v193
    v_cvt_pk_bf16_f32 v81, v194, v195
    v_mfma_f32_16x16x32_bf16 v[196:199], a[180:183], a[12:15], v[196:199]
    v_mfma_f32_16x16x32_bf16 v[196:199], a[184:187], a[16:19], v[196:199]
    v_mfma_f32_16x16x32_bf16 v[196:199], a[188:191], a[20:23], v[196:199]
    v_mfma_f32_16x16x32_bf16 v[200:203], a[192:195], a[0:3], 0
    v_mfma_f32_16x16x32_bf16 v[200:203], a[196:199], a[4:7], v[200:203]
    buffer_store_dwordx2 v[222:223], v13, s[12:15], s16 offen offset:384 sc1
    v_mfma_f32_16x16x32_bf16 v[200:203], a[200:203], a[8:11], v[200:203]
    v_cvt_pk_bf16_f32 v82, v196, v197
    v_cvt_pk_bf16_f32 v83, v198, v199
    v_mfma_f32_16x16x32_bf16 v[200:203], a[204:207], a[12:15], v[200:203]
    buffer_load_dwordx4 v10, s[8:11], s46 offen offset:2048 nt lds
    v_mfma_f32_16x16x32_bf16 v[200:203], a[208:211], a[16:19], v[200:203]
    v_mfma_f32_16x16x32_bf16 v[200:203], a[212:215], a[20:23], v[200:203]
    v_mfma_f32_16x16x32_bf16 v[204:207], a[216:219], a[0:3], 0
    v_mfma_f32_16x16x32_bf16 v[204:207], a[220:223], a[4:7], v[204:207]
    v_mfma_f32_16x16x32_bf16 v[204:207], a[224:227], a[8:11], v[204:207]
    v_cvt_pk_bf16_f32 v84, v200, v201
    v_cvt_pk_bf16_f32 v85, v202, v203
    v_mfma_f32_16x16x32_bf16 v[204:207], a[228:231], a[12:15], v[204:207]
    buffer_store_dwordx2 v[224:225], v13, s[12:15], s16 offen offset:768 sc1
    v_mfma_f32_16x16x32_bf16 v[204:207], a[232:235], a[16:19], v[204:207]
    v_mfma_f32_16x16x32_bf16 v[204:207], a[236:239], a[20:23], v[204:207]
    v_mfma_f32_16x16x32_bf16 v[192:195], a[144:147], a[24:27], 0
    v_mfma_f32_16x16x32_bf16 v[192:195], a[148:151], a[28:31], v[192:195]
    v_mfma_f32_16x16x32_bf16 v[192:195], a[152:155], a[32:35], v[192:195]
    v_cvt_pk_bf16_f32 v86, v204, v205
    v_cvt_pk_bf16_f32 v87, v206, v207
    v_mfma_f32_16x16x32_bf16 v[192:195], a[156:159], a[36:39], v[192:195]
    v_mfma_f32_16x16x32_bf16 v[192:195], a[160:163], a[40:43], v[192:195]
    buffer_store_dwordx2 v[226:227], v13, s[12:15], s16 offen offset:1152 sc1
    v_mfma_f32_16x16x32_bf16 v[192:195], a[164:167], a[44:47], v[192:195]
    s_add_u32 m0, s42, 12288
    s_add_u32 s46, s43, 786432
    v_mfma_f32_16x16x32_bf16 v[196:199], a[168:171], a[24:27], 0
    buffer_load_dwordx4 v8, s[8:11], s46 offen offset:0 nt lds
    v_mfma_f32_16x16x32_bf16 v[196:199], a[172:175], a[28:31], v[196:199]
    s_add_u32 s41, s41, 24576
    s_cmp_ge_u32 s41, 73728
    s_cselect_b32 s56, 73728, 0
    s_sub_u32 s41, s41, s56
    v_add_u32 v4, s41, v2
    v_mfma_f32_16x16x32_bf16 v[196:199], a[176:179], a[32:35], v[196:199]
    v_cvt_pk_bf16_f32 v88, v192, v193
    v_cvt_pk_bf16_f32 v89, v194, v195
    v_mfma_f32_16x16x32_bf16 v[196:199], a[180:183], a[36:39], v[196:199]
    v_add_u32 v5, s41, v3
    v_mfma_f32_16x16x32_bf16 v[196:199], a[184:187], a[40:43], v[196:199]
    v_mfma_f32_16x16x32_bf16 v[196:199], a[188:191], a[44:47], v[196:199]
    v_mfma_f32_16x16x32_bf16 v[200:203], a[192:195], a[24:27], 0
    buffer_store_dwordx4 v[228:231], v17, s[12:15], s16 offen sc1
    v_mfma_f32_16x16x32_bf16 v[200:203], a[196:199], a[28:31], v[200:203]
    v_mfma_f32_16x16x32_bf16 v[200:203], a[200:203], a[32:35], v[200:203]
    v_cvt_pk_bf16_f32 v90, v196, v197
    v_cvt_pk_bf16_f32 v91, v198, v199
    v_mfma_f32_16x16x32_bf16 v[200:203], a[204:207], a[36:39], v[200:203]
    v_mfma_f32_16x16x32_bf16 v[200:203], a[208:211], a[40:43], v[200:203]
    v_mfma_f32_16x16x32_bf16 v[200:203], a[212:215], a[44:47], v[200:203]
    v_mfma_f32_16x16x32_bf16 v[204:207], a[216:219], a[24:27], 0
    v_mfma_f32_16x16x32_bf16 v[204:207], a[220:223], a[28:31], v[204:207]
    v_mfma_f32_16x16x32_bf16 v[204:207], a[224:227], a[32:35], v[204:207]
    buffer_store_dwordx2 v[232:233], v14, s[12:15], s16 offen offset:0 sc1
    v_mfma_f32_16x16x32_bf16 v[204:207], a[228:231], a[36:39], v[204:207]
    buffer_load_dwordx4 v9, s[8:11], s46 offen offset:1024 nt lds
    v_mfma_f32_16x16x32_bf16 v[204:207], a[232:235], a[40:43], v[204:207]
    v_cvt_pk_bf16_f32 v92, v200, v201
    v_cvt_pk_bf16_f32 v93, v202, v203
    v_mfma_f32_16x16x32_bf16 v[204:207], a[236:239], a[44:47], v[204:207]
    v_mfma_f32_16x16x32_bf16 v[192:195], a[144:147], a[48:51], 0
    v_mfma_f32_16x16x32_bf16 v[192:195], a[148:151], a[52:55], v[192:195]
    v_mfma_f32_16x16x32_bf16 v[192:195], a[152:155], a[56:59], v[192:195]
    v_cvt_pk_bf16_f32 v94, v204, v205
    v_cvt_pk_bf16_f32 v95, v206, v207
    v_mfma_f32_16x16x32_bf16 v[192:195], a[156:159], a[60:63], v[192:195]
    buffer_store_dwordx2 v[234:235], v14, s[12:15], s16 offen offset:384 sc1
    v_mfma_f32_16x16x32_bf16 v[192:195], a[160:163], a[64:67], v[192:195]
    v_mfma_f32_16x16x32_bf16 v[192:195], a[164:167], a[68:71], v[192:195]
    v_mfma_f32_16x16x32_bf16 v[196:199], a[168:171], a[48:51], 0
    v_mfma_f32_16x16x32_bf16 v[196:199], a[172:175], a[52:55], v[196:199]
    v_mfma_f32_16x16x32_bf16 v[196:199], a[176:179], a[56:59], v[196:199]
    v_cvt_pk_bf16_f32 v96, v192, v193
    v_cvt_pk_bf16_f32 v97, v194, v195
    v_mfma_f32_16x16x32_bf16 v[196:199], a[180:183], a[60:63], v[196:199]
    v_mfma_f32_16x16x32_bf16 v[196:199], a[184:187], a[64:67], v[196:199]
    v_mfma_f32_16x16x32_bf16 v[196:199], a[188:191], a[68:71], v[196:199]
    buffer_store_dwordx2 v[236:237], v14, s[12:15], s16 offen offset:768 sc1
    v_mfma_f32_16x16x32_bf16 v[200:203], a[192:195], a[48:51], 0
    buffer_load_dwordx4 v10, s[8:11], s46 offen offset:2048 nt lds
    v_mfma_f32_16x16x32_bf16 v[200:203], a[196:199], a[52:55], v[200:203]
    v_mfma_f32_16x16x32_bf16 v[200:203], a[200:203], a[56:59], v[200:203]
    v_cvt_pk_bf16_f32 v98, v196, v197
    v_cvt_pk_bf16_f32 v99, v198, v199
    v_mfma_f32_16x16x32_bf16 v[200:203], a[204:207], a[60:63], v[200:203]
    v_mfma_f32_16x16x32_bf16 v[200:203], a[208:211], a[64:67], v[200:203]
    v_mfma_f32_16x16x32_bf16 v[200:203], a[212:215], a[68:71], v[200:203]
    v_mfma_f32_16x16x32_bf16 v[204:207], a[216:219], a[48:51], 0
    buffer_store_dwordx2 v[238:239], v14, s[12:15], s16 offen offset:1152 sc1
    v_mfma_f32_16x16x32_bf16 v[204:207], a[220:223], a[52:55], v[204:207]
    v_mfma_f32_16x16x32_bf16 v[204:207], a[224:227], a[56:59], v[204:207]
    v_cvt_pk_bf16_f32 v100, v200, v201
    v_cvt_pk_bf16_f32 v101, v202, v203
    v_mfma_f32_16x16x32_bf16 v[204:207], a[228:231], a[60:63], v[204:207]
    v_mfma_f32_16x16x32_bf16 v[204:207], a[232:235], a[64:67], v[204:207]
    v_mfma_f32_16x16x32_bf16 v[204:207], a[236:239], a[68:71], v[204:207]
    v_mfma_f32_16x16x32_bf16 v[192:195], a[144:147], a[72:75], 0
    v_mfma_f32_16x16x32_bf16 v[192:195], a[148:151], a[76:79], v[192:195]
    s_add_u32 m0, s42, 18432
    s_add_u32 s46, s43, 1179648
    v_mfma_f32_16x16x32_bf16 v[192:195], a[152:155], a[80:83], v[192:195]
    buffer_store_dwordx4 v[240:243], v18, s[12:15], s16 offen sc1
    v_mfma_f32_16x16x32_bf16 v[192:195], a[156:159], a[84:87], v[192:195]
    buffer_load_dwordx4 v8, s[8:11], s46 offen offset:0 nt lds
    v_mfma_f32_16x16x32_bf16 v[192:195], a[160:163], a[88:91], v[192:195]
    v_cvt_pk_bf16_f32 v102, v204, v205
    v_cvt_pk_bf16_f32 v103, v206, v207
    v_mfma_f32_16x16x32_bf16 v[192:195], a[164:167], a[92:95], v[192:195]
    v_mfma_f32_16x16x32_bf16 v[196:199], a[168:171], a[72:75], 0
    v_mfma_f32_16x16x32_bf16 v[196:199], a[172:175], a[76:79], v[196:199]
    v_mfma_f32_16x16x32_bf16 v[196:199], a[176:179], a[80:83], v[196:199]
    v_cvt_pk_bf16_f32 v104, v192, v193
    v_cvt_pk_bf16_f32 v105, v194, v195
    v_mfma_f32_16x16x32_bf16 v[196:199], a[180:183], a[84:87], v[196:199]
    v_mfma_f32_16x16x32_bf16 v[196:199], a[184:187], a[88:91], v[196:199]
    buffer_store_dwordx2 v[244:245], v15, s[12:15], s16 offen offset:0 sc1
    v_mfma_f32_16x16x32_bf16 v[196:199], a[188:191], a[92:95], v[196:199]
    v_mfma_f32_16x16x32_bf16 v[200:203], a[192:195], a[72:75], 0
    v_mfma_f32_16x16x32_bf16 v[200:203], a[196:199], a[76:79], v[200:203]
    v_mfma_f32_16x16x32_bf16 v[200:203], a[200:203], a[80:83], v[200:203]
    v_cvt_pk_bf16_f32 v106, v196, v197
    v_cvt_pk_bf16_f32 v107, v198, v199
    v_mfma_f32_16x16x32_bf16 v[200:203], a[204:207], a[84:87], v[200:203]
    v_mfma_f32_16x16x32_bf16 v[200:203], a[208:211], a[88:91], v[200:203]
    v_mfma_f32_16x16x32_bf16 v[200:203], a[212:215], a[92:95], v[200:203]
    buffer_store_dwordx2 v[246:247], v15, s[12:15], s16 offen offset:384 sc1
    v_mfma_f32_16x16x32_bf16 v[204:207], a[216:219], a[72:75], 0
    buffer_load_dwordx4 v9, s[8:11], s46 offen offset:1024 nt lds
    v_mfma_f32_16x16x32_bf16 v[204:207], a[220:223], a[76:79], v[204:207]
    s_add_u32 s42, s42, 24576
    s_cmp_ge_u32 s42, 73728
    s_cselect_b32 s57, 73728, 0
    s_sub_u32 s42, s42, s57
    v_mfma_f32_16x16x32_bf16 v[204:207], a[224:227], a[80:83], v[204:207]
    v_cvt_pk_bf16_f32 v108, v200, v201
    v_cvt_pk_bf16_f32 v109, v202, v203
    v_mfma_f32_16x16x32_bf16 v[204:207], a[228:231], a[84:87], v[204:207]
    v_mfma_f32_16x16x32_bf16 v[204:207], a[232:235], a[88:91], v[204:207]
    v_mfma_f32_16x16x32_bf16 v[204:207], a[236:239], a[92:95], v[204:207]
    v_mfma_f32_16x16x32_bf16 v[192:195], a[144:147], a[96:99], 0
    v_mfma_f32_16x16x32_bf16 v[192:195], a[148:151], a[100:103], v[192:195]
    buffer_store_dwordx2 v[248:249], v15, s[12:15], s16 offen offset:768 sc1
    v_mfma_f32_16x16x32_bf16 v[192:195], a[152:155], a[104:107], v[192:195]
    v_cvt_pk_bf16_f32 v110, v204, v205
    v_cvt_pk_bf16_f32 v111, v206, v207
    v_mfma_f32_16x16x32_bf16 v[192:195], a[156:159], a[108:111], v[192:195]
    v_mfma_f32_16x16x32_bf16 v[192:195], a[160:163], a[112:115], v[192:195]
    v_mfma_f32_16x16x32_bf16 v[192:195], a[164:167], a[116:119], v[192:195]
    v_mfma_f32_16x16x32_bf16 v[196:199], a[168:171], a[96:99], 0
    v_mfma_f32_16x16x32_bf16 v[196:199], a[172:175], a[100:103], v[196:199]
    v_mfma_f32_16x16x32_bf16 v[196:199], a[176:179], a[104:107], v[196:199]
    buffer_store_dwordx2 v[250:251], v15, s[12:15], s16 offen offset:1152 sc1
    v_mfma_f32_16x16x32_bf16 v[196:199], a[180:183], a[108:111], v[196:199]
    buffer_load_dwordx4 v10, s[8:11], s46 offen offset:2048 nt lds
    v_mfma_f32_16x16x32_bf16 v[196:199], a[184:187], a[112:115], v[196:199]
    v_cvt_pk_bf16_f32 v112, v192, v193
    v_cvt_pk_bf16_f32 v113, v194, v195
    v_mfma_f32_16x16x32_bf16 v[196:199], a[188:191], a[116:119], v[196:199]
    v_mfma_f32_16x16x32_bf16 v[200:203], a[192:195], a[96:99], 0
    v_mfma_f32_16x16x32_bf16 v[200:203], a[196:199], a[100:103], v[200:203]
    v_mfma_f32_16x16x32_bf16 v[200:203], a[200:203], a[104:107], v[200:203]
    v_cvt_pk_bf16_f32 v114, v196, v197
    v_cvt_pk_bf16_f32 v115, v198, v199
    v_mfma_f32_16x16x32_bf16 v[200:203], a[204:207], a[108:111], v[200:203]
    v_mfma_f32_16x16x32_bf16 v[200:203], a[208:211], a[112:115], v[200:203]
    buffer_store_dwordx4 v[252:255], v19, s[12:15], s16 offen sc1
    v_mfma_f32_16x16x32_bf16 v[200:203], a[212:215], a[116:119], v[200:203]
    s_nop 0
    s_mov_b32 s16, s17
    s_mov_b32 s17, s18
    v_mfma_f32_16x16x32_bf16 v[204:207], a[216:219], a[96:99], 0
    s_mov_b32 s18, s19
    s_mov_b32 s19, s43
    v_mfma_f32_16x16x32_bf16 v[204:207], a[220:223], a[100:103], v[204:207]
    v_mfma_f32_16x16x32_bf16 v[204:207], a[224:227], a[104:107], v[204:207]
    v_cvt_pk_bf16_f32 v116, v200, v201
    v_cvt_pk_bf16_f32 v117, v202, v203
    v_mfma_f32_16x16x32_bf16 v[204:207], a[228:231], a[108:111], v[204:207]
    v_mfma_f32_16x16x32_bf16 v[204:207], a[232:235], a[112:115], v[204:207]
    v_mfma_f32_16x16x32_bf16 v[204:207], a[236:239], a[116:119], v[204:207]
    s_waitcnt vmcnt(32)
    s_barrier
L_nloop1:
    v_mfma_f32_16x16x32_bf16 v[192:195], a[144:147], a[120:123], 0
    ds_read_b32 v22, v23
    v_xor_b32 v23, 4, v23
    v_mfma_f32_16x16x32_bf16 v[192:195], a[148:151], a[124:127], v[192:195]
    ds_read_b128 v[128:131], v6 offset:0
    v_cvt_pk_bf16_f32 v118, v204, v205
    v_mfma_f32_16x16x32_bf16 v[192:195], a[152:155], a[128:131], v[192:195]
    ds_read_b128 v[132:135], v6 offset:1024
    v_cvt_pk_bf16_f32 v119, v206, v207
    v_mfma_f32_16x16x32_bf16 v[192:195], a[156:159], a[132:135], v[192:195]
    ds_read_b128 v[136:139], v6 offset:2048
    v_mfma_f32_16x16x32_bf16 v[192:195], a[160:163], a[136:139], v[192:195]
    ds_read_b128 v[140:143], v6 offset:3072
    v_mfma_f32_16x16x32_bf16 v[192:195], a[164:167], a[140:143], v[192:195]
    ds_read_b128 v[144:147], v6 offset:4096
    v_mfma_f32_16x16x32_bf16 v[196:199], a[168:171], a[120:123], 0
    ds_read_b128 v[148:151], v6 offset:5120
    v_mfma_f32_16x16x32_bf16 v[196:199], a[172:175], a[124:127], v[196:199]
    ds_read_b128 v[152:155], v6 offset:6144
    v_mfma_f32_16x16x32_bf16 v[196:199], a[176:179], a[128:131], v[196:199]
    ds_read_b128 v[156:159], v6 offset:7168
    v_cvt_pk_bf16_f32 v120, v192, v193
    v_mfma_f32_16x16x32_bf16 v[196:199], a[180:183], a[132:135], v[196:199]
    s_waitcnt lgkmcnt(8)
    v_readfirstlane_b32 s43, v22
    v_mfma_f32_16x16x32_bf16 v[196:199], a[184:187], a[136:139], v[196:199]
    s_add_u32 m0, s42, 0
    s_add_u32 s46, s43, 0
    v_mfma_f32_16x16x32_bf16 v[196:199], a[188:191], a[140:143], v[196:199]
    v_cvt_pk_bf16_f32 v121, v194, v195
    v_xor_b32 v6, 8192, v6
    v_mfma_f32_16x16x32_bf16 v[200:203], a[192:195], a[120:123], 0
    buffer_load_dwordx4 v8, s[8:11], s46 offen offset:0 nt lds
    v_mfma_f32_16x16x32_bf16 v[200:203], a[196:199], a[124:127], v[200:203]
    ds_read_b128 a[144:147], v4 offset:0
    v_mfma_f32_16x16x32_bf16 v[200:203], a[200:203], a[128:131], v[200:203]
    v_cvt_pk_bf16_f32 v122, v196, v197
    v_cvt_pk_bf16_f32 v123, v198, v199
    v_mfma_f32_16x16x32_bf16 v[200:203], a[204:207], a[132:135], v[200:203]
    ds_read_b128 a[148:151], v5 offset:0
    v_mfma_f32_16x16x32_bf16 v[200:203], a[208:211], a[136:139], v[200:203]
    ds_read_b128 a[152:155], v4 offset:128
    v_mfma_f32_16x16x32_bf16 v[200:203], a[212:215], a[140:143], v[200:203]
    ds_read_b128 a[156:159], v5 offset:128
    v_mfma_f32_16x16x32_bf16 v[204:207], a[216:219], a[120:123], 0
    ds_read_b128 a[160:163], v4 offset:256
    v_mfma_f32_16x16x32_bf16 v[204:207], a[220:223], a[124:127], v[204:207]
    ds_read_b128 a[164:167], v5 offset:256
    v_mfma_f32_16x16x32_bf16 v[204:207], a[224:227], a[128:131], v[204:207]
    v_cvt_pk_bf16_f32 v124, v200, v201
    v_cvt_pk_bf16_f32 v125, v202, v203
    v_mfma_f32_16x16x32_bf16 v[204:207], a[228:231], a[132:135], v[204:207]
    ds_read_b128 a[168:171], v4 offset:6144
    v_mfma_f32_16x16x32_bf16 v[204:207], a[232:235], a[136:139], v[204:207]
    ds_read_b128 a[172:175], v5 offset:6144
    v_mfma_f32_16x16x32_bf16 v[204:207], a[236:239], a[140:143], v[204:207]
    ds_read_b128 a[176:179], v4 offset:6272
    s_waitcnt lgkmcnt(9)
    v_mfma_f32_16x16x32_bf16 v[184:187], v[128:131], v[32:35], 0
    ds_read_b128 a[180:183], v5 offset:6272
    v_mfma_f32_16x16x32_bf16 v[184:187], v[132:135], v[36:39], v[184:187]
    ds_read_b128 a[184:187], v4 offset:6400
    v_mfma_f32_16x16x32_bf16 v[188:191], v[128:131], v[40:43], 0
    v_cvt_pk_bf16_f32 v126, v204, v205
    v_cvt_pk_bf16_f32 v127, v206, v207
    v_mfma_f32_16x16x32_bf16 v[188:191], v[132:135], v[44:47], v[188:191]
    buffer_load_dwordx4 v9, s[8:11], s46 offen offset:1024 nt lds
    v_mfma_f32_16x16x32_bf16 v[192:195], v[128:131], v[48:51], 0
    ds_read_b128 a[188:191], v5 offset:6400
    v_mfma_f32_16x16x32_bf16 v[192:195], v[132:135], v[52:55], v[192:195]
    ds_read_b128 a[192:195], v4 offset:12288
    v_mfma_f32_16x16x32_bf16 v[196:199], v[128:131], v[56:59], 0
    v_cvt_pk_bf16_f32 v208, v184, v188
    v_cvt_pk_bf16_f32 v210, v185, v189
    v_mfma_f32_16x16x32_bf16 v[196:199], v[132:135], v[60:63], v[196:199]
    ds_read_b128 a[196:199], v5 offset:12288
    v_cvt_pk_bf16_f32 v212, v186, v190
    v_mfma_f32_16x16x32_bf16 v[200:203], v[64:67], v[128:131], 0
    ds_read_b128 a[200:203], v4 offset:12416
    v_cvt_pk_bf16_f32 v214, v187, v191
    v_mfma_f32_16x16x32_bf16 v[200:203], v[68:71], v[132:135], v[200:203]
    ds_read_b128 a[204:207], v5 offset:12416
    v_mfma_f32_16x16x32_bf16 v[204:207], v[72:75], v[128:131], 0
    v_cvt_pk_bf16_f32 v209, v192, v196
    v_cvt_pk_bf16_f32 v211, v193, v197
    v_mfma_f32_16x16x32_bf16 v[204:207], v[76:79], v[132:135], v[204:207]
    ds_read_b128 a[208:211], v4 offset:12544
    v_cvt_pk_bf16_f32 v213, v194, v198
    v_mfma_f32_16x16x32_bf16 v[160:163], v[136:139], v[32:35], 0
    ds_read_b128 a[212:215], v5 offset:12544
    v_cvt_pk_bf16_f32 v215, v195, v199
    v_mfma_f32_16x16x32_bf16 v[160:163], v[140:143], v[36:39], v[160:163]
    ds_read_b128 a[216:219], v4 offset:18432
    v_cvt_pk_bf16_f32 v216, v200, v201
    v_mfma_f32_16x16x32_bf16 v[164:167], v[136:139], v[40:43], 0
    ds_read_b128 a[220:223], v5 offset:18432
    v_cvt_pk_bf16_f32 v217, v202, v203
    v_mfma_f32_16x16x32_bf16 v[164:167], v[140:143], v[44:47], v[164:167]
    ds_read_b128 a[224:227], v4 offset:18560
    v_cvt_pk_bf16_f32 v218, v204, v205
    v_mfma_f32_16x16x32_bf16 v[168:171], v[136:139], v[48:51], 0
    buffer_store_dwordx2 v[208:209], v12, s[12:15], s16 offen offset:0 sc1
    v_mfma_f32_16x16x32_bf16 v[168:171], v[140:143], v[52:55], v[168:171]
    ds_read_b128 a[228:231], v5 offset:18560
    v_cvt_pk_bf16_f32 v219, v206, v207
    v_mfma_f32_16x16x32_bf16 v[172:175], v[136:139], v[56:59], 0
    buffer_load_dwordx4 v10, s[8:11], s46 offen offset:2048 nt lds
    v_mfma_f32_16x16x32_bf16 v[172:175], v[140:143], v[60:63], v[172:175]
    ds_read_b128 a[232:235], v4 offset:18688
    v_cvt_pk_bf16_f32 v220, v160, v164
    v_mfma_f32_16x16x32_bf16 v[176:179], v[64:67], v[136:139], 0
    ds_read_b128 a[236:239], v5 offset:18688
    v_cvt_pk_bf16_f32 v222, v161, v165
    v_mfma_f32_16x16x32_bf16 v[176:179], v[68:71], v[140:143], v[176:179]
    v_cvt_pk_bf16_f32 v224, v162, v166
    v_cvt_pk_bf16_f32 v226, v163, v167
    v_mfma_f32_16x16x32_bf16 v[180:183], v[72:75], v[136:139], 0
    v_cvt_pk_bf16_f32 v221, v168, v172
    v_cvt_pk_bf16_f32 v223, v169, v173
    v_mfma_f32_16x16x32_bf16 v[180:183], v[76:79], v[140:143], v[180:183]
    buffer_store_dwordx2 v[210:211], v12, s[12:15], s16 offen offset:384 sc1
    v_mfma_f32_16x16x32_bf16 v[184:187], v[144:147], v[32:35], 0
    v_cvt_pk_bf16_f32 v225, v170, v174
    v_cvt_pk_bf16_f32 v227, v171, v175
    v_mfma_f32_16x16x32_bf16 v[184:187], v[148:151], v[36:39], v[184:187]
    v_cvt_pk_bf16_f32 v228, v176, v177
    v_cvt_pk_bf16_f32 v229, v178, v179
    v_mfma_f32_16x16x32_bf16 v[188:191], v[144:147], v[40:43], 0
    v_cvt_pk_bf16_f32 v230, v180, v181
    v_cvt_pk_bf16_f32 v231, v182, v183
    v_mfma_f32_16x16x32_bf16 v[188:191], v[148:151], v[44:47], v[188:191]
    v_mfma_f32_16x16x32_bf16 v[192:195], v[144:147], v[48:51], 0
    v_mfma_f32_16x16x32_bf16 v[192:195], v[148:151], v[52:55], v[192:195]
    v_mfma_f32_16x16x32_bf16 v[196:199], v[144:147], v[56:59], 0
    v_cvt_pk_bf16_f32 v232, v184, v188
    v_cvt_pk_bf16_f32 v234, v185, v189
    v_mfma_f32_16x16x32_bf16 v[196:199], v[148:151], v[60:63], v[196:199]
    buffer_store_dwordx2 v[212:213], v12, s[12:15], s16 offen offset:768 sc1
    v_mfma_f32_16x16x32_bf16 v[200:203], v[64:67], v[144:147], 0
    s_add_u32 m0, s42, 6144
    s_add_u32 s46, s43, 393216
    v_mfma_f32_16x16x32_bf16 v[200:203], v[68:71], v[148:151], v[200:203]
    buffer_load_dwordx4 v8, s[8:11], s46 offen offset:0 nt lds
    v_mfma_f32_16x16x32_bf16 v[204:207], v[72:75], v[144:147], 0
    v_cvt_pk_bf16_f32 v233, v192, v196
    v_cvt_pk_bf16_f32 v235, v193, v197
    v_mfma_f32_16x16x32_bf16 v[204:207], v[76:79], v[148:151], v[204:207]
    v_cvt_pk_bf16_f32 v237, v194, v198
    v_cvt_pk_bf16_f32 v239, v195, v199
    v_mfma_f32_16x16x32_bf16 v[160:163], v[152:155], v[32:35], 0
    v_cvt_pk_bf16_f32 v240, v200, v201
    v_cvt_pk_bf16_f32 v241, v202, v203
    v_mfma_f32_16x16x32_bf16 v[160:163], v[156:159], v[36:39], v[160:163]
    v_cvt_pk_bf16_f32 v236, v186, v190
    v_cvt_pk_bf16_f32 v238, v187, v191
    v_mfma_f32_16x16x32_bf16 v[164:167], v[152:155], v[40:43], 0
    buffer_store_dwordx2 v[214:215], v12, s[12:15], s16 offen offset:1152 sc1
    v_mfma_f32_16x16x32_bf16 v[164:167], v[156:159], v[44:47], v[164:167]
    v_cvt_pk_bf16_f32 v242, v204, v205
    v_cvt_pk_bf16_f32 v243, v206, v207
    v_mfma_f32_16x16x32_bf16 v[168:171], v[152:155], v[48:51], 0
    v_mfma_f32_16x16x32_bf16 v[168:171], v[156:159], v[52:55], v[168:171]
    v_mfma_f32_16x16x32_bf16 v[172:175], v[152:155], v[56:59], 0
    v_cvt_pk_bf16_f32 v244, v160, v164
    v_cvt_pk_bf16_f32 v246, v161, v165
    v_mfma_f32_16x16x32_bf16 v[172:175], v[156:159], v[60:63], v[172:175]
    v_cvt_pk_bf16_f32 v248, v162, v166
    v_cvt_pk_bf16_f32 v250, v163, v167
    v_mfma_f32_16x16x32_bf16 v[176:179], v[64:67], v[152:155], 0
    v_mfma_f32_16x16x32_bf16 v[176:179], v[68:71], v[156:159], v[176:179]
    v_mfma_f32_16x16x32_bf16 v[180:183], v[72:75], v[152:155], 0
    buffer_store_dwordx4 v[216:219], v16, s[12:15], s16 offen sc1
    v_mfma_f32_16x16x32_bf16 v[180:183], v[76:79], v[156:159], v[180:183]
    v_cvt_pk_bf16_f32 v245, v168, v172
    s_cmp_ge_u32 s18, 100663296
    s_cbranch_scc1 L_nepi1
L_nmid1:
    s_waitcnt lgkmcnt(0)
    v_mfma_f32_16x16x32_bf16 v[192:195], a[144:147], a[0:3], 0
    buffer_load_dwordx4 v9, s[8:11], s46 offen offset:1024 nt lds
    v_mfma_f32_16x16x32_bf16 v[192:195], a[148:151], a[4:7], v[192:195]
    v_cvt_pk_bf16_f32 v247, v169, v173
    v_cvt_pk_bf16_f32 v249, v170, v174
    v_mfma_f32_16x16x32_bf16 v[192:195], a[152:155], a[8:11], v[192:195]
    v_cvt_pk_bf16_f32 v251, v171, v175
    v_cvt_pk_bf16_f32 v252, v176, v177
    v_mfma_f32_16x16x32_bf16 v[192:195], a[156:159], a[12:15], v[192:195]
    v_cvt_pk_bf16_f32 v253, v178, v179
    v_cvt_pk_bf16_f32 v254, v180, v181
    v_mfma_f32_16x16x32_bf16 v[192:195], a[160:163], a[16:19], v[192:195]
    v_cvt_pk_bf16_f32 v255, v182, v183
    v_mfma_f32_16x16x32_bf16 v[192:195], a[164:167], a[20:23], v[192:195]
    v_mfma_f32_16x16x32_bf16 v[196:199], a[168:171], a[0:3], 0
    buffer_store_dwordx2 v[220:221], v13, s[12:15], s16 offen offset:0 sc1
    v_mfma_f32_16x16x32_bf16 v[196:199], a[172:175], a[4:7], v[196:199]
    v_mfma_f32_16x16x32_bf16 v[196:199], a[176:179], a[8:11], v[196:199]
    v_cvt_pk_bf16_f32 v32, v192, v193
    v_cvt_pk_bf16_f32 v33, v194, v195
    v_mfma_f32_16x16x32_bf16 v[196:199], a[180:183], a[12:15], v[196:199]
    v_mfma_f32_16x16x32_bf16 v[196:199], a[184:187], a[16:19], v[196:199]
    v_mfma_f32_16x16x32_bf16 v[196:199], a[188:191], a[20:23], v[196:199]
    v_mfma_f32_16x16x32_bf16 v[200:203], a[192:195], a[0:3], 0
    v_mfma_f32_16x16x32_bf16 v[200:203], a[196:199], a[4:7], v[200:203]
    buffer_store_dwordx2 v[222:223], v13, s[12:15], s16 offen offset:384 sc1
    v_mfma_f32_16x16x32_bf16 v[200:203], a[200:203], a[8:11], v[200:203]
    v_cvt_pk_bf16_f32 v34, v196, v197
    v_cvt_pk_bf16_f32 v35, v198, v199
    v_mfma_f32_16x16x32_bf16 v[200:203], a[204:207], a[12:15], v[200:203]
    buffer_load_dwordx4 v10, s[8:11], s46 offen offset:2048 nt lds
    v_mfma_f32_16x16x32_bf16 v[200:203], a[208:211], a[16:19], v[200:203]
    v_mfma_f32_16x16x32_bf16 v[200:203], a[212:215], a[20:23], v[200:203]
    v_mfma_f32_16x16x32_bf16 v[204:207], a[216:219], a[0:3], 0
    v_mfma_f32_16x16x32_bf16 v[204:207], a[220:223], a[4:7], v[204:207]
    v_mfma_f32_16x16x32_bf16 v[204:207], a[224:227], a[8:11], v[204:207]
    v_cvt_pk_bf16_f32 v36, v200, v201
    v_cvt_pk_bf16_f32 v37, v202, v203
    v_mfma_f32_16x16x32_bf16 v[204:207], a[228:231], a[12:15], v[204:207]
    buffer_store_dwordx2 v[224:225], v13, s[12:15], s16 offen offset:768 sc1
    v_mfma_f32_16x16x32_bf16 v[204:207], a[232:235], a[16:19], v[204:207]
    v_mfma_f32_16x16x32_bf16 v[204:207], a[236:239], a[20:23], v[204:207]
    v_mfma_f32_16x16x32_bf16 v[192:195], a[144:147], a[24:27], 0
    v_mfma_f32_16x16x32_bf16 v[192:195], a[148:151], a[28:31], v[192:195]
    v_mfma_f32_16x16x32_bf16 v[192:195], a[152:155], a[32:35], v[192:195]
    v_cvt_pk_bf16_f32 v38, v204, v205
    v_cvt_pk_bf16_f32 v39, v206, v207
    v_mfma_f32_16x16x32_bf16 v[192:195], a[156:159], a[36:39], v[192:195]
    v_mfma_f32_16x16x32_bf16 v[192:195], a[160:163], a[40:43], v[192:195]
    buffer_store_dwordx2 v[226:227], v13, s[12:15], s16 offen offset:1152 sc1
    v_mfma_f32_16x16x32_bf16 v[192:195], a[164:167], a[44:47], v[192:195]
    s_add_u32 m0, s42, 12288
    s_add_u32 s46, s43, 786432
    v_mfma_f32_16x16x32_bf16 v[196:199], a[168:171], a[24:27], 0
    buffer_load_dwordx4 v8, s[8:11], s46 offen offset:0 nt lds
    v_mfma_f32_16x16x32_bf16 v[196:199], a[172:175], a[28:31], v[196:199]
    s_add_u32 s41, s41, 24576
    s_cmp_ge_u32 s41, 73728
    s_cselect_b32 s56, 73728, 0
    s_sub_u32 s41, s41, s56
    v_add_u32 v4, s41, v2
    v_mfma_f32_16x16x32_bf16 v[196:199], a[176:179], a[32:35], v[196:199]
    v_cvt_pk_bf16_f32 v40, v192, v193
    v_cvt_pk_bf16_f32 v41, v194, v195
    v_mfma_f32_16x16x32_bf16 v[196:199], a[180:183], a[36:39], v[196:199]
    v_add_u32 v5, s41, v3
    v_mfma_f32_16x16x32_bf16 v[196:199], a[184:187], a[40:43], v[196:199]
    v_mfma_f32_16x16x32_bf16 v[196:199], a[188:191], a[44:47], v[196:199]
    v_mfma_f32_16x16x32_bf16 v[200:203], a[192:195], a[24:27], 0
    buffer_store_dwordx4 v[228:231], v17, s[12:15], s16 offen sc1
    v_mfma_f32_16x16x32_bf16 v[200:203], a[196:199], a[28:31], v[200:203]
    v_mfma_f32_16x16x32_bf16 v[200:203], a[200:203], a[32:35], v[200:203]
    v_cvt_pk_bf16_f32 v42, v196, v197
    v_cvt_pk_bf16_f32 v43, v198, v199
    v_mfma_f32_16x16x32_bf16 v[200:203], a[204:207], a[36:39], v[200:203]
    v_mfma_f32_16x16x32_bf16 v[200:203], a[208:211], a[40:43], v[200:203]
    v_mfma_f32_16x16x32_bf16 v[200:203], a[212:215], a[44:47], v[200:203]
    v_mfma_f32_16x16x32_bf16 v[204:207], a[216:219], a[24:27], 0
    v_mfma_f32_16x16x32_bf16 v[204:207], a[220:223], a[28:31], v[204:207]
    v_mfma_f32_16x16x32_bf16 v[204:207], a[224:227], a[32:35], v[204:207]
    buffer_store_dwordx2 v[232:233], v14, s[12:15], s16 offen offset:0 sc1
    v_mfma_f32_16x16x32_bf16 v[204:207], a[228:231], a[36:39], v[204:207]
    buffer_load_dwordx4 v9, s[8:11], s46 offen offset:1024 nt lds
    v_mfma_f32_16x16x32_bf16 v[204:207], a[232:235], a[40:43], v[204:207]
    v_cvt_pk_bf16_f32 v44, v200, v201
    v_cvt_pk_bf16_f32 v45, v202, v203
    v_mfma_f32_16x16x32_bf16 v[204:207], a[236:239], a[44:47], v[204:207]
    v_mfma_f32_16x16x32_bf16 v[192:195], a[144:147], a[48:51], 0
    v_mfma_f32_16x16x32_bf16 v[192:195], a[148:151], a[52:55], v[192:195]
    v_mfma_f32_16x16x32_bf16 v[192:195], a[152:155], a[56:59], v[192:195]
    v_cvt_pk_bf16_f32 v46, v204, v205
    v_cvt_pk_bf16_f32 v47, v206, v207
    v_mfma_f32_16x16x32_bf16 v[192:195], a[156:159], a[60:63], v[192:195]
    buffer_store_dwordx2 v[234:235], v14, s[12:15], s16 offen offset:384 sc1
    v_mfma_f32_16x16x32_bf16 v[192:195], a[160:163], a[64:67], v[192:195]
    v_mfma_f32_16x16x32_bf16 v[192:195], a[164:167], a[68:71], v[192:195]
    v_mfma_f32_16x16x32_bf16 v[196:199], a[168:171], a[48:51], 0
    v_mfma_f32_16x16x32_bf16 v[196:199], a[172:175], a[52:55], v[196:199]
    v_mfma_f32_16x16x32_bf16 v[196:199], a[176:179], a[56:59], v[196:199]
    v_cvt_pk_bf16_f32 v48, v192, v193
    v_cvt_pk_bf16_f32 v49, v194, v195
    v_mfma_f32_16x16x32_bf16 v[196:199], a[180:183], a[60:63], v[196:199]
    v_mfma_f32_16x16x32_bf16 v[196:199], a[184:187], a[64:67], v[196:199]
    v_mfma_f32_16x16x32_bf16 v[196:199], a[188:191], a[68:71], v[196:199]
    buffer_store_dwordx2 v[236:237], v14, s[12:15], s16 offen offset:768 sc1
    v_mfma_f32_16x16x32_bf16 v[200:203], a[192:195], a[48:51], 0
    buffer_load_dwordx4 v10, s[8:11], s46 offen offset:2048 nt lds
    v_mfma_f32_16x16x32_bf16 v[200:203], a[196:199], a[52:55], v[200:203]
    v_mfma_f32_16x16x32_bf16 v[200:203], a[200:203], a[56:59], v[200:203]
    v_cvt_pk_bf16_f32 v50, v196, v197
    v_cvt_pk_bf16_f32 v51, v198, v199
    v_mfma_f32_16x16x32_bf16 v[200:203], a[204:207], a[60:63], v[200:203]
    v_mfma_f32_16x16x32_bf16 v[200:203], a[208:211], a[64:67], v[200:203]
    v_mfma_f32_16x16x32_bf16 v[200:203], a[212:215], a[68:71], v[200:203]
    v_mfma_f32_16x16x32_bf16 v[204:207], a[216:219], a[48:51], 0
    buffer_store_dwordx2 v[238:239], v14, s[12:15], s16 offen offset:1152 sc1
    v_mfma_f32_16x16x32_bf16 v[204:207], a[220:223], a[52:55], v[204:207]
    v_mfma_f32_16x16x32_bf16 v[204:207], a[224:227], a[56:59], v[204:207]
    v_cvt_pk_bf16_f32 v52, v200, v201
    v_cvt_pk_bf16_f32 v53, v202, v203
    v_mfma_f32_16x16x32_bf16 v[204:207], a[228:231], a[60:63], v[204:207]
    v_mfma_f32_16x16x32_bf16 v[204:207], a[232:235], a[64:67], v[204:207]
    v_mfma_f32_16x16x32_bf16 v[204:207], a[236:239], a[68:71], v[204:207]
    v_mfma_f32_16x16x32_bf16 v[192:195], a[144:147], a[72:75], 0
    v_mfma_f32_16x16x32_bf16 v[192:195], a[148:151], a[76:79], v[192:195]
    s_add_u32 m0, s42, 18432
    s_add_u32 s46, s43, 1179648
    v_mfma_f32_16x16x32_bf16 v[192:195], a[152:155], a[80:83], v[192:195]
    buffer_store_dwordx4 v[240:243], v18, s[12:15], s16 offen sc1
    v_mfma_f32_16x16x32_bf16 v[192:195], a[156:159], a[84:87], v[192:195]
    buffer_load_dwordx4 v8, s[8:11], s46 offen offset:0 nt lds
    v_mfma_f32_16x16x32_bf16 v[192:195], a[160:163], a[88:91], v[192:195]
    v_cvt_pk_bf16_f32 v54, v204, v205
    v_cvt_pk_bf16_f32 v55, v206, v207
    v_mfma_f32_16x16x32_bf16 v[192:195], a[164:167], a[92:95], v[192:195]
    v_mfma_f32_16x16x32_bf16 v[196:199], a[168:171], a[72:75], 0
    v_mfma_f32_16x16x32_bf16 v[196:199], a[172:175], a[76:79], v[196:199]
    v_mfma_f32_16x16x32_bf16 v[196:199], a[176:179], a[80:83], v[196:199]
    v_cvt_pk_bf16_f32 v56, v192, v193
    v_cvt_pk_bf16_f32 v57, v194, v195
    v_mfma_f32_16x16x32_bf16 v[196:199], a[180:183], a[84:87], v[196:199]
    v_mfma_f32_16x16x32_bf16 v[196:199], a[184:187], a[88:91], v[196:199]
    buffer_store_dwordx2 v[244:245], v15, s[12:15], s16 offen offset:0 sc1
    v_mfma_f32_16x16x32_bf16 v[196:199], a[188:191], a[92:95], v[196:199]
    v_mfma_f32_16x16x32_bf16 v[200:203], a[192:195], a[72:75], 0
    v_mfma_f32_16x16x32_bf16 v[200:203], a[196:199], a[76:79], v[200:203]
    v_mfma_f32_16x16x32_bf16 v[200:203], a[200:203], a[80:83], v[200:203]
    v_cvt_pk_bf16_f32 v58, v196, v197
    v_cvt_pk_bf16_f32 v59, v198, v199
    v_mfma_f32_16x16x32_bf16 v[200:203], a[204:207], a[84:87], v[200:203]
    v_mfma_f32_16x16x32_bf16 v[200:203], a[208:211], a[88:91], v[200:203]
    v_mfma_f32_16x16x32_bf16 v[200:203], a[212:215], a[92:95], v[200:203]
    buffer_store_dwordx2 v[246:247], v15, s[12:15], s16 offen offset:384 sc1
    v_mfma_f32_16x16x32_bf16 v[204:207], a[216:219], a[72:75], 0
    buffer_load_dwordx4 v9, s[8:11], s46 offen offset:1024 nt lds
    v_mfma_f32_16x16x32_bf16 v[204:207], a[220:223], a[76:79], v[204:207]
    s_add_u32 s42, s42, 24576
    s_cmp_ge_u32 s42, 73728
    s_cselect_b32 s57, 73728, 0
    s_sub_u32 s42, s42, s57
    v_mfma_f32_16x16x32_bf16 v[204:207], a[224:227], a[80:83], v[204:207]
    v_cvt_pk_bf16_f32 v60, v200, v201
    v_cvt_pk_bf16_f32 v61, v202, v203
    v_mfma_f32_16x16x32_bf16 v[204:207], a[228:231], a[84:87], v[204:207]
    v_mfma_f32_16x16x32_bf16 v[204:207], a[232:235], a[88:91], v[204:207]
    v_mfma_f32_16x16x32_bf16 v[204:207], a[236:239], a[92:95], v[204:207]
    v_mfma_f32_16x16x32_bf16 v[192:195], a[144:147], a[96:99], 0
    v_mfma_f32_16x16x32_bf16 v[192:195], a[148:151], a[100:103], v[192:195]
    buffer_store_dwordx2 v[248:249], v15, s[12:15], s16 offen offset:768 sc1
    v_mfma_f32_16x16x32_bf16 v[192:195], a[152:155], a[104:107], v[192:195]
    v_cvt_pk_bf16_f32 v62, v204, v205
    v_cvt_pk_bf16_f32 v63, v206, v207
    v_mfma_f32_16x16x32_bf16 v[192:195], a[156:159], a[108:111], v[192:195]
    v_mfma_f32_16x16x32_bf16 v[192:195], a[160:163], a[112:115], v[192:195]
    v_mfma_f32_16x16x32_bf16 v[192:195], a[164:167], a[116:119], v[192:195]
    v_mfma_f32_16x16x32_bf16 v[196:199], a[168:171], a[96:99], 0
    v_mfma_f32_16x16x32_bf16 v[196:199], a[172:175], a[100:103], v[196:199]
    v_mfma_f32_16x16x32_bf16 v[196:199], a[176:179], a[104:107], v[196:199]
    buffer_store_dwordx2 v[250:251], v15, s[12:15], s16 offen offset:1152 sc1
    v_mfma_f32_16x16x32_bf16 v[196:199], a[180:183], a[108:111], v[196:199]
    buffer_load_dwordx4 v10, s[8:11], s46 offen offset:2048 nt lds
    v_mfma_f32_16x16x32_bf16 v[196:199], a[184:187], a[112:115], v[196:199]
    v_cvt_pk_bf16_f32 v64, v192, v193
    v_cvt_pk_bf16_f32 v65, v194, v195
    v_mfma_f32_16x16x32_bf16 v[196:199], a[188:191], a[116:119], v[196:199]
    v_mfma_f32_16x16x32_bf16 v[200:203], a[192:195], a[96:99], 0
    v_mfma_f32_16x16x32_bf16 v[200:203], a[196:199], a[100:103], v[200:203]
    v_mfma_f32_16x16x32_bf16 v[200:203], a[200:203], a[104:107], v[200:203]
    v_cvt_pk_bf16_f32 v66, v196, v197
    v_cvt_pk_bf16_f32 v67, v198, v199
    v_mfma_f32_16x16x32_bf16 v[200:203], a[204:207], a[108:111], v[200:203]
    v_mfma_f32_16x16x32_bf16 v[200:203], a[208:211], a[112:115], v[200:203]
    buffer_store_dwordx4 v[252:255], v19, s[12:15], s16 offen sc1
    v_mfma_f32_16x16x32_bf16 v[200:203], a[212:215], a[116:119], v[200:203]
    s_nop 0
    s_mov_b32 s16, s17
    s_mov_b32 s17, s18
    v_mfma_f32_16x16x32_bf16 v[204:207], a[216:219], a[96:99], 0
    s_mov_b32 s18, s19
    s_mov_b32 s19, s43
    v_mfma_f32_16x16x32_bf16 v[204:207], a[220:223], a[100:103], v[204:207]
    v_mfma_f32_16x16x32_bf16 v[204:207], a[224:227], a[104:107], v[204:207]
    v_cvt_pk_bf16_f32 v68, v200, v201
    v_cvt_pk_bf16_f32 v69, v202, v203
    v_mfma_f32_16x16x32_bf16 v[204:207], a[228:231], a[108:111], v[204:207]
    v_mfma_f32_16x16x32_bf16 v[204:207], a[232:235], a[112:115], v[204:207]
    v_mfma_f32_16x16x32_bf16 v[204:207], a[236:239], a[116:119], v[204:207]
    s_waitcnt vmcnt(32)
    s_barrier
    s_branch L_nloop0
L_nepi0:
    v_cvt_pk_bf16_f32 v247, v169, v173
    v_cvt_pk_bf16_f32 v249, v170, v174
    v_cvt_pk_bf16_f32 v251, v171, v175
    v_cvt_pk_bf16_f32 v252, v176, v177
    v_cvt_pk_bf16_f32 v253, v178, v179
    v_cvt_pk_bf16_f32 v254, v180, v181
    v_cvt_pk_bf16_f32 v255, v182, v183
    buffer_store_dwordx2 v[220:221], v13, s[12:15], s16 offen offset:0 sc1
    buffer_store_dwordx2 v[222:223], v13, s[12:15], s16 offen offset:384 sc1
    buffer_store_dwordx2 v[224:225], v13, s[12:15], s16 offen offset:768 sc1
    buffer_store_dwordx2 v[226:227], v13, s[12:15], s16 offen offset:1152 sc1
    buffer_store_dwordx4 v[228:231], v17, s[12:15], s16 offen sc1
    buffer_store_dwordx2 v[232:233], v14, s[12:15], s16 offen offset:0 sc1
    buffer_store_dwordx2 v[234:235], v14, s[12:15], s16 offen offset:384 sc1
    buffer_store_dwordx2 v[236:237], v14, s[12:15], s16 offen offset:768 sc1
    buffer_store_dwordx2 v[238:239], v14, s[12:15], s16 offen offset:1152 sc1
    buffer_store_dwordx4 v[240:243], v18, s[12:15], s16 offen sc1
    buffer_store_dwordx2 v[244:245], v15, s[12:15], s16 offen offset:0 sc1
    buffer_store_dwordx2 v[246:247], v15, s[12:15], s16 offen offset:384 sc1
    buffer_store_dwordx2 v[248:249], v15, s[12:15], s16 offen offset:768 sc1
    buffer_store_dwordx2 v[250:251], v15, s[12:15], s16 offen offset:1152 sc1
    buffer_store_dwordx4 v[252:255], v19, s[12:15], s16 offen sc1
    s_cmp_ge_u32 s17, 100663296
    s_cbranch_scc1 L_fin
    s_mov_b32 s16, s17
    s_mov_b32 s17, s18
    s_mov_b32 s18, s19
    s_mov_b32 s19, s43
    s_barrier
    s_branch L_nloop1
L_nepi1:
    v_cvt_pk_bf16_f32 v247, v169, v173
    v_cvt_pk_bf16_f32 v249, v170, v174
    v_cvt_pk_bf16_f32 v251, v171, v175
    v_cvt_pk_bf16_f32 v252, v176, v177
    v_cvt_pk_bf16_f32 v253, v178, v179
    v_cvt_pk_bf16_f32 v254, v180, v181
    v_cvt_pk_bf16_f32 v255, v182, v183
    buffer_store_dwordx2 v[220:221], v13, s[12:15], s16 offen offset:0 sc1
    buffer_store_dwordx2 v[222:223], v13, s[12:15], s16 offen offset:384 sc1
    buffer_store_dwordx2 v[224:225], v13, s[12:15], s16 offen offset:768 sc1
    buffer_store_dwordx2 v[226:227], v13, s[12:15], s16 offen offset:1152 sc1
    buffer_store_dwordx4 v[228:231], v17, s[12:15], s16 offen sc1
    buffer_store_dwordx2 v[232:233], v14, s[12:15], s16 offen offset:0 sc1
    buffer_store_dwordx2 v[234:235], v14, s[12:15], s16 offen offset:384 sc1
    buffer_store_dwordx2 v[236:237], v14, s[12:15], s16 offen offset:768 sc1
    buffer_store_dwordx2 v[238:239], v14, s[12:15], s16 offen offset:1152 sc1
    buffer_store_dwordx4 v[240:243], v18, s[12:15], s16 offen sc1
    buffer_store_dwordx2 v[244:245], v15, s[12:15], s16 offen offset:0 sc1
    buffer_store_dwordx2 v[246:247], v15, s[12:15], s16 offen offset:384 sc1
    buffer_store_dwordx2 v[248:249], v15, s[12:15], s16 offen offset:768 sc1
    buffer_store_dwordx2 v[250:251], v15, s[12:15], s16 offen offset:1152 sc1
    buffer_store_dwordx4 v[252:255], v19, s[12:15], s16 offen sc1
    s_cmp_ge_u32 s17, 100663296
    s_cbranch_scc1 L_fin
    s_mov_b32 s16, s17
    s_mov_b32 s17, s18
    s_mov_b32 s18, s19
    s_mov_b32 s19, s43
    s_barrier
    s_branch L_nloop0
L_fin:
L_end:
    s_endpgm
L_codeend:
.section .rodata,"a"
.p2align 6
.amdhsa_kernel swin_prep_kernel
  .amdhsa_next_free_vgpr 136
  .amdhsa_next_free_sgpr 40
  .amdhsa_accum_offset 136
  .amdhsa_group_segment_fixed_size 0
  .amdhsa_kernarg_size 48
  .amdhsa_user_sgpr_count 2
  .amdhsa_user_sgpr_kernarg_segment_ptr 1
  .amdhsa_system_sgpr_workgroup_id_x 1
.end_amdhsa_kernel
.p2align 6
.amdhsa_kernel standalone__swin_window_attn__vision_kernel
  .amdhsa_next_free_vgpr 512
  .amdhsa_next_free_sgpr 100
  .amdhsa_accum_offset 256
  .amdhsa_group_segment_fixed_size 0
  .amdhsa_kernarg_size 48
  .amdhsa_user_sgpr_count 2
  .amdhsa_user_sgpr_kernarg_segment_ptr 1
  .amdhsa_system_sgpr_workgroup_id_x 1
.end_amdhsa_kernel
```

```asm
; @launch kernel=swin_prep_kernel grid=(256,1,1) block=(64,1,1) lds=6144
; @launch kernel=standalone__swin_window_attn__vision_kernel grid=(256,1,1) block=(256,1,1) lds=163840
.amdgcn_target "amdgcn-amd-amdhsa--gfx950"
.text
.globl swin_prep_kernel
.p2align 8
.type swin_prep_kernel,@function
swin_prep_kernel:
    s_cmp_ge_u32 s2, 144
    s_cbranch_scc1 L_prep_pf
    s_load_dwordx4 s[4:7], s[0:1], 8
    s_load_dwordx2 s[8:9], s[0:1], 40
    s_load_dwordx2 s[36:37], s[0:1], 0
    v_and_b32 v1, 15, v0
    v_lshrrev_b32 v2, 4, v0
    v_lshrrev_b32 v3, 2, v1
    v_lshlrev_b32 v3, 3, v3
    v_and_b32 v4, 3, v1
    v_add_u32 v3, v3, v4
    s_cmp_ge_u32 s2, 72
    s_cselect_b32 s20, 1, 0
    s_cselect_b32 s21, 72, 0
    s_sub_u32 s21, s2, s21
    s_mul_i32 s22, s21, 43
    s_lshr_b32 s22, s22, 8
    s_mul_i32 s23, s22, 6
    s_sub_u32 s23, s21, s23
    s_waitcnt lgkmcnt(0)
    s_mov_b32 s12, s4
    s_mov_b32 s13, s5
    s_mov_b32 s14, 221184
    s_mov_b32 s15, 0x00020000
    s_mov_b32 s16, s6
    s_mov_b32 s17, s7
    s_mov_b32 s18, 73728
    s_mov_b32 s19, 0x00020000
    s_mov_b32 s24, s8
    s_mov_b32 s25, s9
    s_mov_b32 s26, 149504
    s_mov_b32 s27, 0x00020000
    s_lshl_b32 s28, s23, 5
    v_add_u32 v6, s28, v3
    s_movk_i32 s29, 1152
    v_mul_lo_u32 v6, v6, s29
    v_lshl_add_u32 v6, v2, 4, v6
    s_mul_i32 s30, s20, 768
    v_add_u32 v6, s30, v6
    v_add_u32 v7, 4608, v6
    buffer_load_dwordx4 v[16:19], v6, s[12:15], 0 offen offset:0
    buffer_load_dwordx4 v[40:43], v7, s[12:15], 0 offen offset:0
    buffer_load_dwordx4 v[20:23], v6, s[12:15], 0 offen offset:64
    buffer_load_dwordx4 v[44:47], v7, s[12:15], 0 offen offset:64
    buffer_load_dwordx4 v[24:27], v6, s[12:15], 0 offen offset:128
    buffer_load_dwordx4 v[48:51], v7, s[12:15], 0 offen offset:128
    buffer_load_dwordx4 v[28:31], v6, s[12:15], 0 offen offset:192
    buffer_load_dwordx4 v[52:55], v7, s[12:15], 0 offen offset:192
    buffer_load_dwordx4 v[32:35], v6, s[12:15], 0 offen offset:256
    buffer_load_dwordx4 v[56:59], v7, s[12:15], 0 offen offset:256
    buffer_load_dwordx4 v[36:39], v6, s[12:15], 0 offen offset:320
    buffer_load_dwordx4 v[60:63], v7, s[12:15], 0 offen offset:320
    s_cmp_eq_u32 s20, 1
    s_cbranch_scc1 L_prep_N
    s_lshr_b32 s28, s22, 1
    s_lshl_b32 s28, s28, 5
    s_and_b32 s31, s22, 1
    s_lshl_b32 s31, s31, 2
    s_add_u32 s28, s28, s31
    v_add_u32 v8, s28, v3
    v_mul_lo_u32 v8, v8, s29
    v_lshl_add_u32 v8, v2, 4, v8
    buffer_load_dwordx4 v[64:67], v8, s[12:15], 0 offen offset:384
    buffer_load_dwordx4 v[68:71], v8, s[12:15], 0 offen offset:448
    buffer_load_dwordx4 v[72:75], v8, s[12:15], 0 offen offset:512
    buffer_load_dwordx4 v[76:79], v8, s[12:15], 0 offen offset:576
    buffer_load_dwordx4 v[80:83], v8, s[12:15], 0 offen offset:640
    buffer_load_dwordx4 v[84:87], v8, s[12:15], 0 offen offset:704
    s_lshl_b32 s28, s21, 10
    v_lshlrev_b32 v9, 4, v0
    v_lshlrev_b32 v12, 7, v0
    s_mul_i32 s35, s2, 24576
    s_add_u32 s35, s35, 6291456
    s_mov_b32 s38, 12582912
    s_mov_b32 s39, 0x00020000
    buffer_load_dword v13, v12, s[36:39], s35 offen
    s_add_u32 s35, s35, 8192
    buffer_load_dword v13, v12, s[36:39], s35 offen
    s_add_u32 s35, s35, 8192
    buffer_load_dword v13, v12, s[36:39], s35 offen
    s_branch L_prep_mm
L_prep_N:
    v_lshrrev_b32 v8, 1, v0
    v_mul_u32_u24 v8, 384, v8
    v_and_b32 v9, 1, v0
    v_lshl_add_u32 v8, v9, 4, v8
    s_lshl_b32 s28, s22, 5
    s_mov_b32 m0, 0
    s_add_u32 s34, s28, 0
    buffer_load_dwordx4 v8, s[16:19], s34 offen lds
    s_mov_b32 m0, 1024
    s_add_u32 s34, s28, 12288
    buffer_load_dwordx4 v8, s[16:19], s34 offen lds
    s_mov_b32 m0, 2048
    s_add_u32 s34, s28, 24576
    buffer_load_dwordx4 v8, s[16:19], s34 offen lds
    s_mov_b32 m0, 3072
    s_add_u32 s34, s28, 36864
    buffer_load_dwordx4 v8, s[16:19], s34 offen lds
    s_mov_b32 m0, 4096
    s_add_u32 s34, s28, 49152
    buffer_load_dwordx4 v8, s[16:19], s34 offen lds
    s_mov_b32 m0, 5120
    s_add_u32 s34, s28, 61440
    buffer_load_dwordx4 v8, s[16:19], s34 offen lds
    v_lshlrev_b32 v8, 3, v2
    v_lshrrev_b32 v9, 2, v0
    v_and_b32 v9, 3, v9
    v_add_u32 v8, v8, v9
    v_lshlrev_b32 v8, 5, v8
    v_and_b32 v10, 3, v0
    v_lshl_add_u32 v8, v10, 3, v8
    v_lshlrev_b32 v12, 7, v0
    s_mul_i32 s35, s2, 24576
    s_add_u32 s35, s35, 6291456
    s_mov_b32 s38, 12582912
    s_mov_b32 s39, 0x00020000
    buffer_load_dword v13, v12, s[36:39], s35 offen
    s_add_u32 s35, s35, 8192
    buffer_load_dword v13, v12, s[36:39], s35 offen
    s_add_u32 s35, s35, 8192
    buffer_load_dword v13, v12, s[36:39], s35 offen
    s_waitcnt vmcnt(3)
    ds_read_b64_tr_b16 v[64:65], v8 offset:0
    ds_read_b64_tr_b16 v[66:67], v8 offset:128
    ds_read_b64_tr_b16 v[68:69], v8 offset:1024
    ds_read_b64_tr_b16 v[70:71], v8 offset:1152
    ds_read_b64_tr_b16 v[72:73], v8 offset:2048
    ds_read_b64_tr_b16 v[74:75], v8 offset:2176
    ds_read_b64_tr_b16 v[76:77], v8 offset:3072
    ds_read_b64_tr_b16 v[78:79], v8 offset:3200
    ds_read_b64_tr_b16 v[80:81], v8 offset:4096
    ds_read_b64_tr_b16 v[82:83], v8 offset:4224
    ds_read_b64_tr_b16 v[84:85], v8 offset:5120
    ds_read_b64_tr_b16 v[86:87], v8 offset:5248
    v_and_b32 v9, 3, v1
    v_lshlrev_b32 v10, 8, v2
    v_lshrrev_b32 v11, 2, v1
    s_lshl_b32 s33, s23, 10
    s_add_u32 s33, s33, 73728
    s_cmp_ge_u32 s22, 8
    s_cbranch_scc1 L_prep_N2
    v_mul_u32_u24 v9, 6144, v9
    v_lshlrev_b32 v11, 4, v11
    v_add3_u32 v9, v9, v10, v11
    s_lshr_b32 s28, s22, 2
    s_mul_i32 s28, s28, 36864
    s_and_b32 s34, s22, 3
    s_lshl_b32 s34, s34, 6
    s_branch L_prep_N3
L_prep_N2:
    v_lshlrev_b32 v9, 4, v9
    v_and_b32 v12, 1, v11
    v_mul_u32_u24 v12, 6144, v12
    v_lshrrev_b32 v11, 3, v1
    v_lshlrev_b32 v11, 6, v11
    v_add3_u32 v9, v9, v10, v11
    v_add_u32 v9, v9, v12
    s_sub_u32 s34, s22, 8
    s_lshr_b32 s28, s34, 1
    s_mul_i32 s28, s28, 36864
    s_add_u32 s28, s28, 24576
    s_and_b32 s34, s34, 1
    s_lshl_b32 s34, s34, 7
L_prep_N3:
    s_add_u32 s28, s28, s34
    s_add_u32 s28, s28, s33
    s_waitcnt lgkmcnt(0)
L_prep_mm:
    s_waitcnt vmcnt(3)
    v_mfma_f32_16x16x32_bf16 v[112:115], v[16:19], v[64:67], 0
    v_mfma_f32_16x16x32_bf16 v[116:119], v[40:43], v[64:67], 0
    v_mfma_f32_16x16x32_bf16 v[112:115], v[20:23], v[68:71], v[112:115]
    v_mfma_f32_16x16x32_bf16 v[116:119], v[44:47], v[68:71], v[116:119]
    v_mfma_f32_16x16x32_bf16 v[112:115], v[24:27], v[72:75], v[112:115]
    v_mfma_f32_16x16x32_bf16 v[116:119], v[48:51], v[72:75], v[116:119]
    v_mfma_f32_16x16x32_bf16 v[112:115], v[28:31], v[76:79], v[112:115]
    v_mfma_f32_16x16x32_bf16 v[116:119], v[52:55], v[76:79], v[116:119]
    v_mfma_f32_16x16x32_bf16 v[112:115], v[32:35], v[80:83], v[112:115]
    v_mfma_f32_16x16x32_bf16 v[116:119], v[56:59], v[80:83], v[116:119]
    v_mfma_f32_16x16x32_bf16 v[112:115], v[36:39], v[84:87], v[112:115]
    v_mfma_f32_16x16x32_bf16 v[116:119], v[60:63], v[84:87], v[116:119]
    s_nop 15
    v_cvt_pk_bf16_f32 v128, v112, v113
    v_cvt_pk_bf16_f32 v129, v114, v115
    v_cvt_pk_bf16_f32 v130, v116, v117
    v_cvt_pk_bf16_f32 v131, v118, v119
    buffer_store_dwordx4 v[128:131], v9, s[24:27], s28 offen
    s_cmp_lg_u32 s2, 143
    s_cbranch_scc1 L_prep_end
    v_lshlrev_b32 v9, 5, v0
    v_mov_b32 v10, 0
    s_mov_b32 s28, 147456
    buffer_store_dword v10, v9, s[24:27], s28 offen
L_prep_end:
    s_endpgm
L_prep_pf:
    s_cmp_ge_u32 s2, 256
    s_cbranch_scc1 L_prep_end
    s_load_dwordx2 s[36:37], s[0:1], 0
    v_lshlrev_b32 v12, 7, v0
    s_mul_i32 s35, s2, 24576
    s_add_u32 s35, s35, 6291456
    s_mov_b32 s38, 12582912
    s_mov_b32 s39, 0x00020000
    s_waitcnt lgkmcnt(0)
    buffer_load_dword v13, v12, s[36:39], s35 offen
    s_add_u32 s35, s35, 8192
    buffer_load_dword v13, v12, s[36:39], s35 offen
    s_add_u32 s35, s35, 8192
    buffer_load_dword v13, v12, s[36:39], s35 offen
    s_endpgm
.globl standalone__swin_window_attn__vision_kernel
.p2align 8
.type standalone__swin_window_attn__vision_kernel,@function
standalone__swin_window_attn__vision_kernel:
    s_cmp_ge_u32 s2, 256
    s_cbranch_scc1 L_end
    s_load_dwordx2 s[4:5], s[0:1], 0
    s_load_dwordx2 s[6:7], s[0:1], 24
    s_load_dwordx2 s[50:51], s[0:1], 40
    v_lshrrev_b32 v16, 6, v0
    v_and_b32 v0, 63, v0
    s_lshr_b32 s53, s2, 6
    v_readfirstlane_b32 s49, v16
    v_lshlrev_b32 v1, 4, v0
    v_and_b32 v16, 15, v0
    v_lshrrev_b32 v17, 4, v0
    s_mul_i32 s53, s53, 1572864
    s_and_b32 s54, s2, 63
    s_mul_i32 s54, s54, 3072
    s_add_u32 s38, s53, s54
    s_and_b32 s37, s49, 1
    s_mov_b32 s54, 149504
    s_mov_b32 s55, 0x00020000
    s_mov_b32 s48, 0
    s_cmp_ge_u32 s49, 2
    s_cbranch_scc1 L_nrole
    s_lshl_b32 s61, s37, 12
    s_add_u32 s60, s61, 73728
    s_waitcnt lgkmcnt(0)
    s_mov_b32 s52, s50
    s_mov_b32 s53, s51
    s_mov_b32 m0, s60
    s_add_u32 s60, s60, 8192
    buffer_load_dwordx4 v1, s[52:55], s61 offen offset:0 lds
    buffer_load_dwordx4 v1, s[52:55], s61 offen offset:1024 lds
    buffer_load_dwordx4 v1, s[52:55], s61 offen offset:2048 lds
    buffer_load_dwordx4 v1, s[52:55], s61 offen offset:3072 lds
    s_add_u32 s61, s61, 8192
    s_mov_b32 m0, s60
    s_add_u32 s60, s60, 8192
    buffer_load_dwordx4 v1, s[52:55], s61 offen offset:0 lds
    buffer_load_dwordx4 v1, s[52:55], s61 offen offset:1024 lds
    buffer_load_dwordx4 v1, s[52:55], s61 offen offset:2048 lds
    buffer_load_dwordx4 v1, s[52:55], s61 offen offset:3072 lds
    s_add_u32 s61, s61, 8192
    s_mov_b32 m0, s60
    s_add_u32 s60, s60, 8192
    buffer_load_dwordx4 v1, s[52:55], s61 offen offset:0 lds
    buffer_load_dwordx4 v1, s[52:55], s61 offen offset:1024 lds
    buffer_load_dwordx4 v1, s[52:55], s61 offen offset:2048 lds
    buffer_load_dwordx4 v1, s[52:55], s61 offen offset:3072 lds
    s_add_u32 s61, s61, 8192
    s_mov_b32 m0, s60
    s_add_u32 s60, s60, 8192
    buffer_load_dwordx4 v1, s[52:55], s61 offen offset:0 lds
    buffer_load_dwordx4 v1, s[52:55], s61 offen offset:1024 lds
    buffer_load_dwordx4 v1, s[52:55], s61 offen offset:2048 lds
    buffer_load_dwordx4 v1, s[52:55], s61 offen offset:3072 lds
    s_add_u32 s61, s61, 8192
    s_mov_b32 m0, s60
    s_add_u32 s60, s60, 8192
    buffer_load_dwordx4 v1, s[52:55], s61 offen offset:0 lds
    buffer_load_dwordx4 v1, s[52:55], s61 offen offset:1024 lds
    buffer_load_dwordx4 v1, s[52:55], s61 offen offset:2048 lds
    buffer_load_dwordx4 v1, s[52:55], s61 offen offset:3072 lds
    s_add_u32 s61, s61, 8192
    s_mov_b32 m0, s60
    s_add_u32 s60, s60, 8192
    buffer_load_dwordx4 v1, s[52:55], s61 offen offset:0 lds
    buffer_load_dwordx4 v1, s[52:55], s61 offen offset:1024 lds
    buffer_load_dwordx4 v1, s[52:55], s61 offen offset:2048 lds
    buffer_load_dwordx4 v1, s[52:55], s61 offen offset:3072 lds
    s_add_u32 s61, s61, 8192
    s_mov_b32 m0, s60
    s_add_u32 s60, s60, 8192
    buffer_load_dwordx4 v1, s[52:55], s61 offen offset:0 lds
    buffer_load_dwordx4 v1, s[52:55], s61 offen offset:1024 lds
    buffer_load_dwordx4 v1, s[52:55], s61 offen offset:2048 lds
    buffer_load_dwordx4 v1, s[52:55], s61 offen offset:3072 lds
    s_add_u32 s61, s61, 8192
    s_mov_b32 m0, s60
    s_add_u32 s60, s60, 8192
    buffer_load_dwordx4 v1, s[52:55], s61 offen offset:0 lds
    buffer_load_dwordx4 v1, s[52:55], s61 offen offset:1024 lds
    buffer_load_dwordx4 v1, s[52:55], s61 offen offset:2048 lds
    buffer_load_dwordx4 v1, s[52:55], s61 offen offset:3072 lds
    s_mov_b32 s61, 65536
    buffer_load_dwordx4 v[224:227], v1, s[52:55], s61 offen offset:0
    buffer_load_dwordx4 v[228:231], v1, s[52:55], s61 offen offset:1024
    buffer_load_dwordx4 v[232:235], v1, s[52:55], s61 offen offset:2048
    buffer_load_dwordx4 v[236:239], v1, s[52:55], s61 offen offset:3072
    s_mov_b32 s61, 69632
    buffer_load_dwordx4 v[240:243], v1, s[52:55], s61 offen offset:0
    buffer_load_dwordx4 v[244:247], v1, s[52:55], s61 offen offset:1024
    buffer_load_dwordx4 v[248:251], v1, s[52:55], s61 offen offset:2048
    buffer_load_dwordx4 v[252:255], v1, s[52:55], s61 offen offset:3072
    v_lshrrev_b32 v18, 1, v16
    v_xor_b32 v18, v18, v17
    v_lshlrev_b32 v18, 4, v18
    v_mul_u32_u24 v19, 384, v16
    v_add_u32 v2, v18, v19
    v_xor_b32 v3, 64, v2
    s_mul_i32 s47, s37, 12288
    s_sub_u32 s39, 12288, s47
    v_add_u32 v4, s47, v2
    v_add_u32 v6, s39, v2
    v_add_u32 v5, s47, v3
    v_add_u32 v7, s39, v3
    s_mov_b32 s41, 0
    s_mul_i32 s60, s37, 5120
    s_add_u32 s60, s60, 147456
    v_add_u32 v8, s60, v1
    v_xor_b32 v9, 1024, v8
    s_mov_b32 s40, 0x3dd53b95
    s_mov_b32 s16, -1
    s_lshr_b32 s60, s2, 3
    s_and_b32 s60, s60, 7
    s_mul_i32 s24, s60, 24576
    s_lshl_b32 s60, s60, 8
    s_add_u32 s60, s60, 147456
    s_cmp_eq_u32 s37, 0
    s_cselect_b32 s60, s60, 0x40000000
    v_mov_b32 v25, s60
    s_lshr_b32 s60, s2, 6
    s_lshl_b32 s60, s60, 3
    s_and_b32 s61, s2, 7
    s_add_u32 s60, s60, s61
    s_sub_u32 s60, s60, 32
    v_mov_b32 v24, s60
    v_mov_b32 v23, 139264
    s_lshl_b32 s61, s37, 3
    v_add_u32 v11, s61, v23
    s_add_u32 s60, s38, 18874368
    v_mov_b32 v10, s60
    ds_write_b32 v11, v10
    v_add_u32 v11, 4, v11
    v_add_u32 v20, 73728, v1
    s_waitcnt vmcnt(0) lgkmcnt(0)
    s_barrier
    ds_read_b128 v[128:131], v4 offset:0
    ds_read_b128 v[132:135], v5 offset:0
    ds_read_b128 v[136:139], v4 offset:128
    ds_read_b128 v[140:143], v5 offset:128
    ds_read_b128 v[144:147], v4 offset:256
    ds_read_b128 v[148:151], v5 offset:256
    ds_read_b128 v[152:155], v4 offset:6144
    ds_read_b128 v[156:159], v5 offset:6144
    ds_read_b128 v[160:163], v4 offset:6272
    ds_read_b128 v[164:167], v5 offset:6272
    ds_read_b128 v[168:171], v4 offset:6400
    ds_read_b128 v[172:175], v5 offset:6400
    ds_read_b128 a[0:3], v20 offset:0
    ds_read_b128 a[4:7], v20 offset:1024
    ds_read_b128 a[8:11], v20 offset:2048
    ds_read_b128 a[12:15], v20 offset:3072
    ds_read_b128 a[16:19], v20 offset:4096
    ds_read_b128 a[20:23], v20 offset:5120
    ds_read_b128 a[24:27], v20 offset:6144
    ds_read_b128 a[28:31], v20 offset:7168
    ds_read_b128 a[32:35], v20 offset:8192
    ds_read_b128 a[36:39], v20 offset:9216
    ds_read_b128 a[40:43], v20 offset:10240
    ds_read_b128 a[44:47], v20 offset:11264
    ds_read_b128 a[48:51], v20 offset:12288
    ds_read_b128 a[52:55], v20 offset:13312
    ds_read_b128 a[56:59], v20 offset:14336
    ds_read_b128 a[60:63], v20 offset:15360
    ds_read_b128 a[64:67], v20 offset:16384
    ds_read_b128 a[68:71], v20 offset:17408
    ds_read_b128 a[72:75], v20 offset:18432
    ds_read_b128 a[76:79], v20 offset:19456
    ds_read_b128 a[80:83], v20 offset:20480
    ds_read_b128 a[84:87], v20 offset:21504
    ds_read_b128 a[88:91], v20 offset:22528
    ds_read_b128 a[92:95], v20 offset:23552
    ds_read_b128 a[96:99], v20 offset:24576
    ds_read_b128 a[100:103], v20 offset:25600
    ds_read_b128 a[104:107], v20 offset:26624
    ds_read_b128 a[108:111], v20 offset:27648
    ds_read_b128 a[112:115], v20 offset:28672
    ds_read_b128 a[116:119], v20 offset:29696
    ds_read_b128 a[120:123], v20 offset:30720
    ds_read_b128 a[124:127], v20 offset:31744
    ds_read_b128 a[128:131], v20 offset:32768
    ds_read_b128 a[132:135], v20 offset:33792
    ds_read_b128 a[136:139], v20 offset:34816
    ds_read_b128 a[140:143], v20 offset:35840
    ds_read_b128 a[144:147], v20 offset:36864
    ds_read_b128 a[148:151], v20 offset:37888
    ds_read_b128 a[152:155], v20 offset:38912
    ds_read_b128 a[156:159], v20 offset:39936
    ds_read_b128 a[160:163], v20 offset:40960
    ds_read_b128 a[164:167], v20 offset:41984
    ds_read_b128 a[168:171], v20 offset:43008
    ds_read_b128 a[172:175], v20 offset:44032
    ds_read_b128 a[176:179], v20 offset:45056
    ds_read_b128 a[180:183], v20 offset:46080
    ds_read_b128 a[184:187], v20 offset:47104
    ds_read_b128 a[188:191], v20 offset:48128
    ds_read_b128 a[192:195], v20 offset:49152
    ds_read_b128 a[196:199], v20 offset:50176
    ds_read_b128 a[200:203], v20 offset:51200
    ds_read_b128 a[204:207], v20 offset:52224
    ds_read_b128 a[208:211], v20 offset:53248
    ds_read_b128 a[212:215], v20 offset:54272
    ds_read_b128 a[216:219], v20 offset:55296
    ds_read_b128 a[220:223], v20 offset:56320
    ds_read_b128 a[224:227], v20 offset:57344
    ds_read_b128 a[228:231], v20 offset:58368
    ds_read_b128 a[232:235], v20 offset:59392
    ds_read_b128 a[236:239], v20 offset:60416
    ds_read_b128 a[240:243], v20 offset:61440
    ds_read_b128 a[244:247], v20 offset:62464
    ds_read_b128 a[248:251], v20 offset:63488
    ds_read_b128 a[252:255], v20 offset:64512
    s_waitcnt lgkmcnt(0)
    s_branch L_mmid
    .p2align 6
L_mloop:
    v_mfma_f32_16x16x32_bf16 v[32:35], v[128:131], v[80:83], 0
    ds_read_b32 v22, v23
    s_add_u32 s41, s41, 24576
    s_cmp_ge_u32 s41, 73728
    s_cselect_b32 s56, 73728, 0
    s_sub_u32 s41, s41, s56
    v_mfma_f32_16x16x32_bf16 v[32:35], v[132:135], v[84:87], v[32:35]
    s_nop 0
    v_cvt_pk_bf16_f32 v126, v76, v77
    v_cvt_pk_bf16_f32 v127, v78, v79
    v_mfma_f32_16x16x32_bf16 v[32:35], v[136:139], v[88:91], v[32:35]
    s_add_u32 s46, s41, s47
    v_add_u32 v4, s46, v2
    v_mfma_f32_16x16x32_bf16 v[32:35], v[140:143], v[92:95], v[32:35]
    v_add_u32 v5, s46, v3
    s_add_u32 s57, s41, s39
    v_mfma_f32_16x16x32_bf16 v[32:35], v[144:147], v[96:99], v[32:35]
    v_add_u32 v6, s57, v2
    v_add_u32 v7, s57, v3
    v_mfma_f32_16x16x32_bf16 v[32:35], v[148:151], v[100:103], v[32:35]
    v_xor_b32 v8, 8192, v8
    v_xor_b32 v9, 8192, v9
    v_mfma_f32_16x16x32_bf16 v[48:51], v[128:131], v[104:107], 0
    ds_read_b128 v[128:131], v4 offset:0
    v_xor_b32 v23, 4, v23
    v_mfma_f32_16x16x32_bf16 v[48:51], v[132:135], v[108:111], v[48:51]
    ds_read_b128 v[132:135], v5 offset:0
    v_mfma_f32_16x16x32_bf16 v[48:51], v[136:139], v[112:115], v[48:51]
    ds_read_b128 v[136:139], v4 offset:128
    v_max3_f32 v12, v32, v33, v34
    v_mfma_f32_16x16x32_bf16 v[48:51], v[140:143], v[116:119], v[48:51]
    ds_read_b128 v[140:143], v5 offset:128
    v_mfma_f32_16x16x32_bf16 v[48:51], v[144:147], v[120:123], v[48:51]
    ds_read_b128 v[144:147], v4 offset:256
    v_mfma_f32_16x16x32_bf16 v[48:51], v[148:151], v[124:127], v[48:51]
    ds_read_b128 v[148:151], v5 offset:256
    v_mfma_f32_16x16x32_bf16 v[36:39], v[152:155], v[80:83], 0
    v_mfma_f32_16x16x32_bf16 v[36:39], v[156:159], v[84:87], v[36:39]
    v_mfma_f32_16x16x32_bf16 v[36:39], v[160:163], v[88:91], v[36:39]
    s_waitcnt lgkmcnt(6)
    v_readfirstlane_b32 s60, v22
    s_nop 0
    s_cmp_lt_u32 s60, 100663296
    s_addc_u32 s16, s16, s16
    v_mfma_f32_16x16x32_bf16 v[36:39], v[164:167], v[92:95], v[36:39]
    v_max3_f32 v13, v48, v49, v50
    v_mfma_f32_16x16x32_bf16 v[36:39], v[168:171], v[96:99], v[36:39]
    v_mfma_f32_16x16x32_bf16 v[36:39], v[172:175], v[100:103], v[36:39]
    v_mfma_f32_16x16x32_bf16 v[52:55], v[152:155], v[104:107], 0
    ds_read_b128 v[152:155], v4 offset:6144
    v_mfma_f32_16x16x32_bf16 v[52:55], v[156:159], v[108:111], v[52:55]
    ds_read_b128 v[156:159], v5 offset:6144
    v_mfma_f32_16x16x32_bf16 v[52:55], v[160:163], v[112:115], v[52:55]
    ds_read_b128 v[160:163], v4 offset:6272
    v_max3_f32 v12, v12, v35, v36
    v_mfma_f32_16x16x32_bf16 v[52:55], v[164:167], v[116:119], v[52:55]
    ds_read_b128 v[164:167], v5 offset:6272
    v_max3_f32 v12, v12, v37, v38
    v_mfma_f32_16x16x32_bf16 v[52:55], v[168:171], v[120:123], v[52:55]
    ds_read_b128 v[168:171], v4 offset:6400
    v_mfma_f32_16x16x32_bf16 v[52:55], v[172:175], v[124:127], v[52:55]
    ds_read_b128 v[172:175], v5 offset:6400
    v_mfma_f32_16x16x32_bf16 v[40:43], v[176:179], v[80:83], 0
    v_mfma_f32_16x16x32_bf16 v[40:43], v[180:183], v[84:87], v[40:43]
    v_mfma_f32_16x16x32_bf16 v[40:43], v[184:187], v[88:91], v[40:43]
    s_waitcnt vmcnt(0)
    v_readfirstlane_b32 s60, v24
    s_nop 0
    s_add_u32 s60, s60, 160
    s_lshr_b32 s61, s60, 3
    s_and_b32 s60, s60, 7
    v_mfma_f32_16x16x32_bf16 v[40:43], v[188:191], v[92:95], v[40:43]
    s_mul_i32 s61, s61, 1572864
    s_mul_i32 s60, s60, 3072
    s_add_u32 s61, s61, s24
    s_add_u32 s61, s61, s60
    v_mfma_f32_16x16x32_bf16 v[40:43], v[192:195], v[96:99], v[40:43]
    v_mov_b32 v10, s61
    v_mov_b32 v24, 1
    v_mfma_f32_16x16x32_bf16 v[40:43], v[196:199], v[100:103], v[40:43]
    s_mov_b64 exec, 1
    ds_write_b32 v11, v10
    s_mov_b64 exec, -1
    v_mfma_f32_16x16x32_bf16 v[56:59], v[176:179], v[104:107], 0
    s_mov_b64 exec, 1
    buffer_atomic_add v24, v25, s[52:55], 0 offen sc0
    s_mov_b64 exec, -1
    v_mfma_f32_16x16x32_bf16 v[56:59], v[180:183], v[108:111], v[56:59]
    v_xor_b32 v11, 4, v11
    v_max3_f32 v13, v13, v51, v52
    v_mfma_f32_16x16x32_bf16 v[56:59], v[184:187], v[112:115], v[56:59]
    v_max3_f32 v13, v13, v53, v54
    v_max3_f32 v12, v12, v39, v40
    v_mfma_f32_16x16x32_bf16 v[56:59], v[188:191], v[116:119], v[56:59]
    v_max3_f32 v12, v12, v41, v42
    v_mfma_f32_16x16x32_bf16 v[56:59], v[192:195], v[120:123], v[56:59]
    v_mfma_f32_16x16x32_bf16 v[56:59], v[196:199], v[124:127], v[56:59]
    v_mfma_f32_16x16x32_bf16 v[44:47], v[200:203], v[80:83], 0
    v_mfma_f32_16x16x32_bf16 v[44:47], v[204:207], v[84:87], v[44:47]
    v_mfma_f32_16x16x32_bf16 v[44:47], v[208:211], v[88:91], v[44:47]
    v_max3_f32 v13, v13, v55, v56
    v_max3_f32 v13, v13, v57, v58
    v_mfma_f32_16x16x32_bf16 v[44:47], v[212:215], v[92:95], v[44:47]
    v_mfma_f32_16x16x32_bf16 v[44:47], v[216:219], v[96:99], v[44:47]
    v_mfma_f32_16x16x32_bf16 v[44:47], v[220:223], v[100:103], v[44:47]
    v_mfma_f32_16x16x32_bf16 v[60:63], v[200:203], v[104:107], 0
    v_mfma_f32_16x16x32_bf16 v[60:63], v[204:207], v[108:111], v[60:63]
    v_mfma_f32_16x16x32_bf16 v[60:63], v[208:211], v[112:115], v[60:63]
    v_max3_f32 v12, v12, v43, v44
    v_max3_f32 v12, v12, v45, v46
    v_mfma_f32_16x16x32_bf16 v[60:63], v[212:215], v[116:119], v[60:63]
    v_max_f32 v12, v12, v47
    v_mfma_f32_16x16x32_bf16 v[60:63], v[216:219], v[120:123], v[60:63]
    v_mfma_f32_16x16x32_bf16 v[60:63], v[220:223], v[124:127], v[60:63]
    s_bitcmp0_b32 s16, 2
    s_cbranch_scc1 L_mtail
L_mmid:
    s_waitcnt lgkmcnt(0)
    v_mfma_f32_16x16x32_bf16 v[64:67], a[0:3], v[128:131], 0
    v_mfma_f32_16x16x32_bf16 v[64:67], a[4:7], v[132:135], v[64:67]
    v_mfma_f32_16x16x32_bf16 v[64:67], a[8:11], v[136:139], v[64:67]
    v_max3_f32 v13, v13, v59, v60
    v_max3_f32 v13, v13, v61, v62
    v_mfma_f32_16x16x32_bf16 v[64:67], a[12:15], v[140:143], v[64:67]
    v_max_f32 v13, v13, v63
    v_mfma_f32_16x16x32_bf16 v[64:67], a[16:19], v[144:147], v[64:67]
    v_mfma_f32_16x16x32_bf16 v[64:67], a[20:23], v[148:151], v[64:67]
    v_permlane16_swap_b32 v12, v13
    v_max_f32 v12, v12, v13
    v_mfma_f32_16x16x32_bf16 v[68:71], a[0:3], v[152:155], 0
    v_mov_b32 v13, v12
    v_mfma_f32_16x16x32_bf16 v[68:71], a[4:7], v[156:159], v[68:71]
    v_mfma_f32_16x16x32_bf16 v[68:71], a[8:11], v[160:163], v[68:71]
    v_cvt_pk_bf16_f32 v80, v64, v65
    v_cvt_pk_bf16_f32 v81, v66, v67
    v_mfma_f32_16x16x32_bf16 v[68:71], a[12:15], v[164:167], v[68:71]
    v_permlane32_swap_b32 v12, v13
    v_max_f32 v12, v12, v13
    v_mfma_f32_16x16x32_bf16 v[68:71], a[16:19], v[168:171], v[68:71]
    v_mul_f32 v12, s40, v12
    v_mov_b32 v13, v12
    v_mfma_f32_16x16x32_bf16 v[68:71], a[20:23], v[172:175], v[68:71]
    v_mfma_f32_16x16x32_bf16 v[72:75], a[24:27], v[128:131], 0
    v_permlane16_swap_b32 v12, v13
    v_fma_f32 v32, v32, s40, -v12
    v_mfma_f32_16x16x32_bf16 v[72:75], a[28:31], v[132:135], v[72:75]
    v_fma_f32 v48, v48, s40, -v13
    v_fma_f32 v33, v33, s40, -v12
    v_mfma_f32_16x16x32_bf16 v[72:75], a[32:35], v[136:139], v[72:75]
    v_cvt_pk_bf16_f32 v104, v68, v69
    v_cvt_pk_bf16_f32 v105, v70, v71
    v_mfma_f32_16x16x32_bf16 v[72:75], a[36:39], v[140:143], v[72:75]
    v_fma_f32 v49, v49, s40, -v13
    v_fma_f32 v34, v34, s40, -v12
    v_mfma_f32_16x16x32_bf16 v[72:75], a[40:43], v[144:147], v[72:75]
    v_exp_f32 v32, v32
    v_mfma_f32_16x16x32_bf16 v[72:75], a[44:47], v[148:151], v[72:75]
    v_exp_f32 v48, v48
    v_mfma_f32_16x16x32_bf16 v[76:79], a[24:27], v[152:155], 0
    v_exp_f32 v33, v33
    v_mfma_f32_16x16x32_bf16 v[76:79], a[28:31], v[156:159], v[76:79]
    v_exp_f32 v49, v49
    v_mfma_f32_16x16x32_bf16 v[76:79], a[32:35], v[160:163], v[76:79]
    v_cvt_pk_bf16_f32 v82, v72, v73
    v_cvt_pk_bf16_f32 v83, v74, v75
    v_mfma_f32_16x16x32_bf16 v[76:79], a[36:39], v[164:167], v[76:79]
    v_fma_f32 v50, v50, s40, -v13
    v_fma_f32 v35, v35, s40, -v12
    v_mfma_f32_16x16x32_bf16 v[76:79], a[40:43], v[168:171], v[76:79]
    v_exp_f32 v34, v34
    v_mfma_f32_16x16x32_bf16 v[76:79], a[44:47], v[172:175], v[76:79]
    v_exp_f32 v50, v50
    v_mfma_f32_16x16x32_bf16 v[64:67], a[48:51], v[128:131], 0
    v_fma_f32 v51, v51, s40, -v13
    v_fma_f32 v36, v36, s40, -v12
    v_mfma_f32_16x16x32_bf16 v[64:67], a[52:55], v[132:135], v[64:67]
    v_exp_f32 v35, v35
    v_mfma_f32_16x16x32_bf16 v[64:67], a[56:59], v[136:139], v[64:67]
    v_cvt_pk_bf16_f32 v106, v76, v77
    v_cvt_pk_bf16_f32 v107, v78, v79
    v_mfma_f32_16x16x32_bf16 v[64:67], a[60:63], v[140:143], v[64:67]
    v_exp_f32 v51, v51
    v_mfma_f32_16x16x32_bf16 v[64:67], a[64:67], v[144:147], v[64:67]
    v_fma_f32 v52, v52, s40, -v13
    v_add_f32 v14, v32, v33
    v_mfma_f32_16x16x32_bf16 v[64:67], a[68:71], v[148:151], v[64:67]
    v_add_f32 v15, v48, v49
    v_fma_f32 v37, v37, s40, -v12
    v_mfma_f32_16x16x32_bf16 v[68:71], a[48:51], v[152:155], 0
    v_exp_f32 v36, v36
    v_mfma_f32_16x16x32_bf16 v[68:71], a[52:55], v[156:159], v[68:71]
    v_exp_f32 v52, v52
    v_mfma_f32_16x16x32_bf16 v[68:71], a[56:59], v[160:163], v[68:71]
    v_cvt_pk_bf16_f32 v84, v64, v65
    v_cvt_pk_bf16_f32 v85, v66, v67
    v_mfma_f32_16x16x32_bf16 v[68:71], a[60:63], v[164:167], v[68:71]
    v_fma_f32 v53, v53, s40, -v13
    v_add_f32 v14, v14, v34
    v_mfma_f32_16x16x32_bf16 v[68:71], a[64:67], v[168:171], v[68:71]
    v_add_f32 v15, v15, v50
    v_fma_f32 v38, v38, s40, -v12
    v_mfma_f32_16x16x32_bf16 v[68:71], a[68:71], v[172:175], v[68:71]
    v_exp_f32 v37, v37
    v_mfma_f32_16x16x32_bf16 v[72:75], a[72:75], v[128:131], 0
    v_exp_f32 v53, v53
    v_mfma_f32_16x16x32_bf16 v[72:75], a[76:79], v[132:135], v[72:75]
    v_fma_f32 v54, v54, s40, -v13
    v_add_f32 v14, v14, v35
    v_mfma_f32_16x16x32_bf16 v[72:75], a[80:83], v[136:139], v[72:75]
    v_cvt_pk_bf16_f32 v108, v68, v69
    v_cvt_pk_bf16_f32 v109, v70, v71
    v_mfma_f32_16x16x32_bf16 v[72:75], a[84:87], v[140:143], v[72:75]
    v_add_f32 v15, v15, v51
    v_fma_f32 v39, v39, s40, -v12
    v_mfma_f32_16x16x32_bf16 v[72:75], a[88:91], v[144:147], v[72:75]
    v_exp_f32 v38, v38
    v_mfma_f32_16x16x32_bf16 v[72:75], a[92:95], v[148:151], v[72:75]
    v_exp_f32 v54, v54
    v_mfma_f32_16x16x32_bf16 v[76:79], a[72:75], v[152:155], 0
    v_fma_f32 v55, v55, s40, -v13
    v_add_f32 v14, v14, v36
    v_mfma_f32_16x16x32_bf16 v[76:79], a[76:79], v[156:159], v[76:79]
    v_add_f32 v15, v15, v52
    v_fma_f32 v40, v40, s40, -v12
    v_mfma_f32_16x16x32_bf16 v[76:79], a[80:83], v[160:163], v[76:79]
    v_cvt_pk_bf16_f32 v86, v72, v73
    v_cvt_pk_bf16_f32 v87, v74, v75
    v_mfma_f32_16x16x32_bf16 v[76:79], a[84:87], v[164:167], v[76:79]
    v_exp_f32 v39, v39
    v_mfma_f32_16x16x32_bf16 v[76:79], a[88:91], v[168:171], v[76:79]
    v_exp_f32 v55, v55
    v_mfma_f32_16x16x32_bf16 v[76:79], a[92:95], v[172:175], v[76:79]
    v_fma_f32 v56, v56, s40, -v13
    v_add_f32 v14, v14, v37
    v_mfma_f32_16x16x32_bf16 v[64:67], a[96:99], v[128:131], 0
    v_add_f32 v15, v15, v53
    v_fma_f32 v41, v41, s40, -v12
    v_mfma_f32_16x16x32_bf16 v[64:67], a[100:103], v[132:135], v[64:67]
    v_exp_f32 v40, v40
    v_mfma_f32_16x16x32_bf16 v[64:67], a[104:107], v[136:139], v[64:67]
    v_cvt_pk_bf16_f32 v110, v76, v77
    v_cvt_pk_bf16_f32 v111, v78, v79
    v_mfma_f32_16x16x32_bf16 v[64:67], a[108:111], v[140:143], v[64:67]
    v_exp_f32 v56, v56
    v_mfma_f32_16x16x32_bf16 v[64:67], a[112:115], v[144:147], v[64:67]
    v_fma_f32 v57, v57, s40, -v13
    v_add_f32 v14, v14, v38
    v_mfma_f32_16x16x32_bf16 v[64:67], a[116:119], v[148:151], v[64:67]
    v_add_f32 v15, v15, v54
    v_fma_f32 v42, v42, s40, -v12
    v_mfma_f32_16x16x32_bf16 v[68:71], a[96:99], v[152:155], 0
    v_exp_f32 v41, v41
    v_mfma_f32_16x16x32_bf16 v[68:71], a[100:103], v[156:159], v[68:71]
    v_exp_f32 v57, v57
    v_mfma_f32_16x16x32_bf16 v[68:71], a[104:107], v[160:163], v[68:71]
    v_cvt_pk_bf16_f32 v88, v64, v65
    v_cvt_pk_bf16_f32 v89, v66, v67
    v_mfma_f32_16x16x32_bf16 v[68:71], a[108:111], v[164:167], v[68:71]
    v_fma_f32 v58, v58, s40, -v13
    v_add_f32 v14, v14, v39
    v_mfma_f32_16x16x32_bf16 v[68:71], a[112:115], v[168:171], v[68:71]
    v_add_f32 v15, v15, v55
    v_fma_f32 v43, v43, s40, -v12
    v_mfma_f32_16x16x32_bf16 v[68:71], a[116:119], v[172:175], v[68:71]
    v_exp_f32 v42, v42
    v_mfma_f32_16x16x32_bf16 v[72:75], a[120:123], v[128:131], 0
    v_exp_f32 v58, v58
    v_mfma_f32_16x16x32_bf16 v[72:75], a[124:127], v[132:135], v[72:75]
    v_fma_f32 v59, v59, s40, -v13
    v_add_f32 v14, v14, v40
    v_mfma_f32_16x16x32_bf16 v[72:75], a[128:131], v[136:139], v[72:75]
    v_cvt_pk_bf16_f32 v112, v68, v69
    v_cvt_pk_bf16_f32 v113, v70, v71
    v_mfma_f32_16x16x32_bf16 v[72:75], a[132:135], v[140:143], v[72:75]
    v_add_f32 v15, v15, v56
    v_fma_f32 v44, v44, s40, -v12
    v_mfma_f32_16x16x32_bf16 v[72:75], a[136:139], v[144:147], v[72:75]
    v_exp_f32 v43, v43
    v_mfma_f32_16x16x32_bf16 v[72:75], a[140:143], v[148:151], v[72:75]
    v_exp_f32 v59, v59
    v_mfma_f32_16x16x32_bf16 v[76:79], a[120:123], v[152:155], 0
    v_fma_f32 v60, v60, s40, -v13
    v_add_f32 v14, v14, v41
    v_mfma_f32_16x16x32_bf16 v[76:79], a[124:127], v[156:159], v[76:79]
    v_add_f32 v15, v15, v57
    v_fma_f32 v45, v45, s40, -v12
    v_mfma_f32_16x16x32_bf16 v[76:79], a[128:131], v[160:163], v[76:79]
    v_cvt_pk_bf16_f32 v90, v72, v73
    v_cvt_pk_bf16_f32 v91, v74, v75
    v_mfma_f32_16x16x32_bf16 v[76:79], a[132:135], v[164:167], v[76:79]
    v_exp_f32 v44, v44
    v_mfma_f32_16x16x32_bf16 v[76:79], a[136:139], v[168:171], v[76:79]
    v_exp_f32 v60, v60
    v_mfma_f32_16x16x32_bf16 v[76:79], a[140:143], v[172:175], v[76:79]
    v_fma_f32 v61, v61, s40, -v13
    v_add_f32 v14, v14, v42
    v_mfma_f32_16x16x32_bf16 v[64:67], a[144:147], v[128:131], 0
    ds_read_b128 v[176:179], v6 offset:0
    v_add_f32 v15, v15, v58
    v_mfma_f32_16x16x32_bf16 v[64:67], a[148:151], v[132:135], v[64:67]
    v_exp_f32 v45, v45
    v_mfma_f32_16x16x32_bf16 v[64:67], a[152:155], v[136:139], v[64:67]
    v_cvt_pk_bf16_f32 v114, v76, v77
    v_cvt_pk_bf16_f32 v115, v78, v79
    v_mfma_f32_16x16x32_bf16 v[64:67], a[156:159], v[140:143], v[64:67]
    v_exp_f32 v61, v61
    v_mfma_f32_16x16x32_bf16 v[64:67], a[160:163], v[144:147], v[64:67]
    v_fma_f32 v46, v46, s40, -v12
    v_fma_f32 v62, v62, s40, -v13
    v_mfma_f32_16x16x32_bf16 v[64:67], a[164:167], v[148:151], v[64:67]
    ds_read_b128 v[180:183], v7 offset:0
    v_add_f32 v14, v14, v43
    v_mfma_f32_16x16x32_bf16 v[68:71], a[144:147], v[152:155], 0
    v_add_f32 v15, v15, v59
    v_fma_f32 v47, v47, s40, -v12
    v_mfma_f32_16x16x32_bf16 v[68:71], a[148:151], v[156:159], v[68:71]
    v_exp_f32 v46, v46
    v_mfma_f32_16x16x32_bf16 v[68:71], a[152:155], v[160:163], v[68:71]
    v_cvt_pk_bf16_f32 v92, v64, v65
    v_cvt_pk_bf16_f32 v93, v66, v67
    v_mfma_f32_16x16x32_bf16 v[68:71], a[156:159], v[164:167], v[68:71]
    v_exp_f32 v62, v62
    v_mfma_f32_16x16x32_bf16 v[68:71], a[160:163], v[168:171], v[68:71]
    ds_read_b128 v[184:187], v6 offset:128
    v_fma_f32 v63, v63, s40, -v13
    v_mfma_f32_16x16x32_bf16 v[68:71], a[164:167], v[172:175], v[68:71]
    v_add_f32 v14, v14, v44
    v_add_f32 v15, v15, v60
    v_mfma_f32_16x16x32_bf16 v[72:75], a[168:171], v[128:131], 0
    v_exp_f32 v47, v47
    v_mfma_f32_16x16x32_bf16 v[72:75], a[172:175], v[132:135], v[72:75]
    v_exp_f32 v63, v63
    v_mfma_f32_16x16x32_bf16 v[72:75], a[176:179], v[136:139], v[72:75]
    v_cvt_pk_bf16_f32 v116, v68, v69
    v_cvt_pk_bf16_f32 v117, v70, v71
    v_mfma_f32_16x16x32_bf16 v[72:75], a[180:183], v[140:143], v[72:75]
    ds_read_b128 v[188:191], v7 offset:128
    v_add_f32 v14, v14, v45
    v_mfma_f32_16x16x32_bf16 v[72:75], a[184:187], v[144:147], v[72:75]
    v_add_f32 v15, v15, v61
    v_add_f32 v14, v14, v46
    v_mfma_f32_16x16x32_bf16 v[72:75], a[188:191], v[148:151], v[72:75]
    v_add_f32 v15, v15, v62
    v_add_f32 v14, v14, v47
    v_mfma_f32_16x16x32_bf16 v[76:79], a[168:171], v[152:155], 0
    v_add_f32 v15, v15, v63
    v_mfma_f32_16x16x32_bf16 v[76:79], a[172:175], v[156:159], v[76:79]
    v_mfma_f32_16x16x32_bf16 v[76:79], a[176:179], v[160:163], v[76:79]
    ds_read_b128 v[192:195], v6 offset:256
    v_cvt_pk_bf16_f32 v94, v72, v73
    v_mfma_f32_16x16x32_bf16 v[76:79], a[180:183], v[164:167], v[76:79]
    v_cvt_pk_bf16_f32 v95, v74, v75
    v_permlane16_swap_b32 v14, v15
    v_mfma_f32_16x16x32_bf16 v[76:79], a[184:187], v[168:171], v[76:79]
    v_add_f32 v14, v14, v15
    v_mov_b32 v15, v14
    v_mfma_f32_16x16x32_bf16 v[76:79], a[188:191], v[172:175], v[76:79]
    v_mfma_f32_16x16x32_bf16 v[64:67], a[192:195], v[128:131], 0
    v_permlane32_swap_b32 v14, v15
    v_add_f32 v14, v14, v15
    v_mfma_f32_16x16x32_bf16 v[64:67], a[196:199], v[132:135], v[64:67]
    ds_read_b128 v[196:199], v7 offset:256
    v_mfma_f32_16x16x32_bf16 v[64:67], a[200:203], v[136:139], v[64:67]
    v_cvt_pk_bf16_f32 v118, v76, v77
    v_cvt_pk_bf16_f32 v119, v78, v79
    v_mfma_f32_16x16x32_bf16 v[64:67], a[204:207], v[140:143], v[64:67]
    v_rcp_f32 v14, v14
    v_mfma_f32_16x16x32_bf16 v[64:67], a[208:211], v[144:147], v[64:67]
    v_mov_b32 v15, v14
    v_mfma_f32_16x16x32_bf16 v[64:67], a[212:215], v[148:151], v[64:67]
    v_mfma_f32_16x16x32_bf16 v[68:71], a[192:195], v[152:155], 0
    ds_read_b128 v[200:203], v6 offset:6144
    v_permlane16_swap_b32 v14, v15
    v_mfma_f32_16x16x32_bf16 v[68:71], a[196:199], v[156:159], v[68:71]
    v_mul_f32 v32, v32, v14
    v_mul_f32 v33, v33, v14
    v_mfma_f32_16x16x32_bf16 v[68:71], a[200:203], v[160:163], v[68:71]
    v_cvt_pk_bf16_f32 v96, v64, v65
    v_cvt_pk_bf16_f32 v97, v66, v67
    v_mfma_f32_16x16x32_bf16 v[68:71], a[204:207], v[164:167], v[68:71]
    v_mul_f32 v40, v40, v14
    v_mul_f32 v41, v41, v14
    v_mfma_f32_16x16x32_bf16 v[68:71], a[208:211], v[168:171], v[68:71]
    v_mul_f32 v48, v48, v15
    v_mul_f32 v49, v49, v15
    v_mfma_f32_16x16x32_bf16 v[68:71], a[212:215], v[172:175], v[68:71]
    ds_read_b128 v[204:207], v7 offset:6144
    v_mul_f32 v56, v56, v15
    v_mfma_f32_16x16x32_bf16 v[72:75], a[216:219], v[128:131], 0
    v_mul_f32 v57, v57, v15
    v_cvt_pk_bf16_f32 v32, v32, v33
    v_mfma_f32_16x16x32_bf16 v[72:75], a[220:223], v[132:135], v[72:75]
    v_mul_f32 v34, v34, v14
    v_mul_f32 v35, v35, v14
    v_mfma_f32_16x16x32_bf16 v[72:75], a[224:227], v[136:139], v[72:75]
    v_cvt_pk_bf16_f32 v120, v68, v69
    v_cvt_pk_bf16_f32 v121, v70, v71
    v_mfma_f32_16x16x32_bf16 v[72:75], a[228:231], v[140:143], v[72:75]
    v_cvt_pk_bf16_f32 v40, v40, v41
    v_mul_f32 v42, v42, v14
    v_mfma_f32_16x16x32_bf16 v[72:75], a[232:235], v[144:147], v[72:75]
    ds_read_b128 v[208:211], v6 offset:6272
    v_mul_f32 v43, v43, v14
    v_mfma_f32_16x16x32_bf16 v[72:75], a[236:239], v[148:151], v[72:75]
    v_cvt_pk_bf16_f32 v48, v48, v49
    v_mul_f32 v50, v50, v15
    v_mfma_f32_16x16x32_bf16 v[76:79], a[216:219], v[152:155], 0
    v_mul_f32 v51, v51, v15
    v_cvt_pk_bf16_f32 v56, v56, v57
    v_mfma_f32_16x16x32_bf16 v[76:79], a[220:223], v[156:159], v[76:79]
    v_mul_f32 v58, v58, v15
    v_mul_f32 v59, v59, v15
    v_mfma_f32_16x16x32_bf16 v[76:79], a[224:227], v[160:163], v[76:79]
    v_cvt_pk_bf16_f32 v98, v72, v73
    v_cvt_pk_bf16_f32 v99, v74, v75
    v_mfma_f32_16x16x32_bf16 v[76:79], a[228:231], v[164:167], v[76:79]
    ds_read_b128 v[212:215], v7 offset:6272
    v_cvt_pk_bf16_f32 v33, v34, v35
    v_mfma_f32_16x16x32_bf16 v[76:79], a[232:235], v[168:171], v[76:79]
    v_mul_f32 v36, v36, v14
    v_mul_f32 v37, v37, v14
    v_mfma_f32_16x16x32_bf16 v[76:79], a[236:239], v[172:175], v[76:79]
    v_mul_f32 v38, v38, v14
    v_mul_f32 v39, v39, v14
    v_mfma_f32_16x16x32_bf16 v[64:67], a[240:243], v[128:131], 0
    v_cvt_pk_bf16_f32 v41, v42, v43
    v_mul_f32 v44, v44, v14
    v_mfma_f32_16x16x32_bf16 v[64:67], a[244:247], v[132:135], v[64:67]
    v_mul_f32 v45, v45, v14
    v_mul_f32 v46, v46, v14
    v_mfma_f32_16x16x32_bf16 v[64:67], a[248:251], v[136:139], v[64:67]
    ds_read_b128 v[216:219], v6 offset:6400
    v_cvt_pk_bf16_f32 v122, v76, v77
    v_mfma_f32_16x16x32_bf16 v[64:67], a[252:255], v[140:143], v[64:67]
    v_cvt_pk_bf16_f32 v123, v78, v79
    v_mul_f32 v47, v47, v14
    v_mfma_f32_16x16x32_bf16 v[64:67], v[224:227], v[144:147], v[64:67]
    v_cvt_pk_bf16_f32 v49, v50, v51
    v_mul_f32 v52, v52, v15
    v_mfma_f32_16x16x32_bf16 v[64:67], v[228:231], v[148:151], v[64:67]
    v_mul_f32 v53, v53, v15
    v_mul_f32 v54, v54, v15
    v_mfma_f32_16x16x32_bf16 v[68:71], a[240:243], v[152:155], 0
    v_mul_f32 v55, v55, v15
    v_cvt_pk_bf16_f32 v57, v58, v59
    v_mfma_f32_16x16x32_bf16 v[68:71], a[244:247], v[156:159], v[68:71]
    ds_read_b128 v[220:223], v7 offset:6400
    v_mul_f32 v60, v60, v15
    v_mfma_f32_16x16x32_bf16 v[68:71], a[248:251], v[160:163], v[68:71]
    v_mul_f32 v61, v61, v15
    v_mul_f32 v62, v62, v15
    v_mfma_f32_16x16x32_bf16 v[68:71], a[252:255], v[164:167], v[68:71]
    v_mul_f32 v63, v63, v15
    v_cvt_pk_bf16_f32 v34, v36, v37
    v_mfma_f32_16x16x32_bf16 v[68:71], v[224:227], v[168:171], v[68:71]
    v_cvt_pk_bf16_f32 v35, v38, v39
    v_cvt_pk_bf16_f32 v42, v44, v45
    v_mfma_f32_16x16x32_bf16 v[68:71], v[228:231], v[172:175], v[68:71]
    ds_write_b128 v8, v[32:35] offset:0
    v_mfma_f32_16x16x32_bf16 v[72:75], v[232:235], v[128:131], 0
    v_cvt_pk_bf16_f32 v43, v46, v47
    v_cvt_pk_bf16_f32 v50, v52, v53
    v_mfma_f32_16x16x32_bf16 v[72:75], v[236:239], v[132:135], v[72:75]
    ds_write_b128 v9, v[40:43] offset:0
    v_mfma_f32_16x16x32_bf16 v[72:75], v[240:243], v[136:139], v[72:75]
    v_cvt_pk_bf16_f32 v51, v54, v55
    v_cvt_pk_bf16_f32 v58, v60, v61
    v_mfma_f32_16x16x32_bf16 v[72:75], v[244:247], v[140:143], v[72:75]
    ds_write_b128 v8, v[48:51] offset:2048
    v_mfma_f32_16x16x32_bf16 v[72:75], v[248:251], v[144:147], v[72:75]
    v_cvt_pk_bf16_f32 v59, v62, v63
    v_cvt_pk_bf16_f32 v100, v64, v65
    v_mfma_f32_16x16x32_bf16 v[72:75], v[252:255], v[148:151], v[72:75]
    ds_write_b128 v9, v[56:59] offset:2048
    v_mfma_f32_16x16x32_bf16 v[76:79], v[232:235], v[152:155], 0
    v_cvt_pk_bf16_f32 v101, v66, v67
    v_cvt_pk_bf16_f32 v124, v68, v69
    v_mfma_f32_16x16x32_bf16 v[76:79], v[236:239], v[156:159], v[76:79]
    v_cvt_pk_bf16_f32 v125, v70, v71
    v_mfma_f32_16x16x32_bf16 v[76:79], v[240:243], v[160:163], v[76:79]
    v_cvt_pk_bf16_f32 v102, v72, v73
    v_cvt_pk_bf16_f32 v103, v74, v75
    v_mfma_f32_16x16x32_bf16 v[76:79], v[244:247], v[164:167], v[76:79]
    v_mfma_f32_16x16x32_bf16 v[76:79], v[248:251], v[168:171], v[76:79]
    v_mfma_f32_16x16x32_bf16 v[76:79], v[252:255], v[172:175], v[76:79]
    s_waitcnt lgkmcnt(0)
    s_barrier
    s_branch L_mloop
L_mtail:
    s_nop 5
    v_max3_f32 v13, v13, v59, v60
    v_max3_f32 v13, v13, v61, v62
    v_max_f32 v13, v13, v63
    s_nop 1
    v_permlane16_swap_b32 v12, v13
    v_max_f32 v12, v12, v13
    v_mov_b32 v13, v12
    s_nop 1
    v_permlane32_swap_b32 v12, v13
    v_max_f32 v12, v12, v13
    v_mul_f32 v12, s40, v12
    v_mov_b32 v13, v12
    s_nop 1
    v_permlane16_swap_b32 v12, v13
    v_fma_f32 v32, v32, s40, -v12
    v_fma_f32 v48, v48, s40, -v13
    v_fma_f32 v33, v33, s40, -v12
    v_fma_f32 v49, v49, s40, -v13
    v_exp_f32 v32, v32
    v_exp_f32 v48, v48
    v_exp_f32 v33, v33
    v_exp_f32 v49, v49
    v_fma_f32 v34, v34, s40, -v12
    v_fma_f32 v50, v50, s40, -v13
    v_exp_f32 v34, v34
    v_exp_f32 v50, v50
    v_fma_f32 v35, v35, s40, -v12
    v_fma_f32 v51, v51, s40, -v13
    v_exp_f32 v35, v35
    v_exp_f32 v51, v51
    v_fma_f32 v36, v36, s40, -v12
    v_fma_f32 v52, v52, s40, -v13
    v_add_f32 v14, v32, v33
    v_add_f32 v15, v48, v49
    v_exp_f32 v36, v36
    v_exp_f32 v52, v52
    v_fma_f32 v37, v37, s40, -v12
    v_fma_f32 v53, v53, s40, -v13
    v_add_f32 v14, v14, v34
    v_add_f32 v15, v15, v50
    v_exp_f32 v37, v37
    v_exp_f32 v53, v53
    v_fma_f32 v38, v38, s40, -v12
    v_fma_f32 v54, v54, s40, -v13
    v_add_f32 v14, v14, v35
    v_add_f32 v15, v15, v51
    v_exp_f32 v38, v38
    v_exp_f32 v54, v54
    v_fma_f32 v39, v39, s40, -v12
    v_fma_f32 v55, v55, s40, -v13
    v_add_f32 v14, v14, v36
    v_add_f32 v15, v15, v52
    v_exp_f32 v39, v39
    v_exp_f32 v55, v55
    v_fma_f32 v40, v40, s40, -v12
    v_fma_f32 v56, v56, s40, -v13
    v_add_f32 v14, v14, v37
    v_add_f32 v15, v15, v53
    v_exp_f32 v40, v40
    v_exp_f32 v56, v56
    v_fma_f32 v41, v41, s40, -v12
    v_fma_f32 v57, v57, s40, -v13
    v_add_f32 v14, v14, v38
    v_add_f32 v15, v15, v54
    v_exp_f32 v41, v41
    v_exp_f32 v57, v57
    v_fma_f32 v42, v42, s40, -v12
    v_fma_f32 v58, v58, s40, -v13
    v_add_f32 v14, v14, v39
    v_add_f32 v15, v15, v55
    v_exp_f32 v42, v42
    v_exp_f32 v58, v58
    v_fma_f32 v43, v43, s40, -v12
    v_fma_f32 v59, v59, s40, -v13
    v_add_f32 v14, v14, v40
    v_add_f32 v15, v15, v56
    v_exp_f32 v43, v43
    v_exp_f32 v59, v59
    v_fma_f32 v44, v44, s40, -v12
    v_fma_f32 v60, v60, s40, -v13
    v_add_f32 v14, v14, v41
    v_add_f32 v15, v15, v57
    v_exp_f32 v44, v44
    v_exp_f32 v60, v60
    v_fma_f32 v45, v45, s40, -v12
    v_fma_f32 v61, v61, s40, -v13
    v_add_f32 v14, v14, v42
    v_add_f32 v15, v15, v58
    v_exp_f32 v45, v45
    v_exp_f32 v61, v61
    v_fma_f32 v46, v46, s40, -v12
    v_fma_f32 v62, v62, s40, -v13
    v_add_f32 v14, v14, v43
    v_add_f32 v15, v15, v59
    v_exp_f32 v46, v46
    v_exp_f32 v62, v62
    v_fma_f32 v47, v47, s40, -v12
    v_fma_f32 v63, v63, s40, -v13
    v_add_f32 v14, v14, v44
    v_add_f32 v15, v15, v60
    v_exp_f32 v47, v47
    v_exp_f32 v63, v63
    v_add_f32 v14, v14, v45
    v_add_f32 v15, v15, v61
    v_add_f32 v14, v14, v46
    v_add_f32 v15, v15, v62
    v_add_f32 v14, v14, v47
    v_add_f32 v15, v15, v63
    s_nop 1
    v_permlane16_swap_b32 v14, v15
    v_add_f32 v14, v14, v15
    v_mov_b32 v15, v14
    s_nop 1
    v_permlane32_swap_b32 v14, v15
    v_add_f32 v14, v14, v15
    v_rcp_f32 v14, v14
    s_nop 0
    v_mov_b32 v15, v14
    s_nop 1
    v_permlane16_swap_b32 v14, v15
    v_mul_f32 v32, v32, v14
    v_mul_f32 v33, v33, v14
    v_mul_f32 v40, v40, v14
    v_mul_f32 v41, v41, v14
    v_mul_f32 v48, v48, v15
    v_mul_f32 v49, v49, v15
    v_mul_f32 v56, v56, v15
    v_mul_f32 v57, v57, v15
    v_cvt_pk_bf16_f32 v32, v32, v33
    v_mul_f32 v34, v34, v14
    v_mul_f32 v35, v35, v14
    v_cvt_pk_bf16_f32 v40, v40, v41
    v_mul_f32 v42, v42, v14
    v_mul_f32 v43, v43, v14
    v_cvt_pk_bf16_f32 v48, v48, v49
    v_mul_f32 v50, v50, v15
    v_mul_f32 v51, v51, v15
    v_cvt_pk_bf16_f32 v56, v56, v57
    v_mul_f32 v58, v58, v15
    v_mul_f32 v59, v59, v15
    v_cvt_pk_bf16_f32 v33, v34, v35
    v_mul_f32 v36, v36, v14
    v_mul_f32 v37, v37, v14
    v_mul_f32 v38, v38, v14
    v_mul_f32 v39, v39, v14
    v_cvt_pk_bf16_f32 v41, v42, v43
    v_mul_f32 v44, v44, v14
    v_mul_f32 v45, v45, v14
    v_mul_f32 v46, v46, v14
    v_mul_f32 v47, v47, v14
    v_cvt_pk_bf16_f32 v49, v50, v51
    v_mul_f32 v52, v52, v15
    v_mul_f32 v53, v53, v15
    v_mul_f32 v54, v54, v15
    v_mul_f32 v55, v55, v15
    v_cvt_pk_bf16_f32 v57, v58, v59
    v_mul_f32 v60, v60, v15
    v_mul_f32 v61, v61, v15
    v_mul_f32 v62, v62, v15
    v_mul_f32 v63, v63, v15
    v_cvt_pk_bf16_f32 v34, v36, v37
    v_cvt_pk_bf16_f32 v35, v38, v39
    v_cvt_pk_bf16_f32 v42, v44, v45
    v_cvt_pk_bf16_f32 v43, v46, v47
    v_cvt_pk_bf16_f32 v50, v52, v53
    v_cvt_pk_bf16_f32 v51, v54, v55
    v_cvt_pk_bf16_f32 v58, v60, v61
    v_cvt_pk_bf16_f32 v59, v62, v63
    ds_write_b128 v8, v[32:35] offset:0
    ds_write_b128 v9, v[40:43] offset:0
    ds_write_b128 v8, v[48:51] offset:2048
    ds_write_b128 v9, v[56:59] offset:2048
    s_waitcnt lgkmcnt(0)
    s_barrier
    s_branch L_fin
L_nrole:
    v_add_u32 v18, 0, v0
    v_mul_u32_u24 v18, 171, v18
    v_lshrrev_b32 v18, 13, v18
    s_lshl_b32 s60, s37, 2
    v_or_b32 v18, s60, v18
    v_lshlrev_b32 v18, 4, v18
    v_xor_b32 v18, v18, v1
    s_mul_i32 s60, s37, 196608
    v_add_u32 v8, s60, v18
    v_add_u32 v18, 64, v0
    v_mul_u32_u24 v18, 171, v18
    v_lshrrev_b32 v18, 13, v18
    s_lshl_b32 s60, s37, 2
    v_or_b32 v18, s60, v18
    v_lshlrev_b32 v18, 4, v18
    v_xor_b32 v18, v18, v1
    s_mul_i32 s60, s37, 196608
    v_add_u32 v9, s60, v18
    v_add_u32 v18, 128, v0
    v_mul_u32_u24 v18, 171, v18
    v_lshrrev_b32 v18, 13, v18
    s_lshl_b32 s60, s37, 2
    v_or_b32 v18, s60, v18
    v_lshlrev_b32 v18, 4, v18
    v_xor_b32 v18, v18, v1
    s_mul_i32 s60, s37, 196608
    v_add_u32 v10, s60, v18
    s_mul_i32 s42, s37, 3072
    s_mov_b32 s10, 100663296
    s_mov_b32 s11, 0x00020000
    s_waitcnt lgkmcnt(0)
    s_mov_b32 s8, s4
    s_mov_b32 s9, s5
    s_mov_b32 s52, s50
    s_mov_b32 s53, s51
    s_add_u32 m0, s42, 0
    s_add_u32 s46, s38, 0
    buffer_load_dwordx4 v8, s[8:11], s46 offen offset:0 nt lds
    buffer_load_dwordx4 v9, s[8:11], s46 offen offset:1024 nt lds
    buffer_load_dwordx4 v10, s[8:11], s46 offen offset:2048 nt lds
    s_add_u32 m0, s42, 6144
    s_add_u32 s46, s38, 393216
    buffer_load_dwordx4 v8, s[8:11], s46 offen offset:0 nt lds
    buffer_load_dwordx4 v9, s[8:11], s46 offen offset:1024 nt lds
    buffer_load_dwordx4 v10, s[8:11], s46 offen offset:2048 nt lds
    s_add_u32 m0, s42, 12288
    s_add_u32 s46, s38, 786432
    buffer_load_dwordx4 v8, s[8:11], s46 offen offset:0 nt lds
    buffer_load_dwordx4 v9, s[8:11], s46 offen offset:1024 nt lds
    buffer_load_dwordx4 v10, s[8:11], s46 offen offset:2048 nt lds
    s_add_u32 m0, s42, 18432
    s_add_u32 s46, s38, 1179648
    buffer_load_dwordx4 v8, s[8:11], s46 offen offset:0 nt lds
    buffer_load_dwordx4 v9, s[8:11], s46 offen offset:1024 nt lds
    buffer_load_dwordx4 v10, s[8:11], s46 offen offset:2048 nt lds
    v_lshrrev_b32 v18, 1, v16
    v_xor_b32 v18, v18, v17
    v_lshlrev_b32 v18, 4, v18
    v_mul_u32_u24 v19, 384, v16
    v_add_u32 v2, v18, v19
    v_xor_b32 v3, 64, v2
    v_lshrrev_b32 v18, 5, v0
    v_mul_u32_u24 v18, 196608, v18
    v_and_b32 v19, 1, v17
    v_mul_u32_u24 v19, 1536, v19
    v_lshlrev_b32 v20, 3, v16
    v_add3_u32 v12, v18, v19, v20
    s_lshl_b32 s60, s37, 7
    v_add_u32 v12, s60, v12
    v_lshrrev_b32 v18, 3, v16
    v_mul_u32_u24 v18, 196608, v18
    v_and_b32 v19, 7, v16
    v_mul_u32_u24 v19, 384, v19
    v_lshlrev_b32 v20, 4, v17
    v_add3_u32 v21, v18, v19, v20
    s_lshl_b32 s60, s37, 6
    s_add_u32 s60, s60, 256
    v_add_u32 v16, s60, v21
    v_add_u32 v13, 393216, v12
    v_add_u32 v17, 393216, v16
    v_add_u32 v14, 786432, v12
    v_add_u32 v18, 786432, v16
    v_add_u32 v15, 1179648, v12
    v_add_u32 v19, 1179648, v16
    v_add_u32 v6, 147456, v1
    v_mov_b32 v23, 139264
    s_mov_b32 s12, s6
    s_mov_b32 s13, s7
    s_mov_b32 s14, 100663296
    s_mov_b32 s15, 0x00020000
    s_mov_b32 s41, 0
    s_mov_b32 s16, 100663296
    s_mov_b32 s17, 100663296
    s_add_u32 s18, s38, 0
    s_add_u32 s19, s38, 6291456
    s_add_u32 s43, s38, 12582912
    s_getpc_b64 s[56:57]
L_pc:
    s_sub_u32 s56, s56, L_pc-L_mloop
    s_subb_u32 s57, s57, 0
    s_mov_b32 s58, L_codeend-L_mloop
    s_mov_b32 s59, 0x00020000
    s_lshr_b32 s60, s2, 3
    s_and_b32 s60, s60, 7
    s_lshl_b32 s60, s60, 1
    s_add_u32 s60, s60, s37
    s_lshl_b32 s60, s60, 10
    buffer_load_dwordx4 v[28:31], v1, s[56:59], s60 offen
    s_mul_i32 s61, s37, 36864
    s_add_u32 s61, s61, 73728
    s_waitcnt vmcnt(1)
    s_barrier
    buffer_load_dwordx4 a[0:3], v1, s[52:55], s61 offen offset:0
    buffer_load_dwordx4 a[4:7], v1, s[52:55], s61 offen offset:1024
    buffer_load_dwordx4 a[8:11], v1, s[52:55], s61 offen offset:2048
    buffer_load_dwordx4 a[12:15], v1, s[52:55], s61 offen offset:3072
    s_add_u32 s61, s61, 4096
    buffer_load_dwordx4 a[16:19], v1, s[52:55], s61 offen offset:0
    buffer_load_dwordx4 a[20:23], v1, s[52:55], s61 offen offset:1024
    buffer_load_dwordx4 a[24:27], v1, s[52:55], s61 offen offset:2048
    buffer_load_dwordx4 a[28:31], v1, s[52:55], s61 offen offset:3072
    s_add_u32 s61, s61, 4096
    buffer_load_dwordx4 a[32:35], v1, s[52:55], s61 offen offset:0
    buffer_load_dwordx4 a[36:39], v1, s[52:55], s61 offen offset:1024
    buffer_load_dwordx4 a[40:43], v1, s[52:55], s61 offen offset:2048
    buffer_load_dwordx4 a[44:47], v1, s[52:55], s61 offen offset:3072
    s_add_u32 s61, s61, 4096
    buffer_load_dwordx4 a[48:51], v1, s[52:55], s61 offen offset:0
    buffer_load_dwordx4 a[52:55], v1, s[52:55], s61 offen offset:1024
    buffer_load_dwordx4 a[56:59], v1, s[52:55], s61 offen offset:2048
    buffer_load_dwordx4 a[60:63], v1, s[52:55], s61 offen offset:3072
    s_add_u32 s61, s61, 4096
    buffer_load_dwordx4 a[64:67], v1, s[52:55], s61 offen offset:0
    buffer_load_dwordx4 a[68:71], v1, s[52:55], s61 offen offset:1024
    buffer_load_dwordx4 a[72:75], v1, s[52:55], s61 offen offset:2048
    buffer_load_dwordx4 a[76:79], v1, s[52:55], s61 offen offset:3072
    s_add_u32 s61, s61, 4096
    buffer_load_dwordx4 a[80:83], v1, s[52:55], s61 offen offset:0
    buffer_load_dwordx4 a[84:87], v1, s[52:55], s61 offen offset:1024
    buffer_load_dwordx4 a[88:91], v1, s[52:55], s61 offen offset:2048
    buffer_load_dwordx4 a[92:95], v1, s[52:55], s61 offen offset:3072
    s_add_u32 s61, s61, 4096
    buffer_load_dwordx4 a[96:99], v1, s[52:55], s61 offen offset:0
    buffer_load_dwordx4 a[100:103], v1, s[52:55], s61 offen offset:1024
    buffer_load_dwordx4 a[104:107], v1, s[52:55], s61 offen offset:2048
    buffer_load_dwordx4 a[108:111], v1, s[52:55], s61 offen offset:3072
    s_add_u32 s61, s61, 4096
    buffer_load_dwordx4 a[112:115], v1, s[52:55], s61 offen offset:0
    buffer_load_dwordx4 a[116:119], v1, s[52:55], s61 offen offset:1024
    buffer_load_dwordx4 a[120:123], v1, s[52:55], s61 offen offset:2048
    buffer_load_dwordx4 a[124:127], v1, s[52:55], s61 offen offset:3072
    s_add_u32 s61, s61, 4096
    buffer_load_dwordx4 a[128:131], v1, s[52:55], s61 offen offset:0
    buffer_load_dwordx4 a[132:135], v1, s[52:55], s61 offen offset:1024
    buffer_load_dwordx4 a[136:139], v1, s[52:55], s61 offen offset:2048
    buffer_load_dwordx4 a[140:143], v1, s[52:55], s61 offen offset:3072
    ds_read_b128 a[144:147], v2 offset:0
    ds_read_b128 a[148:151], v3 offset:0
    ds_read_b128 a[152:155], v2 offset:128
    ds_read_b128 a[156:159], v3 offset:128
    ds_read_b128 a[160:163], v2 offset:256
    ds_read_b128 a[164:167], v3 offset:256
    ds_read_b128 a[168:171], v2 offset:6144
    ds_read_b128 a[172:175], v3 offset:6144
    ds_read_b128 a[176:179], v2 offset:6272
    ds_read_b128 a[180:183], v3 offset:6272
    ds_read_b128 a[184:187], v2 offset:6400
    ds_read_b128 a[188:191], v3 offset:6400
    ds_read_b128 a[192:195], v2 offset:12288
    ds_read_b128 a[196:199], v3 offset:12288
    ds_read_b128 a[200:203], v2 offset:12416
    ds_read_b128 a[204:207], v3 offset:12416
    ds_read_b128 a[208:211], v2 offset:12544
    ds_read_b128 a[212:215], v3 offset:12544
    ds_read_b128 a[216:219], v2 offset:18432
    ds_read_b128 a[220:223], v3 offset:18432
    ds_read_b128 a[224:227], v2 offset:18560
    ds_read_b128 a[228:231], v3 offset:18560
    ds_read_b128 a[232:235], v2 offset:18688
    ds_read_b128 a[236:239], v3 offset:18688
    s_add_u32 m0, s42, 24576
    s_add_u32 s46, s38, 6291456
    buffer_load_dwordx4 v8, s[8:11], s46 offen offset:0 nt lds
    buffer_load_dwordx4 v9, s[8:11], s46 offen offset:1024 nt lds
    buffer_load_dwordx4 v10, s[8:11], s46 offen offset:2048 nt lds
    s_add_u32 m0, s42, 30720
    s_add_u32 s46, s38, 6684672
    buffer_load_dwordx4 v8, s[8:11], s46 offen offset:0 nt lds
    buffer_load_dwordx4 v9, s[8:11], s46 offen offset:1024 nt lds
    buffer_load_dwordx4 v10, s[8:11], s46 offen offset:2048 nt lds
    s_add_u32 m0, s42, 36864
    s_add_u32 s46, s38, 7077888
    buffer_load_dwordx4 v8, s[8:11], s46 offen offset:0 nt lds
    buffer_load_dwordx4 v9, s[8:11], s46 offen offset:1024 nt lds
    buffer_load_dwordx4 v10, s[8:11], s46 offen offset:2048 nt lds
    s_add_u32 m0, s42, 43008
    s_add_u32 s46, s38, 7471104
    buffer_load_dwordx4 v8, s[8:11], s46 offen offset:0 nt lds
    buffer_load_dwordx4 v9, s[8:11], s46 offen offset:1024 nt lds
    buffer_load_dwordx4 v10, s[8:11], s46 offen offset:2048 nt lds
    buffer_load_dword v28, v1, s[8:11], s16 offen
    buffer_load_dword v28, v1, s[8:11], s16 offen
    buffer_load_dword v28, v1, s[8:11], s16 offen
    buffer_load_dword v28, v1, s[8:11], s16 offen
    buffer_load_dword v28, v1, s[8:11], s16 offen
    s_add_u32 m0, s42, 49152
    s_add_u32 s46, s38, 12582912
    buffer_load_dwordx4 v8, s[8:11], s46 offen offset:0 nt lds
    buffer_load_dwordx4 v9, s[8:11], s46 offen offset:1024 nt lds
    buffer_load_dwordx4 v10, s[8:11], s46 offen offset:2048 nt lds
    s_add_u32 m0, s42, 55296
    s_add_u32 s46, s38, 12976128
    buffer_load_dwordx4 v8, s[8:11], s46 offen offset:0 nt lds
    s_add_u32 s42, s42, 49152
    s_waitcnt vmcnt(21) lgkmcnt(0)
    s_branch L_nmid1
    .p2align 6
L_nloop0:
    v_mfma_f32_16x16x32_bf16 v[192:195], a[144:147], a[120:123], 0
    ds_read_b32 v22, v23
    v_xor_b32 v23, 4, v23
    v_mfma_f32_16x16x32_bf16 v[192:195], a[148:151], a[124:127], v[192:195]
    ds_read_b128 v[128:131], v6 offset:0
    v_cvt_pk_bf16_f32 v70, v204, v205
    v_mfma_f32_16x16x32_bf16 v[192:195], a[152:155], a[128:131], v[192:195]
    ds_read_b128 v[132:135], v6 offset:1024
    v_cvt_pk_bf16_f32 v71, v206, v207
    v_mfma_f32_16x16x32_bf16 v[192:195], a[156:159], a[132:135], v[192:195]
    ds_read_b128 v[136:139], v6 offset:2048
    v_mfma_f32_16x16x32_bf16 v[192:195], a[160:163], a[136:139], v[192:195]
    ds_read_b128 v[140:143], v6 offset:3072
    v_mfma_f32_16x16x32_bf16 v[192:195], a[164:167], a[140:143], v[192:195]
    ds_read_b128 v[144:147], v6 offset:4096
    v_mfma_f32_16x16x32_bf16 v[196:199], a[168:171], a[120:123], 0
    ds_read_b128 v[148:151], v6 offset:5120
    v_mfma_f32_16x16x32_bf16 v[196:199], a[172:175], a[124:127], v[196:199]
    ds_read_b128 v[152:155], v6 offset:6144
    v_mfma_f32_16x16x32_bf16 v[196:199], a[176:179], a[128:131], v[196:199]
    ds_read_b128 v[156:159], v6 offset:7168
    v_cvt_pk_bf16_f32 v72, v192, v193
    v_mfma_f32_16x16x32_bf16 v[196:199], a[180:183], a[132:135], v[196:199]
    s_waitcnt lgkmcnt(8)
    v_readfirstlane_b32 s43, v22
    v_mfma_f32_16x16x32_bf16 v[196:199], a[184:187], a[136:139], v[196:199]
    s_add_u32 m0, s42, 0
    s_add_u32 s46, s43, 0
    v_mfma_f32_16x16x32_bf16 v[196:199], a[188:191], a[140:143], v[196:199]
    v_cvt_pk_bf16_f32 v73, v194, v195
    v_xor_b32 v6, 8192, v6
    v_mfma_f32_16x16x32_bf16 v[200:203], a[192:195], a[120:123], 0
    buffer_load_dwordx4 v8, s[8:11], s46 offen offset:0 nt lds
    v_mfma_f32_16x16x32_bf16 v[200:203], a[196:199], a[124:127], v[200:203]
    ds_read_b128 a[144:147], v4 offset:0
    v_mfma_f32_16x16x32_bf16 v[200:203], a[200:203], a[128:131], v[200:203]
    v_cvt_pk_bf16_f32 v74, v196, v197
    v_cvt_pk_bf16_f32 v75, v198, v199
    v_mfma_f32_16x16x32_bf16 v[200:203], a[204:207], a[132:135], v[200:203]
    ds_read_b128 a[148:151], v5 offset:0
    v_mfma_f32_16x16x32_bf16 v[200:203], a[208:211], a[136:139], v[200:203]
    ds_read_b128 a[152:155], v4 offset:128
    v_mfma_f32_16x16x32_bf16 v[200:203], a[212:215], a[140:143], v[200:203]
    ds_read_b128 a[156:159], v5 offset:128
    v_mfma_f32_16x16x32_bf16 v[204:207], a[216:219], a[120:123], 0
    ds_read_b128 a[160:163], v4 offset:256
    v_mfma_f32_16x16x32_bf16 v[204:207], a[220:223], a[124:127], v[204:207]
    ds_read_b128 a[164:167], v5 offset:256
    v_mfma_f32_16x16x32_bf16 v[204:207], a[224:227], a[128:131], v[204:207]
    v_cvt_pk_bf16_f32 v76, v200, v201
    v_cvt_pk_bf16_f32 v77, v202, v203
    v_mfma_f32_16x16x32_bf16 v[204:207], a[228:231], a[132:135], v[204:207]
    ds_read_b128 a[168:171], v4 offset:6144
    v_mfma_f32_16x16x32_bf16 v[204:207], a[232:235], a[136:139], v[204:207]
    ds_read_b128 a[172:175], v5 offset:6144
    v_mfma_f32_16x16x32_bf16 v[204:207], a[236:239], a[140:143], v[204:207]
    ds_read_b128 a[176:179], v4 offset:6272
    s_waitcnt lgkmcnt(9)
    v_mfma_f32_16x16x32_bf16 v[184:187], v[128:131], v[80:83], 0
    ds_read_b128 a[180:183], v5 offset:6272
    v_mfma_f32_16x16x32_bf16 v[184:187], v[132:135], v[84:87], v[184:187]
    ds_read_b128 a[184:187], v4 offset:6400
    v_mfma_f32_16x16x32_bf16 v[188:191], v[128:131], v[88:91], 0
    v_cvt_pk_bf16_f32 v78, v204, v205
    v_cvt_pk_bf16_f32 v79, v206, v207
    v_mfma_f32_16x16x32_bf16 v[188:191], v[132:135], v[92:95], v[188:191]
    buffer_load_dwordx4 v9, s[8:11], s46 offen offset:1024 nt lds
    v_mfma_f32_16x16x32_bf16 v[192:195], v[128:131], v[96:99], 0
    ds_read_b128 a[188:191], v5 offset:6400
    v_mfma_f32_16x16x32_bf16 v[192:195], v[132:135], v[100:103], v[192:195]
    ds_read_b128 a[192:195], v4 offset:12288
    v_mfma_f32_16x16x32_bf16 v[196:199], v[128:131], v[104:107], 0
    v_cvt_pk_bf16_f32 v208, v184, v188
    v_cvt_pk_bf16_f32 v210, v185, v189
    v_mfma_f32_16x16x32_bf16 v[196:199], v[132:135], v[108:111], v[196:199]
    ds_read_b128 a[196:199], v5 offset:12288
    v_cvt_pk_bf16_f32 v212, v186, v190
    v_mfma_f32_16x16x32_bf16 v[200:203], v[112:115], v[128:131], 0
    ds_read_b128 a[200:203], v4 offset:12416
    v_cvt_pk_bf16_f32 v214, v187, v191
    v_mfma_f32_16x16x32_bf16 v[200:203], v[116:119], v[132:135], v[200:203]
    ds_read_b128 a[204:207], v5 offset:12416
    v_mfma_f32_16x16x32_bf16 v[204:207], v[120:123], v[128:131], 0
    v_cvt_pk_bf16_f32 v209, v192, v196
    v_cvt_pk_bf16_f32 v211, v193, v197
    v_mfma_f32_16x16x32_bf16 v[204:207], v[124:127], v[132:135], v[204:207]
    ds_read_b128 a[208:211], v4 offset:12544
    v_cvt_pk_bf16_f32 v213, v194, v198
    v_mfma_f32_16x16x32_bf16 v[160:163], v[136:139], v[80:83], 0
    ds_read_b128 a[212:215], v5 offset:12544
    v_cvt_pk_bf16_f32 v215, v195, v199
    v_mfma_f32_16x16x32_bf16 v[160:163], v[140:143], v[84:87], v[160:163]
    ds_read_b128 a[216:219], v4 offset:18432
    v_cvt_pk_bf16_f32 v216, v200, v201
    v_mfma_f32_16x16x32_bf16 v[164:167], v[136:139], v[88:91], 0
    ds_read_b128 a[220:223], v5 offset:18432
    v_cvt_pk_bf16_f32 v217, v202, v203
    v_mfma_f32_16x16x32_bf16 v[164:167], v[140:143], v[92:95], v[164:167]
    ds_read_b128 a[224:227], v4 offset:18560
    v_cvt_pk_bf16_f32 v218, v204, v205
    v_mfma_f32_16x16x32_bf16 v[168:171], v[136:139], v[96:99], 0
    buffer_store_dwordx2 v[208:209], v12, s[12:15], s16 offen offset:0 sc1
    v_mfma_f32_16x16x32_bf16 v[168:171], v[140:143], v[100:103], v[168:171]
    ds_read_b128 a[228:231], v5 offset:18560
    v_cvt_pk_bf16_f32 v219, v206, v207
    v_mfma_f32_16x16x32_bf16 v[172:175], v[136:139], v[104:107], 0
    buffer_load_dwordx4 v10, s[8:11], s46 offen offset:2048 nt lds
    v_mfma_f32_16x16x32_bf16 v[172:175], v[140:143], v[108:111], v[172:175]
    ds_read_b128 a[232:235], v4 offset:18688
    v_cvt_pk_bf16_f32 v220, v160, v164
    v_mfma_f32_16x16x32_bf16 v[176:179], v[112:115], v[136:139], 0
    ds_read_b128 a[236:239], v5 offset:18688
    v_cvt_pk_bf16_f32 v222, v161, v165
    v_mfma_f32_16x16x32_bf16 v[176:179], v[116:119], v[140:143], v[176:179]
    v_cvt_pk_bf16_f32 v224, v162, v166
    v_cvt_pk_bf16_f32 v226, v163, v167
    v_mfma_f32_16x16x32_bf16 v[180:183], v[120:123], v[136:139], 0
    v_cvt_pk_bf16_f32 v221, v168, v172
    v_cvt_pk_bf16_f32 v223, v169, v173
    v_mfma_f32_16x16x32_bf16 v[180:183], v[124:127], v[140:143], v[180:183]
    buffer_store_dwordx2 v[210:211], v12, s[12:15], s16 offen offset:384 sc1
    v_mfma_f32_16x16x32_bf16 v[184:187], v[144:147], v[80:83], 0
    v_cvt_pk_bf16_f32 v225, v170, v174
    v_cvt_pk_bf16_f32 v227, v171, v175
    v_mfma_f32_16x16x32_bf16 v[184:187], v[148:151], v[84:87], v[184:187]
    v_cvt_pk_bf16_f32 v228, v176, v177
    v_cvt_pk_bf16_f32 v229, v178, v179
    v_mfma_f32_16x16x32_bf16 v[188:191], v[144:147], v[88:91], 0
    v_cvt_pk_bf16_f32 v230, v180, v181
    v_cvt_pk_bf16_f32 v231, v182, v183
    v_mfma_f32_16x16x32_bf16 v[188:191], v[148:151], v[92:95], v[188:191]
    v_mfma_f32_16x16x32_bf16 v[192:195], v[144:147], v[96:99], 0
    v_mfma_f32_16x16x32_bf16 v[192:195], v[148:151], v[100:103], v[192:195]
    v_mfma_f32_16x16x32_bf16 v[196:199], v[144:147], v[104:107], 0
    v_cvt_pk_bf16_f32 v232, v184, v188
    v_cvt_pk_bf16_f32 v234, v185, v189
    v_mfma_f32_16x16x32_bf16 v[196:199], v[148:151], v[108:111], v[196:199]
    buffer_store_dwordx2 v[212:213], v12, s[12:15], s16 offen offset:768 sc1
    v_mfma_f32_16x16x32_bf16 v[200:203], v[112:115], v[144:147], 0
    s_add_u32 m0, s42, 6144
    s_add_u32 s46, s43, 393216
    v_mfma_f32_16x16x32_bf16 v[200:203], v[116:119], v[148:151], v[200:203]
    buffer_load_dwordx4 v8, s[8:11], s46 offen offset:0 nt lds
    v_mfma_f32_16x16x32_bf16 v[204:207], v[120:123], v[144:147], 0
    v_cvt_pk_bf16_f32 v233, v192, v196
    v_cvt_pk_bf16_f32 v235, v193, v197
    v_mfma_f32_16x16x32_bf16 v[204:207], v[124:127], v[148:151], v[204:207]
    v_cvt_pk_bf16_f32 v237, v194, v198
    v_cvt_pk_bf16_f32 v239, v195, v199
    v_mfma_f32_16x16x32_bf16 v[160:163], v[152:155], v[80:83], 0
    v_cvt_pk_bf16_f32 v240, v200, v201
    v_cvt_pk_bf16_f32 v241, v202, v203
    v_mfma_f32_16x16x32_bf16 v[160:163], v[156:159], v[84:87], v[160:163]
    v_cvt_pk_bf16_f32 v236, v186, v190
    v_cvt_pk_bf16_f32 v238, v187, v191
    v_mfma_f32_16x16x32_bf16 v[164:167], v[152:155], v[88:91], 0
    buffer_store_dwordx2 v[214:215], v12, s[12:15], s16 offen offset:1152 sc1
    v_mfma_f32_16x16x32_bf16 v[164:167], v[156:159], v[92:95], v[164:167]
    v_cvt_pk_bf16_f32 v242, v204, v205
    v_cvt_pk_bf16_f32 v243, v206, v207
    v_mfma_f32_16x16x32_bf16 v[168:171], v[152:155], v[96:99], 0
    v_mfma_f32_16x16x32_bf16 v[168:171], v[156:159], v[100:103], v[168:171]
    v_mfma_f32_16x16x32_bf16 v[172:175], v[152:155], v[104:107], 0
    v_cvt_pk_bf16_f32 v244, v160, v164
    v_cvt_pk_bf16_f32 v246, v161, v165
    v_mfma_f32_16x16x32_bf16 v[172:175], v[156:159], v[108:111], v[172:175]
    v_cvt_pk_bf16_f32 v248, v162, v166
    v_cvt_pk_bf16_f32 v250, v163, v167
    v_mfma_f32_16x16x32_bf16 v[176:179], v[112:115], v[152:155], 0
    v_mfma_f32_16x16x32_bf16 v[176:179], v[116:119], v[156:159], v[176:179]
    v_mfma_f32_16x16x32_bf16 v[180:183], v[120:123], v[152:155], 0
    buffer_store_dwordx4 v[216:219], v16, s[12:15], s16 offen sc1
    v_mfma_f32_16x16x32_bf16 v[180:183], v[124:127], v[156:159], v[180:183]
    v_cvt_pk_bf16_f32 v245, v168, v172
    s_cmp_ge_u32 s18, 100663296
    s_cbranch_scc1 L_nepi0
L_nmid0:
    s_waitcnt lgkmcnt(0)
    v_mfma_f32_16x16x32_bf16 v[192:195], a[144:147], a[0:3], 0
    buffer_load_dwordx4 v9, s[8:11], s46 offen offset:1024 nt lds
    v_mfma_f32_16x16x32_bf16 v[192:195], a[148:151], a[4:7], v[192:195]
    v_cvt_pk_bf16_f32 v247, v169, v173
    v_cvt_pk_bf16_f32 v249, v170, v174
    v_mfma_f32_16x16x32_bf16 v[192:195], a[152:155], a[8:11], v[192:195]
    v_cvt_pk_bf16_f32 v251, v171, v175
    v_cvt_pk_bf16_f32 v252, v176, v177
    v_mfma_f32_16x16x32_bf16 v[192:195], a[156:159], a[12:15], v[192:195]
    v_cvt_pk_bf16_f32 v253, v178, v179
    v_cvt_pk_bf16_f32 v254, v180, v181
    v_mfma_f32_16x16x32_bf16 v[192:195], a[160:163], a[16:19], v[192:195]
    v_cvt_pk_bf16_f32 v255, v182, v183
    v_mfma_f32_16x16x32_bf16 v[192:195], a[164:167], a[20:23], v[192:195]
    v_mfma_f32_16x16x32_bf16 v[196:199], a[168:171], a[0:3], 0
    buffer_store_dwordx2 v[220:221], v13, s[12:15], s16 offen offset:0 sc1
    v_mfma_f32_16x16x32_bf16 v[196:199], a[172:175], a[4:7], v[196:199]
    v_mfma_f32_16x16x32_bf16 v[196:199], a[176:179], a[8:11], v[196:199]
    v_cvt_pk_bf16_f32 v80, v192, v193
    v_cvt_pk_bf16_f32 v81, v194, v195
    v_mfma_f32_16x16x32_bf16 v[196:199], a[180:183], a[12:15], v[196:199]
    v_mfma_f32_16x16x32_bf16 v[196:199], a[184:187], a[16:19], v[196:199]
    v_mfma_f32_16x16x32_bf16 v[196:199], a[188:191], a[20:23], v[196:199]
    v_mfma_f32_16x16x32_bf16 v[200:203], a[192:195], a[0:3], 0
    v_mfma_f32_16x16x32_bf16 v[200:203], a[196:199], a[4:7], v[200:203]
    buffer_store_dwordx2 v[222:223], v13, s[12:15], s16 offen offset:384 sc1
    v_mfma_f32_16x16x32_bf16 v[200:203], a[200:203], a[8:11], v[200:203]
    v_cvt_pk_bf16_f32 v82, v196, v197
    v_cvt_pk_bf16_f32 v83, v198, v199
    v_mfma_f32_16x16x32_bf16 v[200:203], a[204:207], a[12:15], v[200:203]
    buffer_load_dwordx4 v10, s[8:11], s46 offen offset:2048 nt lds
    v_mfma_f32_16x16x32_bf16 v[200:203], a[208:211], a[16:19], v[200:203]
    v_mfma_f32_16x16x32_bf16 v[200:203], a[212:215], a[20:23], v[200:203]
    v_mfma_f32_16x16x32_bf16 v[204:207], a[216:219], a[0:3], 0
    v_mfma_f32_16x16x32_bf16 v[204:207], a[220:223], a[4:7], v[204:207]
    v_mfma_f32_16x16x32_bf16 v[204:207], a[224:227], a[8:11], v[204:207]
    v_cvt_pk_bf16_f32 v84, v200, v201
    v_cvt_pk_bf16_f32 v85, v202, v203
    v_mfma_f32_16x16x32_bf16 v[204:207], a[228:231], a[12:15], v[204:207]
    buffer_store_dwordx2 v[224:225], v13, s[12:15], s16 offen offset:768 sc1
    v_mfma_f32_16x16x32_bf16 v[204:207], a[232:235], a[16:19], v[204:207]
    v_mfma_f32_16x16x32_bf16 v[204:207], a[236:239], a[20:23], v[204:207]
    v_mfma_f32_16x16x32_bf16 v[192:195], a[144:147], a[24:27], 0
    v_mfma_f32_16x16x32_bf16 v[192:195], a[148:151], a[28:31], v[192:195]
    v_mfma_f32_16x16x32_bf16 v[192:195], a[152:155], a[32:35], v[192:195]
    v_cvt_pk_bf16_f32 v86, v204, v205
    v_cvt_pk_bf16_f32 v87, v206, v207
    v_mfma_f32_16x16x32_bf16 v[192:195], a[156:159], a[36:39], v[192:195]
    v_mfma_f32_16x16x32_bf16 v[192:195], a[160:163], a[40:43], v[192:195]
    buffer_store_dwordx2 v[226:227], v13, s[12:15], s16 offen offset:1152 sc1
    v_mfma_f32_16x16x32_bf16 v[192:195], a[164:167], a[44:47], v[192:195]
    s_add_u32 m0, s42, 12288
    s_add_u32 s46, s43, 786432
    v_mfma_f32_16x16x32_bf16 v[196:199], a[168:171], a[24:27], 0
    buffer_load_dwordx4 v8, s[8:11], s46 offen offset:0 nt lds
    v_mfma_f32_16x16x32_bf16 v[196:199], a[172:175], a[28:31], v[196:199]
    s_add_u32 s41, s41, 24576
    s_cmp_ge_u32 s41, 73728
    s_cselect_b32 s56, 73728, 0
    s_sub_u32 s41, s41, s56
    v_add_u32 v4, s41, v2
    v_mfma_f32_16x16x32_bf16 v[196:199], a[176:179], a[32:35], v[196:199]
    v_cvt_pk_bf16_f32 v88, v192, v193
    v_cvt_pk_bf16_f32 v89, v194, v195
    v_mfma_f32_16x16x32_bf16 v[196:199], a[180:183], a[36:39], v[196:199]
    v_add_u32 v5, s41, v3
    v_mfma_f32_16x16x32_bf16 v[196:199], a[184:187], a[40:43], v[196:199]
    v_mfma_f32_16x16x32_bf16 v[196:199], a[188:191], a[44:47], v[196:199]
    v_mfma_f32_16x16x32_bf16 v[200:203], a[192:195], a[24:27], 0
    buffer_store_dwordx4 v[228:231], v17, s[12:15], s16 offen sc1
    v_mfma_f32_16x16x32_bf16 v[200:203], a[196:199], a[28:31], v[200:203]
    v_mfma_f32_16x16x32_bf16 v[200:203], a[200:203], a[32:35], v[200:203]
    v_cvt_pk_bf16_f32 v90, v196, v197
    v_cvt_pk_bf16_f32 v91, v198, v199
    v_mfma_f32_16x16x32_bf16 v[200:203], a[204:207], a[36:39], v[200:203]
    v_mfma_f32_16x16x32_bf16 v[200:203], a[208:211], a[40:43], v[200:203]
    v_mfma_f32_16x16x32_bf16 v[200:203], a[212:215], a[44:47], v[200:203]
    v_mfma_f32_16x16x32_bf16 v[204:207], a[216:219], a[24:27], 0
    v_mfma_f32_16x16x32_bf16 v[204:207], a[220:223], a[28:31], v[204:207]
    v_mfma_f32_16x16x32_bf16 v[204:207], a[224:227], a[32:35], v[204:207]
    buffer_store_dwordx2 v[232:233], v14, s[12:15], s16 offen offset:0 sc1
    v_mfma_f32_16x16x32_bf16 v[204:207], a[228:231], a[36:39], v[204:207]
    buffer_load_dwordx4 v9, s[8:11], s46 offen offset:1024 nt lds
    v_mfma_f32_16x16x32_bf16 v[204:207], a[232:235], a[40:43], v[204:207]
    v_cvt_pk_bf16_f32 v92, v200, v201
    v_cvt_pk_bf16_f32 v93, v202, v203
    v_mfma_f32_16x16x32_bf16 v[204:207], a[236:239], a[44:47], v[204:207]
    v_mfma_f32_16x16x32_bf16 v[192:195], a[144:147], a[48:51], 0
    v_mfma_f32_16x16x32_bf16 v[192:195], a[148:151], a[52:55], v[192:195]
    v_mfma_f32_16x16x32_bf16 v[192:195], a[152:155], a[56:59], v[192:195]
    v_cvt_pk_bf16_f32 v94, v204, v205
    v_cvt_pk_bf16_f32 v95, v206, v207
    v_mfma_f32_16x16x32_bf16 v[192:195], a[156:159], a[60:63], v[192:195]
    buffer_store_dwordx2 v[234:235], v14, s[12:15], s16 offen offset:384 sc1
    v_mfma_f32_16x16x32_bf16 v[192:195], a[160:163], a[64:67], v[192:195]
    v_mfma_f32_16x16x32_bf16 v[192:195], a[164:167], a[68:71], v[192:195]
    v_mfma_f32_16x16x32_bf16 v[196:199], a[168:171], a[48:51], 0
    v_mfma_f32_16x16x32_bf16 v[196:199], a[172:175], a[52:55], v[196:199]
    v_mfma_f32_16x16x32_bf16 v[196:199], a[176:179], a[56:59], v[196:199]
    v_cvt_pk_bf16_f32 v96, v192, v193
    v_cvt_pk_bf16_f32 v97, v194, v195
    v_mfma_f32_16x16x32_bf16 v[196:199], a[180:183], a[60:63], v[196:199]
    v_mfma_f32_16x16x32_bf16 v[196:199], a[184:187], a[64:67], v[196:199]
    v_mfma_f32_16x16x32_bf16 v[196:199], a[188:191], a[68:71], v[196:199]
    buffer_store_dwordx2 v[236:237], v14, s[12:15], s16 offen offset:768 sc1
    v_mfma_f32_16x16x32_bf16 v[200:203], a[192:195], a[48:51], 0
    buffer_load_dwordx4 v10, s[8:11], s46 offen offset:2048 nt lds
    v_mfma_f32_16x16x32_bf16 v[200:203], a[196:199], a[52:55], v[200:203]
    v_mfma_f32_16x16x32_bf16 v[200:203], a[200:203], a[56:59], v[200:203]
    v_cvt_pk_bf16_f32 v98, v196, v197
    v_cvt_pk_bf16_f32 v99, v198, v199
    v_mfma_f32_16x16x32_bf16 v[200:203], a[204:207], a[60:63], v[200:203]
    v_mfma_f32_16x16x32_bf16 v[200:203], a[208:211], a[64:67], v[200:203]
    v_mfma_f32_16x16x32_bf16 v[200:203], a[212:215], a[68:71], v[200:203]
    v_mfma_f32_16x16x32_bf16 v[204:207], a[216:219], a[48:51], 0
    buffer_store_dwordx2 v[238:239], v14, s[12:15], s16 offen offset:1152 sc1
    v_mfma_f32_16x16x32_bf16 v[204:207], a[220:223], a[52:55], v[204:207]
    v_mfma_f32_16x16x32_bf16 v[204:207], a[224:227], a[56:59], v[204:207]
    v_cvt_pk_bf16_f32 v100, v200, v201
    v_cvt_pk_bf16_f32 v101, v202, v203
    v_mfma_f32_16x16x32_bf16 v[204:207], a[228:231], a[60:63], v[204:207]
    v_mfma_f32_16x16x32_bf16 v[204:207], a[232:235], a[64:67], v[204:207]
    v_mfma_f32_16x16x32_bf16 v[204:207], a[236:239], a[68:71], v[204:207]
    v_mfma_f32_16x16x32_bf16 v[192:195], a[144:147], a[72:75], 0
    v_mfma_f32_16x16x32_bf16 v[192:195], a[148:151], a[76:79], v[192:195]
    s_add_u32 m0, s42, 18432
    s_add_u32 s46, s43, 1179648
    v_mfma_f32_16x16x32_bf16 v[192:195], a[152:155], a[80:83], v[192:195]
    buffer_store_dwordx4 v[240:243], v18, s[12:15], s16 offen sc1
    v_mfma_f32_16x16x32_bf16 v[192:195], a[156:159], a[84:87], v[192:195]
    buffer_load_dwordx4 v8, s[8:11], s46 offen offset:0 nt lds
    v_mfma_f32_16x16x32_bf16 v[192:195], a[160:163], a[88:91], v[192:195]
    v_cvt_pk_bf16_f32 v102, v204, v205
    v_cvt_pk_bf16_f32 v103, v206, v207
    v_mfma_f32_16x16x32_bf16 v[192:195], a[164:167], a[92:95], v[192:195]
    v_mfma_f32_16x16x32_bf16 v[196:199], a[168:171], a[72:75], 0
    v_mfma_f32_16x16x32_bf16 v[196:199], a[172:175], a[76:79], v[196:199]
    v_mfma_f32_16x16x32_bf16 v[196:199], a[176:179], a[80:83], v[196:199]
    v_cvt_pk_bf16_f32 v104, v192, v193
    v_cvt_pk_bf16_f32 v105, v194, v195
    v_mfma_f32_16x16x32_bf16 v[196:199], a[180:183], a[84:87], v[196:199]
    v_mfma_f32_16x16x32_bf16 v[196:199], a[184:187], a[88:91], v[196:199]
    buffer_store_dwordx2 v[244:245], v15, s[12:15], s16 offen offset:0 sc1
    v_mfma_f32_16x16x32_bf16 v[196:199], a[188:191], a[92:95], v[196:199]
    v_mfma_f32_16x16x32_bf16 v[200:203], a[192:195], a[72:75], 0
    v_mfma_f32_16x16x32_bf16 v[200:203], a[196:199], a[76:79], v[200:203]
    v_mfma_f32_16x16x32_bf16 v[200:203], a[200:203], a[80:83], v[200:203]
    v_cvt_pk_bf16_f32 v106, v196, v197
    v_cvt_pk_bf16_f32 v107, v198, v199
    v_mfma_f32_16x16x32_bf16 v[200:203], a[204:207], a[84:87], v[200:203]
    v_mfma_f32_16x16x32_bf16 v[200:203], a[208:211], a[88:91], v[200:203]
    v_mfma_f32_16x16x32_bf16 v[200:203], a[212:215], a[92:95], v[200:203]
    buffer_store_dwordx2 v[246:247], v15, s[12:15], s16 offen offset:384 sc1
    v_mfma_f32_16x16x32_bf16 v[204:207], a[216:219], a[72:75], 0
    buffer_load_dwordx4 v9, s[8:11], s46 offen offset:1024 nt lds
    v_mfma_f32_16x16x32_bf16 v[204:207], a[220:223], a[76:79], v[204:207]
    s_add_u32 s42, s42, 24576
    s_cmp_ge_u32 s42, 73728
    s_cselect_b32 s57, 73728, 0
    s_sub_u32 s42, s42, s57
    v_mfma_f32_16x16x32_bf16 v[204:207], a[224:227], a[80:83], v[204:207]
    v_cvt_pk_bf16_f32 v108, v200, v201
    v_cvt_pk_bf16_f32 v109, v202, v203
    v_mfma_f32_16x16x32_bf16 v[204:207], a[228:231], a[84:87], v[204:207]
    v_mfma_f32_16x16x32_bf16 v[204:207], a[232:235], a[88:91], v[204:207]
    v_mfma_f32_16x16x32_bf16 v[204:207], a[236:239], a[92:95], v[204:207]
    v_mfma_f32_16x16x32_bf16 v[192:195], a[144:147], a[96:99], 0
    v_mfma_f32_16x16x32_bf16 v[192:195], a[148:151], a[100:103], v[192:195]
    buffer_store_dwordx2 v[248:249], v15, s[12:15], s16 offen offset:768 sc1
    v_mfma_f32_16x16x32_bf16 v[192:195], a[152:155], a[104:107], v[192:195]
    v_cvt_pk_bf16_f32 v110, v204, v205
    v_cvt_pk_bf16_f32 v111, v206, v207
    v_mfma_f32_16x16x32_bf16 v[192:195], a[156:159], a[108:111], v[192:195]
    v_mfma_f32_16x16x32_bf16 v[192:195], a[160:163], a[112:115], v[192:195]
    v_mfma_f32_16x16x32_bf16 v[192:195], a[164:167], a[116:119], v[192:195]
    v_mfma_f32_16x16x32_bf16 v[196:199], a[168:171], a[96:99], 0
    v_mfma_f32_16x16x32_bf16 v[196:199], a[172:175], a[100:103], v[196:199]
    v_mfma_f32_16x16x32_bf16 v[196:199], a[176:179], a[104:107], v[196:199]
    buffer_store_dwordx2 v[250:251], v15, s[12:15], s16 offen offset:1152 sc1
    v_mfma_f32_16x16x32_bf16 v[196:199], a[180:183], a[108:111], v[196:199]
    buffer_load_dwordx4 v10, s[8:11], s46 offen offset:2048 nt lds
    v_mfma_f32_16x16x32_bf16 v[196:199], a[184:187], a[112:115], v[196:199]
    v_cvt_pk_bf16_f32 v112, v192, v193
    v_cvt_pk_bf16_f32 v113, v194, v195
    v_mfma_f32_16x16x32_bf16 v[196:199], a[188:191], a[116:119], v[196:199]
    v_mfma_f32_16x16x32_bf16 v[200:203], a[192:195], a[96:99], 0
    v_mfma_f32_16x16x32_bf16 v[200:203], a[196:199], a[100:103], v[200:203]
    v_mfma_f32_16x16x32_bf16 v[200:203], a[200:203], a[104:107], v[200:203]
    v_cvt_pk_bf16_f32 v114, v196, v197
    v_cvt_pk_bf16_f32 v115, v198, v199
    v_mfma_f32_16x16x32_bf16 v[200:203], a[204:207], a[108:111], v[200:203]
    v_mfma_f32_16x16x32_bf16 v[200:203], a[208:211], a[112:115], v[200:203]
    buffer_store_dwordx4 v[252:255], v19, s[12:15], s16 offen sc1
    v_mfma_f32_16x16x32_bf16 v[200:203], a[212:215], a[116:119], v[200:203]
    s_nop 0
    s_mov_b32 s16, s17
    s_mov_b32 s17, s18
    v_mfma_f32_16x16x32_bf16 v[204:207], a[216:219], a[96:99], 0
    s_mov_b32 s18, s19
    s_mov_b32 s19, s43
    v_mfma_f32_16x16x32_bf16 v[204:207], a[220:223], a[100:103], v[204:207]
    v_mfma_f32_16x16x32_bf16 v[204:207], a[224:227], a[104:107], v[204:207]
    v_cvt_pk_bf16_f32 v116, v200, v201
    v_cvt_pk_bf16_f32 v117, v202, v203
    v_mfma_f32_16x16x32_bf16 v[204:207], a[228:231], a[108:111], v[204:207]
    v_mfma_f32_16x16x32_bf16 v[204:207], a[232:235], a[112:115], v[204:207]
    v_mfma_f32_16x16x32_bf16 v[204:207], a[236:239], a[116:119], v[204:207]
    s_waitcnt vmcnt(32)
    s_barrier
L_nloop1:
    v_mfma_f32_16x16x32_bf16 v[192:195], a[144:147], a[120:123], 0
    ds_read_b32 v22, v23
    v_xor_b32 v23, 4, v23
    v_mfma_f32_16x16x32_bf16 v[192:195], a[148:151], a[124:127], v[192:195]
    ds_read_b128 v[128:131], v6 offset:0
    v_cvt_pk_bf16_f32 v118, v204, v205
    v_mfma_f32_16x16x32_bf16 v[192:195], a[152:155], a[128:131], v[192:195]
    ds_read_b128 v[132:135], v6 offset:1024
    v_cvt_pk_bf16_f32 v119, v206, v207
    v_mfma_f32_16x16x32_bf16 v[192:195], a[156:159], a[132:135], v[192:195]
    ds_read_b128 v[136:139], v6 offset:2048
    v_mfma_f32_16x16x32_bf16 v[192:195], a[160:163], a[136:139], v[192:195]
    ds_read_b128 v[140:143], v6 offset:3072
    v_mfma_f32_16x16x32_bf16 v[192:195], a[164:167], a[140:143], v[192:195]
    ds_read_b128 v[144:147], v6 offset:4096
    v_mfma_f32_16x16x32_bf16 v[196:199], a[168:171], a[120:123], 0
    ds_read_b128 v[148:151], v6 offset:5120
    v_mfma_f32_16x16x32_bf16 v[196:199], a[172:175], a[124:127], v[196:199]
    ds_read_b128 v[152:155], v6 offset:6144
    v_mfma_f32_16x16x32_bf16 v[196:199], a[176:179], a[128:131], v[196:199]
    ds_read_b128 v[156:159], v6 offset:7168
    v_cvt_pk_bf16_f32 v120, v192, v193
    v_mfma_f32_16x16x32_bf16 v[196:199], a[180:183], a[132:135], v[196:199]
    s_waitcnt lgkmcnt(8)
    v_readfirstlane_b32 s43, v22
    v_mfma_f32_16x16x32_bf16 v[196:199], a[184:187], a[136:139], v[196:199]
    s_add_u32 m0, s42, 0
    s_add_u32 s46, s43, 0
    v_mfma_f32_16x16x32_bf16 v[196:199], a[188:191], a[140:143], v[196:199]
    v_cvt_pk_bf16_f32 v121, v194, v195
    v_xor_b32 v6, 8192, v6
    v_mfma_f32_16x16x32_bf16 v[200:203], a[192:195], a[120:123], 0
    buffer_load_dwordx4 v8, s[8:11], s46 offen offset:0 nt lds
    v_mfma_f32_16x16x32_bf16 v[200:203], a[196:199], a[124:127], v[200:203]
    ds_read_b128 a[144:147], v4 offset:0
    v_mfma_f32_16x16x32_bf16 v[200:203], a[200:203], a[128:131], v[200:203]
    v_cvt_pk_bf16_f32 v122, v196, v197
    v_cvt_pk_bf16_f32 v123, v198, v199
    v_mfma_f32_16x16x32_bf16 v[200:203], a[204:207], a[132:135], v[200:203]
    ds_read_b128 a[148:151], v5 offset:0
    v_mfma_f32_16x16x32_bf16 v[200:203], a[208:211], a[136:139], v[200:203]
    ds_read_b128 a[152:155], v4 offset:128
    v_mfma_f32_16x16x32_bf16 v[200:203], a[212:215], a[140:143], v[200:203]
    ds_read_b128 a[156:159], v5 offset:128
    v_mfma_f32_16x16x32_bf16 v[204:207], a[216:219], a[120:123], 0
    ds_read_b128 a[160:163], v4 offset:256
    v_mfma_f32_16x16x32_bf16 v[204:207], a[220:223], a[124:127], v[204:207]
    ds_read_b128 a[164:167], v5 offset:256
    v_mfma_f32_16x16x32_bf16 v[204:207], a[224:227], a[128:131], v[204:207]
    v_cvt_pk_bf16_f32 v124, v200, v201
    v_cvt_pk_bf16_f32 v125, v202, v203
    v_mfma_f32_16x16x32_bf16 v[204:207], a[228:231], a[132:135], v[204:207]
    ds_read_b128 a[168:171], v4 offset:6144
    v_mfma_f32_16x16x32_bf16 v[204:207], a[232:235], a[136:139], v[204:207]
    ds_read_b128 a[172:175], v5 offset:6144
    v_mfma_f32_16x16x32_bf16 v[204:207], a[236:239], a[140:143], v[204:207]
    ds_read_b128 a[176:179], v4 offset:6272
    s_waitcnt lgkmcnt(9)
    v_mfma_f32_16x16x32_bf16 v[184:187], v[128:131], v[32:35], 0
    ds_read_b128 a[180:183], v5 offset:6272
    v_mfma_f32_16x16x32_bf16 v[184:187], v[132:135], v[36:39], v[184:187]
    ds_read_b128 a[184:187], v4 offset:6400
    v_mfma_f32_16x16x32_bf16 v[188:191], v[128:131], v[40:43], 0
    v_cvt_pk_bf16_f32 v126, v204, v205
    v_cvt_pk_bf16_f32 v127, v206, v207
    v_mfma_f32_16x16x32_bf16 v[188:191], v[132:135], v[44:47], v[188:191]
    buffer_load_dwordx4 v9, s[8:11], s46 offen offset:1024 nt lds
    v_mfma_f32_16x16x32_bf16 v[192:195], v[128:131], v[48:51], 0
    ds_read_b128 a[188:191], v5 offset:6400
    v_mfma_f32_16x16x32_bf16 v[192:195], v[132:135], v[52:55], v[192:195]
    ds_read_b128 a[192:195], v4 offset:12288
    v_mfma_f32_16x16x32_bf16 v[196:199], v[128:131], v[56:59], 0
    v_cvt_pk_bf16_f32 v208, v184, v188
    v_cvt_pk_bf16_f32 v210, v185, v189
    v_mfma_f32_16x16x32_bf16 v[196:199], v[132:135], v[60:63], v[196:199]
    ds_read_b128 a[196:199], v5 offset:12288
    v_cvt_pk_bf16_f32 v212, v186, v190
    v_mfma_f32_16x16x32_bf16 v[200:203], v[64:67], v[128:131], 0
    ds_read_b128 a[200:203], v4 offset:12416
    v_cvt_pk_bf16_f32 v214, v187, v191
    v_mfma_f32_16x16x32_bf16 v[200:203], v[68:71], v[132:135], v[200:203]
    ds_read_b128 a[204:207], v5 offset:12416
    v_mfma_f32_16x16x32_bf16 v[204:207], v[72:75], v[128:131], 0
    v_cvt_pk_bf16_f32 v209, v192, v196
    v_cvt_pk_bf16_f32 v211, v193, v197
    v_mfma_f32_16x16x32_bf16 v[204:207], v[76:79], v[132:135], v[204:207]
    ds_read_b128 a[208:211], v4 offset:12544
    v_cvt_pk_bf16_f32 v213, v194, v198
    v_mfma_f32_16x16x32_bf16 v[160:163], v[136:139], v[32:35], 0
    ds_read_b128 a[212:215], v5 offset:12544
    v_cvt_pk_bf16_f32 v215, v195, v199
    v_mfma_f32_16x16x32_bf16 v[160:163], v[140:143], v[36:39], v[160:163]
    ds_read_b128 a[216:219], v4 offset:18432
    v_cvt_pk_bf16_f32 v216, v200, v201
    v_mfma_f32_16x16x32_bf16 v[164:167], v[136:139], v[40:43], 0
    ds_read_b128 a[220:223], v5 offset:18432
    v_cvt_pk_bf16_f32 v217, v202, v203
    v_mfma_f32_16x16x32_bf16 v[164:167], v[140:143], v[44:47], v[164:167]
    ds_read_b128 a[224:227], v4 offset:18560
    v_cvt_pk_bf16_f32 v218, v204, v205
    v_mfma_f32_16x16x32_bf16 v[168:171], v[136:139], v[48:51], 0
    buffer_store_dwordx2 v[208:209], v12, s[12:15], s16 offen offset:0 sc1
    v_mfma_f32_16x16x32_bf16 v[168:171], v[140:143], v[52:55], v[168:171]
    ds_read_b128 a[228:231], v5 offset:18560
    v_cvt_pk_bf16_f32 v219, v206, v207
    v_mfma_f32_16x16x32_bf16 v[172:175], v[136:139], v[56:59], 0
    buffer_load_dwordx4 v10, s[8:11], s46 offen offset:2048 nt lds
    v_mfma_f32_16x16x32_bf16 v[172:175], v[140:143], v[60:63], v[172:175]
    ds_read_b128 a[232:235], v4 offset:18688
    v_cvt_pk_bf16_f32 v220, v160, v164
    v_mfma_f32_16x16x32_bf16 v[176:179], v[64:67], v[136:139], 0
    ds_read_b128 a[236:239], v5 offset:18688
    v_cvt_pk_bf16_f32 v222, v161, v165
    v_mfma_f32_16x16x32_bf16 v[176:179], v[68:71], v[140:143], v[176:179]
    v_cvt_pk_bf16_f32 v224, v162, v166
    v_cvt_pk_bf16_f32 v226, v163, v167
    v_mfma_f32_16x16x32_bf16 v[180:183], v[72:75], v[136:139], 0
    v_cvt_pk_bf16_f32 v221, v168, v172
    v_cvt_pk_bf16_f32 v223, v169, v173
    v_mfma_f32_16x16x32_bf16 v[180:183], v[76:79], v[140:143], v[180:183]
    buffer_store_dwordx2 v[210:211], v12, s[12:15], s16 offen offset:384 sc1
    v_mfma_f32_16x16x32_bf16 v[184:187], v[144:147], v[32:35], 0
    v_cvt_pk_bf16_f32 v225, v170, v174
    v_cvt_pk_bf16_f32 v227, v171, v175
    v_mfma_f32_16x16x32_bf16 v[184:187], v[148:151], v[36:39], v[184:187]
    v_cvt_pk_bf16_f32 v228, v176, v177
    v_cvt_pk_bf16_f32 v229, v178, v179
    v_mfma_f32_16x16x32_bf16 v[188:191], v[144:147], v[40:43], 0
    v_cvt_pk_bf16_f32 v230, v180, v181
    v_cvt_pk_bf16_f32 v231, v182, v183
    v_mfma_f32_16x16x32_bf16 v[188:191], v[148:151], v[44:47], v[188:191]
    v_mfma_f32_16x16x32_bf16 v[192:195], v[144:147], v[48:51], 0
    v_mfma_f32_16x16x32_bf16 v[192:195], v[148:151], v[52:55], v[192:195]
    v_mfma_f32_16x16x32_bf16 v[196:199], v[144:147], v[56:59], 0
    v_cvt_pk_bf16_f32 v232, v184, v188
    v_cvt_pk_bf16_f32 v234, v185, v189
    v_mfma_f32_16x16x32_bf16 v[196:199], v[148:151], v[60:63], v[196:199]
    buffer_store_dwordx2 v[212:213], v12, s[12:15], s16 offen offset:768 sc1
    v_mfma_f32_16x16x32_bf16 v[200:203], v[64:67], v[144:147], 0
    s_add_u32 m0, s42, 6144
    s_add_u32 s46, s43, 393216
    v_mfma_f32_16x16x32_bf16 v[200:203], v[68:71], v[148:151], v[200:203]
    buffer_load_dwordx4 v8, s[8:11], s46 offen offset:0 nt lds
    v_mfma_f32_16x16x32_bf16 v[204:207], v[72:75], v[144:147], 0
    v_cvt_pk_bf16_f32 v233, v192, v196
    v_cvt_pk_bf16_f32 v235, v193, v197
    v_mfma_f32_16x16x32_bf16 v[204:207], v[76:79], v[148:151], v[204:207]
    v_cvt_pk_bf16_f32 v237, v194, v198
    v_cvt_pk_bf16_f32 v239, v195, v199
    v_mfma_f32_16x16x32_bf16 v[160:163], v[152:155], v[32:35], 0
    v_cvt_pk_bf16_f32 v240, v200, v201
    v_cvt_pk_bf16_f32 v241, v202, v203
    v_mfma_f32_16x16x32_bf16 v[160:163], v[156:159], v[36:39], v[160:163]
    v_cvt_pk_bf16_f32 v236, v186, v190
    v_cvt_pk_bf16_f32 v238, v187, v191
    v_mfma_f32_16x16x32_bf16 v[164:167], v[152:155], v[40:43], 0
    buffer_store_dwordx2 v[214:215], v12, s[12:15], s16 offen offset:1152 sc1
    v_mfma_f32_16x16x32_bf16 v[164:167], v[156:159], v[44:47], v[164:167]
    v_cvt_pk_bf16_f32 v242, v204, v205
    v_cvt_pk_bf16_f32 v243, v206, v207
    v_mfma_f32_16x16x32_bf16 v[168:171], v[152:155], v[48:51], 0
    v_mfma_f32_16x16x32_bf16 v[168:171], v[156:159], v[52:55], v[168:171]
    v_mfma_f32_16x16x32_bf16 v[172:175], v[152:155], v[56:59], 0
    v_cvt_pk_bf16_f32 v244, v160, v164
    v_cvt_pk_bf16_f32 v246, v161, v165
    v_mfma_f32_16x16x32_bf16 v[172:175], v[156:159], v[60:63], v[172:175]
    v_cvt_pk_bf16_f32 v248, v162, v166
    v_cvt_pk_bf16_f32 v250, v163, v167
    v_mfma_f32_16x16x32_bf16 v[176:179], v[64:67], v[152:155], 0
    v_mfma_f32_16x16x32_bf16 v[176:179], v[68:71], v[156:159], v[176:179]
    v_mfma_f32_16x16x32_bf16 v[180:183], v[72:75], v[152:155], 0
    buffer_store_dwordx4 v[216:219], v16, s[12:15], s16 offen sc1
    v_mfma_f32_16x16x32_bf16 v[180:183], v[76:79], v[156:159], v[180:183]
    v_cvt_pk_bf16_f32 v245, v168, v172
    s_cmp_ge_u32 s18, 100663296
    s_cbranch_scc1 L_nepi1
L_nmid1:
    s_waitcnt lgkmcnt(0)
    v_mfma_f32_16x16x32_bf16 v[192:195], a[144:147], a[0:3], 0
    buffer_load_dwordx4 v9, s[8:11], s46 offen offset:1024 nt lds
    v_mfma_f32_16x16x32_bf16 v[192:195], a[148:151], a[4:7], v[192:195]
    v_cvt_pk_bf16_f32 v247, v169, v173
    v_cvt_pk_bf16_f32 v249, v170, v174
    v_mfma_f32_16x16x32_bf16 v[192:195], a[152:155], a[8:11], v[192:195]
    v_cvt_pk_bf16_f32 v251, v171, v175
    v_cvt_pk_bf16_f32 v252, v176, v177
    v_mfma_f32_16x16x32_bf16 v[192:195], a[156:159], a[12:15], v[192:195]
    v_cvt_pk_bf16_f32 v253, v178, v179
    v_cvt_pk_bf16_f32 v254, v180, v181
    v_mfma_f32_16x16x32_bf16 v[192:195], a[160:163], a[16:19], v[192:195]
    v_cvt_pk_bf16_f32 v255, v182, v183
    v_mfma_f32_16x16x32_bf16 v[192:195], a[164:167], a[20:23], v[192:195]
    v_mfma_f32_16x16x32_bf16 v[196:199], a[168:171], a[0:3], 0
    buffer_store_dwordx2 v[220:221], v13, s[12:15], s16 offen offset:0 sc1
    v_mfma_f32_16x16x32_bf16 v[196:199], a[172:175], a[4:7], v[196:199]
    v_mfma_f32_16x16x32_bf16 v[196:199], a[176:179], a[8:11], v[196:199]
    v_cvt_pk_bf16_f32 v32, v192, v193
    v_cvt_pk_bf16_f32 v33, v194, v195
    v_mfma_f32_16x16x32_bf16 v[196:199], a[180:183], a[12:15], v[196:199]
    v_mfma_f32_16x16x32_bf16 v[196:199], a[184:187], a[16:19], v[196:199]
    v_mfma_f32_16x16x32_bf16 v[196:199], a[188:191], a[20:23], v[196:199]
    v_mfma_f32_16x16x32_bf16 v[200:203], a[192:195], a[0:3], 0
    v_mfma_f32_16x16x32_bf16 v[200:203], a[196:199], a[4:7], v[200:203]
    buffer_store_dwordx2 v[222:223], v13, s[12:15], s16 offen offset:384 sc1
    v_mfma_f32_16x16x32_bf16 v[200:203], a[200:203], a[8:11], v[200:203]
    v_cvt_pk_bf16_f32 v34, v196, v197
    v_cvt_pk_bf16_f32 v35, v198, v199
    v_mfma_f32_16x16x32_bf16 v[200:203], a[204:207], a[12:15], v[200:203]
    buffer_load_dwordx4 v10, s[8:11], s46 offen offset:2048 nt lds
    v_mfma_f32_16x16x32_bf16 v[200:203], a[208:211], a[16:19], v[200:203]
    v_mfma_f32_16x16x32_bf16 v[200:203], a[212:215], a[20:23], v[200:203]
    v_mfma_f32_16x16x32_bf16 v[204:207], a[216:219], a[0:3], 0
    v_mfma_f32_16x16x32_bf16 v[204:207], a[220:223], a[4:7], v[204:207]
    v_mfma_f32_16x16x32_bf16 v[204:207], a[224:227], a[8:11], v[204:207]
    v_cvt_pk_bf16_f32 v36, v200, v201
    v_cvt_pk_bf16_f32 v37, v202, v203
    v_mfma_f32_16x16x32_bf16 v[204:207], a[228:231], a[12:15], v[204:207]
    buffer_store_dwordx2 v[224:225], v13, s[12:15], s16 offen offset:768 sc1
    v_mfma_f32_16x16x32_bf16 v[204:207], a[232:235], a[16:19], v[204:207]
    v_mfma_f32_16x16x32_bf16 v[204:207], a[236:239], a[20:23], v[204:207]
    v_mfma_f32_16x16x32_bf16 v[192:195], a[144:147], a[24:27], 0
    v_mfma_f32_16x16x32_bf16 v[192:195], a[148:151], a[28:31], v[192:195]
    v_mfma_f32_16x16x32_bf16 v[192:195], a[152:155], a[32:35], v[192:195]
    v_cvt_pk_bf16_f32 v38, v204, v205
    v_cvt_pk_bf16_f32 v39, v206, v207
    v_mfma_f32_16x16x32_bf16 v[192:195], a[156:159], a[36:39], v[192:195]
    v_mfma_f32_16x16x32_bf16 v[192:195], a[160:163], a[40:43], v[192:195]
    buffer_store_dwordx2 v[226:227], v13, s[12:15], s16 offen offset:1152 sc1
    v_mfma_f32_16x16x32_bf16 v[192:195], a[164:167], a[44:47], v[192:195]
    s_add_u32 m0, s42, 12288
    s_add_u32 s46, s43, 786432
    v_mfma_f32_16x16x32_bf16 v[196:199], a[168:171], a[24:27], 0
    buffer_load_dwordx4 v8, s[8:11], s46 offen offset:0 nt lds
    v_mfma_f32_16x16x32_bf16 v[196:199], a[172:175], a[28:31], v[196:199]
    s_add_u32 s41, s41, 24576
    s_cmp_ge_u32 s41, 73728
    s_cselect_b32 s56, 73728, 0
    s_sub_u32 s41, s41, s56
    v_add_u32 v4, s41, v2
    v_mfma_f32_16x16x32_bf16 v[196:199], a[176:179], a[32:35], v[196:199]
    v_cvt_pk_bf16_f32 v40, v192, v193
    v_cvt_pk_bf16_f32 v41, v194, v195
    v_mfma_f32_16x16x32_bf16 v[196:199], a[180:183], a[36:39], v[196:199]
    v_add_u32 v5, s41, v3
    v_mfma_f32_16x16x32_bf16 v[196:199], a[184:187], a[40:43], v[196:199]
    v_mfma_f32_16x16x32_bf16 v[196:199], a[188:191], a[44:47], v[196:199]
    v_mfma_f32_16x16x32_bf16 v[200:203], a[192:195], a[24:27], 0
    buffer_store_dwordx4 v[228:231], v17, s[12:15], s16 offen sc1
    v_mfma_f32_16x16x32_bf16 v[200:203], a[196:199], a[28:31], v[200:203]
    v_mfma_f32_16x16x32_bf16 v[200:203], a[200:203], a[32:35], v[200:203]
    v_cvt_pk_bf16_f32 v42, v196, v197
    v_cvt_pk_bf16_f32 v43, v198, v199
    v_mfma_f32_16x16x32_bf16 v[200:203], a[204:207], a[36:39], v[200:203]
    v_mfma_f32_16x16x32_bf16 v[200:203], a[208:211], a[40:43], v[200:203]
    v_mfma_f32_16x16x32_bf16 v[200:203], a[212:215], a[44:47], v[200:203]
    v_mfma_f32_16x16x32_bf16 v[204:207], a[216:219], a[24:27], 0
    v_mfma_f32_16x16x32_bf16 v[204:207], a[220:223], a[28:31], v[204:207]
    v_mfma_f32_16x16x32_bf16 v[204:207], a[224:227], a[32:35], v[204:207]
    buffer_store_dwordx2 v[232:233], v14, s[12:15], s16 offen offset:0 sc1
    v_mfma_f32_16x16x32_bf16 v[204:207], a[228:231], a[36:39], v[204:207]
    buffer_load_dwordx4 v9, s[8:11], s46 offen offset:1024 nt lds
    v_mfma_f32_16x16x32_bf16 v[204:207], a[232:235], a[40:43], v[204:207]
    v_cvt_pk_bf16_f32 v44, v200, v201
    v_cvt_pk_bf16_f32 v45, v202, v203
    v_mfma_f32_16x16x32_bf16 v[204:207], a[236:239], a[44:47], v[204:207]
    v_mfma_f32_16x16x32_bf16 v[192:195], a[144:147], a[48:51], 0
    v_mfma_f32_16x16x32_bf16 v[192:195], a[148:151], a[52:55], v[192:195]
    v_mfma_f32_16x16x32_bf16 v[192:195], a[152:155], a[56:59], v[192:195]
    v_cvt_pk_bf16_f32 v46, v204, v205
    v_cvt_pk_bf16_f32 v47, v206, v207
    v_mfma_f32_16x16x32_bf16 v[192:195], a[156:159], a[60:63], v[192:195]
    buffer_store_dwordx2 v[234:235], v14, s[12:15], s16 offen offset:384 sc1
    v_mfma_f32_16x16x32_bf16 v[192:195], a[160:163], a[64:67], v[192:195]
    v_mfma_f32_16x16x32_bf16 v[192:195], a[164:167], a[68:71], v[192:195]
    v_mfma_f32_16x16x32_bf16 v[196:199], a[168:171], a[48:51], 0
    v_mfma_f32_16x16x32_bf16 v[196:199], a[172:175], a[52:55], v[196:199]
    v_mfma_f32_16x16x32_bf16 v[196:199], a[176:179], a[56:59], v[196:199]
    v_cvt_pk_bf16_f32 v48, v192, v193
    v_cvt_pk_bf16_f32 v49, v194, v195
    v_mfma_f32_16x16x32_bf16 v[196:199], a[180:183], a[60:63], v[196:199]
    v_mfma_f32_16x16x32_bf16 v[196:199], a[184:187], a[64:67], v[196:199]
    v_mfma_f32_16x16x32_bf16 v[196:199], a[188:191], a[68:71], v[196:199]
    buffer_store_dwordx2 v[236:237], v14, s[12:15], s16 offen offset:768 sc1
    v_mfma_f32_16x16x32_bf16 v[200:203], a[192:195], a[48:51], 0
    buffer_load_dwordx4 v10, s[8:11], s46 offen offset:2048 nt lds
    v_mfma_f32_16x16x32_bf16 v[200:203], a[196:199], a[52:55], v[200:203]
    v_mfma_f32_16x16x32_bf16 v[200:203], a[200:203], a[56:59], v[200:203]
    v_cvt_pk_bf16_f32 v50, v196, v197
    v_cvt_pk_bf16_f32 v51, v198, v199
    v_mfma_f32_16x16x32_bf16 v[200:203], a[204:207], a[60:63], v[200:203]
    v_mfma_f32_16x16x32_bf16 v[200:203], a[208:211], a[64:67], v[200:203]
    v_mfma_f32_16x16x32_bf16 v[200:203], a[212:215], a[68:71], v[200:203]
    v_mfma_f32_16x16x32_bf16 v[204:207], a[216:219], a[48:51], 0
    buffer_store_dwordx2 v[238:239], v14, s[12:15], s16 offen offset:1152 sc1
    v_mfma_f32_16x16x32_bf16 v[204:207], a[220:223], a[52:55], v[204:207]
    v_mfma_f32_16x16x32_bf16 v[204:207], a[224:227], a[56:59], v[204:207]
    v_cvt_pk_bf16_f32 v52, v200, v201
    v_cvt_pk_bf16_f32 v53, v202, v203
    v_mfma_f32_16x16x32_bf16 v[204:207], a[228:231], a[60:63], v[204:207]
    v_mfma_f32_16x16x32_bf16 v[204:207], a[232:235], a[64:67], v[204:207]
    v_mfma_f32_16x16x32_bf16 v[204:207], a[236:239], a[68:71], v[204:207]
    v_mfma_f32_16x16x32_bf16 v[192:195], a[144:147], a[72:75], 0
    v_mfma_f32_16x16x32_bf16 v[192:195], a[148:151], a[76:79], v[192:195]
    s_add_u32 m0, s42, 18432
    s_add_u32 s46, s43, 1179648
    v_mfma_f32_16x16x32_bf16 v[192:195], a[152:155], a[80:83], v[192:195]
    buffer_store_dwordx4 v[240:243], v18, s[12:15], s16 offen sc1
    v_mfma_f32_16x16x32_bf16 v[192:195], a[156:159], a[84:87], v[192:195]
    buffer_load_dwordx4 v8, s[8:11], s46 offen offset:0 nt lds
    v_mfma_f32_16x16x32_bf16 v[192:195], a[160:163], a[88:91], v[192:195]
    v_cvt_pk_bf16_f32 v54, v204, v205
    v_cvt_pk_bf16_f32 v55, v206, v207
    v_mfma_f32_16x16x32_bf16 v[192:195], a[164:167], a[92:95], v[192:195]
    v_mfma_f32_16x16x32_bf16 v[196:199], a[168:171], a[72:75], 0
    v_mfma_f32_16x16x32_bf16 v[196:199], a[172:175], a[76:79], v[196:199]
    v_mfma_f32_16x16x32_bf16 v[196:199], a[176:179], a[80:83], v[196:199]
    v_cvt_pk_bf16_f32 v56, v192, v193
    v_cvt_pk_bf16_f32 v57, v194, v195
    v_mfma_f32_16x16x32_bf16 v[196:199], a[180:183], a[84:87], v[196:199]
    v_mfma_f32_16x16x32_bf16 v[196:199], a[184:187], a[88:91], v[196:199]
    buffer_store_dwordx2 v[244:245], v15, s[12:15], s16 offen offset:0 sc1
    v_mfma_f32_16x16x32_bf16 v[196:199], a[188:191], a[92:95], v[196:199]
    v_mfma_f32_16x16x32_bf16 v[200:203], a[192:195], a[72:75], 0
    v_mfma_f32_16x16x32_bf16 v[200:203], a[196:199], a[76:79], v[200:203]
    v_mfma_f32_16x16x32_bf16 v[200:203], a[200:203], a[80:83], v[200:203]
    v_cvt_pk_bf16_f32 v58, v196, v197
    v_cvt_pk_bf16_f32 v59, v198, v199
    v_mfma_f32_16x16x32_bf16 v[200:203], a[204:207], a[84:87], v[200:203]
    v_mfma_f32_16x16x32_bf16 v[200:203], a[208:211], a[88:91], v[200:203]
    v_mfma_f32_16x16x32_bf16 v[200:203], a[212:215], a[92:95], v[200:203]
    buffer_store_dwordx2 v[246:247], v15, s[12:15], s16 offen offset:384 sc1
    v_mfma_f32_16x16x32_bf16 v[204:207], a[216:219], a[72:75], 0
    buffer_load_dwordx4 v9, s[8:11], s46 offen offset:1024 nt lds
    v_mfma_f32_16x16x32_bf16 v[204:207], a[220:223], a[76:79], v[204:207]
    s_add_u32 s42, s42, 24576
    s_cmp_ge_u32 s42, 73728
    s_cselect_b32 s57, 73728, 0
    s_sub_u32 s42, s42, s57
    v_mfma_f32_16x16x32_bf16 v[204:207], a[224:227], a[80:83], v[204:207]
    v_cvt_pk_bf16_f32 v60, v200, v201
    v_cvt_pk_bf16_f32 v61, v202, v203
    v_mfma_f32_16x16x32_bf16 v[204:207], a[228:231], a[84:87], v[204:207]
    v_mfma_f32_16x16x32_bf16 v[204:207], a[232:235], a[88:91], v[204:207]
    v_mfma_f32_16x16x32_bf16 v[204:207], a[236:239], a[92:95], v[204:207]
    v_mfma_f32_16x16x32_bf16 v[192:195], a[144:147], a[96:99], 0
    v_mfma_f32_16x16x32_bf16 v[192:195], a[148:151], a[100:103], v[192:195]
    buffer_store_dwordx2 v[248:249], v15, s[12:15], s16 offen offset:768 sc1
    v_mfma_f32_16x16x32_bf16 v[192:195], a[152:155], a[104:107], v[192:195]
    v_cvt_pk_bf16_f32 v62, v204, v205
    v_cvt_pk_bf16_f32 v63, v206, v207
    v_mfma_f32_16x16x32_bf16 v[192:195], a[156:159], a[108:111], v[192:195]
    v_mfma_f32_16x16x32_bf16 v[192:195], a[160:163], a[112:115], v[192:195]
    v_mfma_f32_16x16x32_bf16 v[192:195], a[164:167], a[116:119], v[192:195]
    v_mfma_f32_16x16x32_bf16 v[196:199], a[168:171], a[96:99], 0
    v_mfma_f32_16x16x32_bf16 v[196:199], a[172:175], a[100:103], v[196:199]
    v_mfma_f32_16x16x32_bf16 v[196:199], a[176:179], a[104:107], v[196:199]
    buffer_store_dwordx2 v[250:251], v15, s[12:15], s16 offen offset:1152 sc1
    v_mfma_f32_16x16x32_bf16 v[196:199], a[180:183], a[108:111], v[196:199]
    buffer_load_dwordx4 v10, s[8:11], s46 offen offset:2048 nt lds
    v_mfma_f32_16x16x32_bf16 v[196:199], a[184:187], a[112:115], v[196:199]
    v_cvt_pk_bf16_f32 v64, v192, v193
    v_cvt_pk_bf16_f32 v65, v194, v195
    v_mfma_f32_16x16x32_bf16 v[196:199], a[188:191], a[116:119], v[196:199]
    v_mfma_f32_16x16x32_bf16 v[200:203], a[192:195], a[96:99], 0
    v_mfma_f32_16x16x32_bf16 v[200:203], a[196:199], a[100:103], v[200:203]
    v_mfma_f32_16x16x32_bf16 v[200:203], a[200:203], a[104:107], v[200:203]
    v_cvt_pk_bf16_f32 v66, v196, v197
    v_cvt_pk_bf16_f32 v67, v198, v199
    v_mfma_f32_16x16x32_bf16 v[200:203], a[204:207], a[108:111], v[200:203]
    v_mfma_f32_16x16x32_bf16 v[200:203], a[208:211], a[112:115], v[200:203]
    buffer_store_dwordx4 v[252:255], v19, s[12:15], s16 offen sc1
    v_mfma_f32_16x16x32_bf16 v[200:203], a[212:215], a[116:119], v[200:203]
    s_nop 0
    s_mov_b32 s16, s17
    s_mov_b32 s17, s18
    v_mfma_f32_16x16x32_bf16 v[204:207], a[216:219], a[96:99], 0
    s_mov_b32 s18, s19
    s_mov_b32 s19, s43
    v_mfma_f32_16x16x32_bf16 v[204:207], a[220:223], a[100:103], v[204:207]
    v_mfma_f32_16x16x32_bf16 v[204:207], a[224:227], a[104:107], v[204:207]
    v_cvt_pk_bf16_f32 v68, v200, v201
    v_cvt_pk_bf16_f32 v69, v202, v203
    v_mfma_f32_16x16x32_bf16 v[204:207], a[228:231], a[108:111], v[204:207]
    v_mfma_f32_16x16x32_bf16 v[204:207], a[232:235], a[112:115], v[204:207]
    v_mfma_f32_16x16x32_bf16 v[204:207], a[236:239], a[116:119], v[204:207]
    s_waitcnt vmcnt(32)
    s_barrier
    s_branch L_nloop0
L_nepi0:
    v_cvt_pk_bf16_f32 v247, v169, v173
    v_cvt_pk_bf16_f32 v249, v170, v174
    v_cvt_pk_bf16_f32 v251, v171, v175
    v_cvt_pk_bf16_f32 v252, v176, v177
    v_cvt_pk_bf16_f32 v253, v178, v179
    v_cvt_pk_bf16_f32 v254, v180, v181
    v_cvt_pk_bf16_f32 v255, v182, v183
    buffer_store_dwordx2 v[220:221], v13, s[12:15], s16 offen offset:0 sc1
    buffer_store_dwordx2 v[222:223], v13, s[12:15], s16 offen offset:384 sc1
    buffer_store_dwordx2 v[224:225], v13, s[12:15], s16 offen offset:768 sc1
    buffer_store_dwordx2 v[226:227], v13, s[12:15], s16 offen offset:1152 sc1
    buffer_store_dwordx4 v[228:231], v17, s[12:15], s16 offen sc1
    buffer_store_dwordx2 v[232:233], v14, s[12:15], s16 offen offset:0 sc1
    buffer_store_dwordx2 v[234:235], v14, s[12:15], s16 offen offset:384 sc1
    buffer_store_dwordx2 v[236:237], v14, s[12:15], s16 offen offset:768 sc1
    buffer_store_dwordx2 v[238:239], v14, s[12:15], s16 offen offset:1152 sc1
    buffer_store_dwordx4 v[240:243], v18, s[12:15], s16 offen sc1
    buffer_store_dwordx2 v[244:245], v15, s[12:15], s16 offen offset:0 sc1
    buffer_store_dwordx2 v[246:247], v15, s[12:15], s16 offen offset:384 sc1
    buffer_store_dwordx2 v[248:249], v15, s[12:15], s16 offen offset:768 sc1
    buffer_store_dwordx2 v[250:251], v15, s[12:15], s16 offen offset:1152 sc1
    buffer_store_dwordx4 v[252:255], v19, s[12:15], s16 offen sc1
    s_cmp_ge_u32 s17, 100663296
    s_cbranch_scc1 L_fin
    s_mov_b32 s16, s17
    s_mov_b32 s17, s18
    s_mov_b32 s18, s19
    s_mov_b32 s19, s43
    s_barrier
    s_branch L_nloop1
L_nepi1:
    v_cvt_pk_bf16_f32 v247, v169, v173
    v_cvt_pk_bf16_f32 v249, v170, v174
    v_cvt_pk_bf16_f32 v251, v171, v175
    v_cvt_pk_bf16_f32 v252, v176, v177
    v_cvt_pk_bf16_f32 v253, v178, v179
    v_cvt_pk_bf16_f32 v254, v180, v181
    v_cvt_pk_bf16_f32 v255, v182, v183
    buffer_store_dwordx2 v[220:221], v13, s[12:15], s16 offen offset:0 sc1
    buffer_store_dwordx2 v[222:223], v13, s[12:15], s16 offen offset:384 sc1
    buffer_store_dwordx2 v[224:225], v13, s[12:15], s16 offen offset:768 sc1
    buffer_store_dwordx2 v[226:227], v13, s[12:15], s16 offen offset:1152 sc1
    buffer_store_dwordx4 v[228:231], v17, s[12:15], s16 offen sc1
    buffer_store_dwordx2 v[232:233], v14, s[12:15], s16 offen offset:0 sc1
    buffer_store_dwordx2 v[234:235], v14, s[12:15], s16 offen offset:384 sc1
    buffer_store_dwordx2 v[236:237], v14, s[12:15], s16 offen offset:768 sc1
    buffer_store_dwordx2 v[238:239], v14, s[12:15], s16 offen offset:1152 sc1
    buffer_store_dwordx4 v[240:243], v18, s[12:15], s16 offen sc1
    buffer_store_dwordx2 v[244:245], v15, s[12:15], s16 offen offset:0 sc1
    buffer_store_dwordx2 v[246:247], v15, s[12:15], s16 offen offset:384 sc1
    buffer_store_dwordx2 v[248:249], v15, s[12:15], s16 offen offset:768 sc1
    buffer_store_dwordx2 v[250:251], v15, s[12:15], s16 offen offset:1152 sc1
    buffer_store_dwordx4 v[252:255], v19, s[12:15], s16 offen sc1
    s_cmp_ge_u32 s17, 100663296
    s_cbranch_scc1 L_fin
    s_mov_b32 s16, s17
    s_mov_b32 s17, s18
    s_mov_b32 s18, s19
    s_mov_b32 s19, s43
    s_barrier
    s_branch L_nloop0
L_fin:
L_end:
    s_endpgm
L_codeend:
.section .rodata,"a"
.p2align 6
.amdhsa_kernel swin_prep_kernel
  .amdhsa_next_free_vgpr 136
  .amdhsa_next_free_sgpr 40
  .amdhsa_accum_offset 136
  .amdhsa_group_segment_fixed_size 0
  .amdhsa_kernarg_size 48
  .amdhsa_user_sgpr_count 2
  .amdhsa_user_sgpr_kernarg_segment_ptr 1
  .amdhsa_system_sgpr_workgroup_id_x 1
.end_amdhsa_kernel
.p2align 6
.amdhsa_kernel standalone__swin_window_attn__vision_kernel
  .amdhsa_next_free_vgpr 512
  .amdhsa_next_free_sgpr 100
  .amdhsa_accum_offset 256
  .amdhsa_group_segment_fixed_size 0
  .amdhsa_kernarg_size 48
  .amdhsa_user_sgpr_count 2
  .amdhsa_user_sgpr_kernarg_segment_ptr 1
  .amdhsa_system_sgpr_workgroup_id_x 1
.end_amdhsa_kernel
```
